```python
import torch

def _softmax(x, axis=-1):
    return torch.softmax(x, dim=axis)

def _gelu(x):
    return torch.nn.functional.gelu(x, approximate='tanh')

def _silu(x):
    return torch.nn.functional.silu(x)

def _sigmoid(x):
    return torch.sigmoid(x)

def _layernorm(x, axis=-1, eps=1e-05):
    m = x.mean(dim=axis, keepdim=True)
    v = x.var(dim=axis, keepdim=True, unbiased=False)
    return (x - m) / torch.sqrt(v + eps)

def _scatter_add(tgt, idx, src, axis=0):
    return tgt.clone().index_add_(axis, idx, src)

def _segment_sum(src, seg, n):
    out = torch.zeros((n,) + src.shape[1:], dtype=src.dtype)
    return out.index_add_(0, seg, src)

def _pad(x, pw):
    flat = tuple((v for pair in reversed(pw) for v in pair))
    return torch.nn.functional.pad(x, flat)
kernel_name = 'sequential_preLN__memory_aug_recurrent_mem_tr__mixer_token_mlp__prompt'

def setup_inputs():

    _w = lambda a: (lambda t: t.to(torch.bfloat16) if t.is_floating_point() else t)(torch.as_tensor(a))

    def _A_setup():
        B, S, Dm = (1, 2048, 576)
        H, Dh = (32, 128)
        M, seg = (8, 32)
        seg = min(seg, S)
        S = S // seg * seg
        return {'x': _w((lambda *s: torch.randn(*s, dtype=torch.bfloat16) * 0.05)(B, S, Dm)), 'mem0': _w((lambda *s: torch.randn(*s, dtype=torch.bfloat16) * 0.2)(B, M, Dm)), 'Wq': _w((lambda *s: torch.randn(*s, dtype=torch.bfloat16) * 1.6)(Dm, H, Dh) * Dm ** (-0.5)), 'Wk': _w((lambda *s: torch.randn(*s, dtype=torch.bfloat16) * 1.6)(Dm, H, Dh) * Dm ** (-0.5)), 'Wv': _w((lambda *s: torch.randn(*s, dtype=torch.bfloat16) * 0.2)(Dm, H, Dh) * Dm ** (-0.5)), 'Wo': _w((lambda *s: torch.randn(*s, dtype=torch.bfloat16) * 0.2)(H, Dh, Dm) * (H * Dh) ** (-0.5)), 'seg_len': seg}
    _A_in = _A_setup()

    def _B_setup():
        B, S, D, F = (1, 2048, 576, 4608)
        return {'x': _w((lambda *s: torch.randn(*s, dtype=torch.bfloat16) * 0.05)(B, S, D)), 'w1': _w((lambda *s: torch.randn(*s, dtype=torch.bfloat16) * 0.4)(S, F) * S ** (-0.5)), 'b1': _w((lambda *s: torch.randn(*s, dtype=torch.bfloat16) * 3.2)(F) * 0.02), 'w2': _w((lambda *s: torch.randn(*s, dtype=torch.bfloat16) * 0.8)(F, S) * F ** (-0.5)), 'b2': _w((lambda *s: torch.randn(*s, dtype=torch.bfloat16) * 3.2)(S) * 0.02)}
    _B_in = _B_setup()
    return {'A_x': _A_in['x'], 'A_mem0': _A_in['mem0'], 'A_Wq': _A_in['Wq'], 'A_Wk': _A_in['Wk'], 'A_Wv': _A_in['Wv'], 'A_Wo': _A_in['Wo'], 'A_seg_len': _A_in['seg_len'], 'B_x': _B_in['x'], 'B_w1': _B_in['w1'], 'B_b1': _B_in['b1'], 'B_w2': _B_in['w2'], 'B_b2': _B_in['b2']}

def reference(A_x, A_mem0, A_Wq, A_Wk, A_Wv, A_Wo, A_seg_len, B_x, B_w1, B_b1, B_w2, B_b2):

    def _A_ref(x, mem0, Wq, Wk, Wv, Wo, seg_len):
        B, S, Dm = x.shape
        H, Dh = (Wq.shape[1], Wq.shape[2])
        M = mem0.shape[1]
        scale = Dh ** (-0.5)
        n_seg = S // seg_len
        L = M + seg_len
        idx = torch.arange(L)
        mask = (idx[:, None] < M) | (idx[:, None] >= idx[None, :])
        mem = mem0
        outs = []
        for s in range(n_seg):
            xs = x[:, s * seg_len:(s + 1) * seg_len, :].clone()
            h = torch.concatenate([mem, xs], axis=1)
            q = torch.einsum('btd,dhe->bhte', h, Wq)
            k = torch.einsum('btd,dhe->bhte', h, Wk)
            v = torch.einsum('btd,dhe->bhte', h, Wv)
            scores = torch.einsum('bhqe,bhke->bhqk', q, k) * scale
            scores = torch.where(mask[None, None], scores, -1000000000.0)
            p = _softmax(scores, axis=-1)
            o = torch.einsum('bhqk,bhke->bhqe', p, v)
            o = torch.einsum('bhte,hed->btd', o, Wo)
            mem = o[:, :M, :].clone()
            outs.append(o[:, M:, :])
        return torch.concatenate(outs, axis=1)

    def _B_ref(x, w1, b1, w2, b2):
        B, S, D = x.shape
        h = _layernorm(x, axis=-1)
        u = torch.einsum('bsd,sf->bdf', h, w1) + b1
        u = _gelu(u)
        y = torch.einsum('bdf,fs->bds', u, w2) + b2
        return (lambda x, *d: x.permute(*d))(y, 0, 2, 1)
    x = A_x
    h = x + _A_ref(_layernorm(x, axis=-1), A_mem0, A_Wq, A_Wk, A_Wv, A_Wo, A_seg_len)
    h2 = h + _B_ref(_layernorm(h, axis=-1), B_w1, B_b1, B_w2, B_b2)
    return h2
```

```asm
; @launch kernel=init_kernel grid=(256,1,1) block=(256,1,1) lds=0
; @launch kernel=main_kernel grid=(256,1,1) block=(256,1,1) lds=163840
; @launch kernel=mlp2_kernel grid=(192,1,1) block=(512,1,1) lds=163840
; @launch kernel=fin_kernel grid=(576,1,1) block=(256,1,1) lds=0
.amdgcn_target "amdgcn-amd-amdhsa--gfx950"
.text
.globl init_kernel
.p2align 8
.type init_kernel,@function
init_kernel:
    s_cmp_lt_u32 s2, 256
    s_cbranch_scc1 go_1
    s_endpgm
go_1:
    s_load_dwordx2 s[4:5], s[0:1], 112
    s_load_dwordx2 s[8:9], s[0:1], 0
    s_mov_b32 s10, 2359296
    s_mov_b32 s11, 0x00020000
    s_load_dwordx2 s[12:13], s[0:1], 8
    s_mov_b32 s14, 9216
    s_mov_b32 s15, 0x00020000
    s_waitcnt lgkmcnt(0)
    s_add_u32 s16, s4, 0
    s_addc_u32 s17, s5, 0
    s_mov_b32 s18, 2359296
    s_mov_b32 s19, 0x00020000
    s_add_u32 s20, s4, 2359296
    s_addc_u32 s21, s5, 0
    s_mov_b32 s22, 1179648
    s_mov_b32 s23, 0x00020000
    s_add_u32 s24, s4, 3538944
    s_addc_u32 s25, s5, 0
    s_mov_b32 s26, 27648
    s_mov_b32 s27, 0x00020000
    s_add_u32 s28, s4, 3567616
    s_addc_u32 s29, s5, 0
    s_mov_b32 s30, 262144
    s_mov_b32 s31, 0x00020000
    s_add_u32 s32, s4, 3538944
    s_addc_u32 s33, s5, 0
    s_mov_b32 s34, 27648
    s_mov_b32 s35, 0x00020000
    s_mov_b32 s34, 9216
    s_lshl_b32 s3, s2, 8
    v_add_u32 v40, s3, v0
    v_lshlrev_b32 v41, 4, v40
    v_and_b32 v42, 7, v40
    v_mul_u32_u24 v42, 1152, v42
    v_lshrrev_b32 v43, 3, v40
    v_lshl_add_u32 v42, v43, 4, v42
    buffer_load_dwordx4 v[44:47], v42, s[12:15], 0 offen
    v_mov_b32 v48, -1
    v_mov_b32 v52, 0
    v_mov_b32 v49, -1
    v_mov_b32 v53, 0
    v_mov_b32 v50, -1
    v_mov_b32 v54, 0
    v_mov_b32 v51, -1
    v_mov_b32 v55, 0
    s_mov_b32 s6, 1048576
    s_mov_b32 s7, 9216
    buffer_store_dwordx4 v[48:51], v41, s[20:23], 0 offen
    buffer_store_dwordx4 v[48:51], v41, s[20:23], s6 offen
    buffer_store_dwordx4 v[48:51], v41, s[24:27], s7 offen
    buffer_store_dwordx4 v[52:55], v41, s[28:31], 0 offen
    v_lshrrev_b32 v1, 5, v0
    s_lshl_b32 s3, s2, 3
    v_add_u32 v1, s3, v1
    v_mul_u32_u24 v1, 1152, v1
    v_and_b32 v2, 31, v0
    v_lshl_add_u32 v1, v2, 2, v1
    buffer_load_dword v10, v1, s[8:11], 0 offen offset:0
    buffer_load_dword v11, v1, s[8:11], 0 offen offset:128
    buffer_load_dword v12, v1, s[8:11], 0 offen offset:256
    buffer_load_dword v13, v1, s[8:11], 0 offen offset:384
    buffer_load_dword v14, v1, s[8:11], 0 offen offset:512
    buffer_load_dword v15, v1, s[8:11], 0 offen offset:640
    buffer_load_dword v16, v1, s[8:11], 0 offen offset:768
    buffer_load_dword v17, v1, s[8:11], 0 offen offset:896
    buffer_load_dword v18, v1, s[8:11], 0 offen offset:1024
    s_waitcnt vmcnt(0)
    v_lshlrev_b32 v20, 16, v10
    v_and_b32 v21, 0xffff0000, v10
    v_lshlrev_b32 v22, 16, v11
    v_and_b32 v23, 0xffff0000, v11
    v_lshlrev_b32 v24, 16, v12
    v_and_b32 v25, 0xffff0000, v12
    v_lshlrev_b32 v26, 16, v13
    v_and_b32 v27, 0xffff0000, v13
    v_lshlrev_b32 v28, 16, v14
    v_and_b32 v29, 0xffff0000, v14
    v_lshlrev_b32 v30, 16, v15
    v_and_b32 v31, 0xffff0000, v15
    v_lshlrev_b32 v32, 16, v16
    v_and_b32 v33, 0xffff0000, v16
    v_lshlrev_b32 v34, 16, v17
    v_and_b32 v35, 0xffff0000, v17
    v_lshlrev_b32 v36, 16, v18
    v_and_b32 v37, 0xffff0000, v18
    v_add_f32 v3, v20, v21
    v_add_f32 v3, v3, v22
    v_add_f32 v3, v3, v23
    v_add_f32 v3, v3, v24
    v_add_f32 v3, v3, v25
    v_add_f32 v3, v3, v26
    v_add_f32 v3, v3, v27
    v_add_f32 v3, v3, v28
    v_add_f32 v3, v3, v29
    v_add_f32 v3, v3, v30
    v_add_f32 v3, v3, v31
    v_add_f32 v3, v3, v32
    v_add_f32 v3, v3, v33
    v_add_f32 v3, v3, v34
    v_add_f32 v3, v3, v35
    v_add_f32 v3, v3, v36
    v_add_f32 v3, v3, v37
    s_nop 1
    v_add_f32_dpp v3, v3, v3 row_ror:8 row_mask:0xf bank_mask:0xf
    s_nop 1
    v_add_f32_dpp v3, v3, v3 row_ror:4 row_mask:0xf bank_mask:0xf
    s_nop 1
    v_add_f32_dpp v3, v3, v3 row_ror:2 row_mask:0xf bank_mask:0xf
    s_nop 1
    v_add_f32_dpp v3, v3, v3 row_ror:1 row_mask:0xf bank_mask:0xf
    v_mov_b32 v4, v3
    s_nop 1
    v_permlane16_swap_b32 v3, v4
    s_nop 0
    v_add_f32 v3, v3, v4
    v_mul_f32 v3, 0x3ae38e39, v3
    v_sub_f32 v20, v20, v3
    v_sub_f32 v21, v21, v3
    v_sub_f32 v22, v22, v3
    v_sub_f32 v23, v23, v3
    v_sub_f32 v24, v24, v3
    v_sub_f32 v25, v25, v3
    v_sub_f32 v26, v26, v3
    v_sub_f32 v27, v27, v3
    v_sub_f32 v28, v28, v3
    v_sub_f32 v29, v29, v3
    v_sub_f32 v30, v30, v3
    v_sub_f32 v31, v31, v3
    v_sub_f32 v32, v32, v3
    v_sub_f32 v33, v33, v3
    v_sub_f32 v34, v34, v3
    v_sub_f32 v35, v35, v3
    v_sub_f32 v36, v36, v3
    v_sub_f32 v37, v37, v3
    v_mul_f32 v3, v20, v20
    v_fmac_f32 v3, v21, v21
    v_fmac_f32 v3, v22, v22
    v_fmac_f32 v3, v23, v23
    v_fmac_f32 v3, v24, v24
    v_fmac_f32 v3, v25, v25
    v_fmac_f32 v3, v26, v26
    v_fmac_f32 v3, v27, v27
    v_fmac_f32 v3, v28, v28
    v_fmac_f32 v3, v29, v29
    v_fmac_f32 v3, v30, v30
    v_fmac_f32 v3, v31, v31
    v_fmac_f32 v3, v32, v32
    v_fmac_f32 v3, v33, v33
    v_fmac_f32 v3, v34, v34
    v_fmac_f32 v3, v35, v35
    v_fmac_f32 v3, v36, v36
    v_fmac_f32 v3, v37, v37
    s_nop 1
    v_add_f32_dpp v3, v3, v3 row_ror:8 row_mask:0xf bank_mask:0xf
    s_nop 1
    v_add_f32_dpp v3, v3, v3 row_ror:4 row_mask:0xf bank_mask:0xf
    s_nop 1
    v_add_f32_dpp v3, v3, v3 row_ror:2 row_mask:0xf bank_mask:0xf
    s_nop 1
    v_add_f32_dpp v3, v3, v3 row_ror:1 row_mask:0xf bank_mask:0xf
    v_mov_b32 v4, v3
    s_nop 1
    v_permlane16_swap_b32 v3, v4
    s_nop 0
    v_add_f32 v3, v3, v4
    v_mul_f32 v3, 0x3ae38e39, v3
    v_add_f32 v4, 0x3727c5ac, v3
    v_rsq_f32 v4, v4
    s_nop 0
    v_mul_f32 v20, v20, v4
    v_mul_f32 v21, v21, v4
    v_mul_f32 v22, v22, v4
    v_mul_f32 v23, v23, v4
    v_mul_f32 v24, v24, v4
    v_mul_f32 v25, v25, v4
    v_mul_f32 v26, v26, v4
    v_mul_f32 v27, v27, v4
    v_mul_f32 v28, v28, v4
    v_mul_f32 v29, v29, v4
    v_mul_f32 v30, v30, v4
    v_mul_f32 v31, v31, v4
    v_mul_f32 v32, v32, v4
    v_mul_f32 v33, v33, v4
    v_mul_f32 v34, v34, v4
    v_mul_f32 v35, v35, v4
    v_mul_f32 v36, v36, v4
    v_mul_f32 v37, v37, v4
    v_cvt_pk_bf16_f32 v10, v20, v21
    buffer_store_dword v10, v1, s[16:19], 0 offen offset:0
    v_cvt_pk_bf16_f32 v11, v22, v23
    buffer_store_dword v11, v1, s[16:19], 0 offen offset:128
    v_cvt_pk_bf16_f32 v12, v24, v25
    buffer_store_dword v12, v1, s[16:19], 0 offen offset:256
    v_cvt_pk_bf16_f32 v13, v26, v27
    buffer_store_dword v13, v1, s[16:19], 0 offen offset:384
    v_cvt_pk_bf16_f32 v14, v28, v29
    buffer_store_dword v14, v1, s[16:19], 0 offen offset:512
    v_cvt_pk_bf16_f32 v15, v30, v31
    buffer_store_dword v15, v1, s[16:19], 0 offen offset:640
    v_cvt_pk_bf16_f32 v16, v32, v33
    buffer_store_dword v16, v1, s[16:19], 0 offen offset:768
    v_cvt_pk_bf16_f32 v17, v34, v35
    buffer_store_dword v17, v1, s[16:19], 0 offen offset:896
    v_cvt_pk_bf16_f32 v18, v36, v37
    buffer_store_dword v18, v1, s[16:19], 0 offen offset:1024
    v_lshrrev_b32 v42, 1, v41
    v_xor_b32 v42, v42, v41
    v_bfe_i32 v42, v42, 6, 1
    v_and_b32 v42, 0xc0, v42
    v_xor_b32 v42, v42, v41
    buffer_store_dwordx4 v[44:47], v42, s[32:35], 0 offen
    s_endpgm
.globl main_kernel
.p2align 8
.type main_kernel,@function
main_kernel:
    s_cmp_lt_u32 s2, 256
    s_cbranch_scc1 go_2
    s_endpgm
go_2:
    s_load_dwordx2 s[4:5], s[0:1], 112
    s_load_dwordx2 s[8:9], s[0:1], 16
    s_mov_b32 s10, 4718592
    s_mov_b32 s11, 0x00020000
    s_load_dwordx2 s[12:13], s[0:1], 24
    s_mov_b32 s14, 4718592
    s_mov_b32 s15, 0x00020000
    s_load_dwordx2 s[16:17], s[0:1], 32
    s_mov_b32 s18, 4718592
    s_mov_b32 s19, 0x00020000
    s_load_dwordx2 s[20:21], s[0:1], 40
    s_mov_b32 s22, 4718592
    s_mov_b32 s23, 0x00020000
    s_load_dwordx2 s[72:73], s[0:1], 104
    s_mov_b32 s74, 256
    s_mov_b32 s75, 0x00020000
    v_lshrrev_b32 v1, 6, v0
    s_nop 0
    v_readfirstlane_b32 s6, v1
    s_lshl_b32 s7, s6, 10
    s_waitcnt lgkmcnt(0)
    s_add_u32 s24, s4, 0
    s_addc_u32 s25, s5, 0
    s_mov_b32 s26, 2359296
    s_mov_b32 s27, 0x00020000
    s_add_u32 s28, s4, 3829760
    s_addc_u32 s29, s5, 0
    s_mov_b32 s30, 16777216
    s_mov_b32 s31, 0x00020000
    s_add_u32 s32, s4, 20606976
    s_addc_u32 s33, s5, 0
    s_mov_b32 s34, 16777216
    s_mov_b32 s35, 0x00020000
    s_add_u32 s36, s4, 37384192
    s_addc_u32 s37, s5, 0
    s_mov_b32 s38, 16777216
    s_mov_b32 s39, 0x00020000
    s_add_u32 s48, s4, 3567616
    s_addc_u32 s49, s5, 0
    s_mov_b32 s50, 262144
    s_mov_b32 s51, 0x00020000
    s_add_u32 s52, s4, 2359296
    s_addc_u32 s53, s5, 0
    s_mov_b32 s54, 1179648
    s_mov_b32 s55, 0x00020000
    s_add_u32 s56, s4, 3538944
    s_addc_u32 s57, s5, 0
    s_mov_b32 s58, 27648
    s_mov_b32 s59, 0x00020000
    s_add_u32 s60, s4, 54161408
    s_addc_u32 s61, s5, 0
    s_mov_b32 s62, 17825792
    s_mov_b32 s63, 0x00020000
    s_getreg_b32 s70, hwreg(HW_REG_XCC_ID, 0, 4)
    s_and_b32 s70, s70, 7
    s_cmp_lg_u32 s6, 0
    s_cbranch_scc1 role_wait
    s_lshl_b32 s71, s70, 2
    v_mov_b32 v2, s71
    v_mov_b32 v3, 1
    s_mov_b64 exec, 1
    buffer_atomic_add v3, v2, s[72:75], 0 offen sc0
    s_waitcnt vmcnt(0)
    s_mov_b64 exec, -1
    v_readfirstlane_b32 s71, v3
    s_lshl_b32 s77, s70, 5
    s_add_u32 s77, s77, s71
    s_cmp_ge_u32 s71, 32
    s_cselect_b32 s77, -1, s77
role_pub:
    v_mov_b32 v2, 0
    v_mov_b32 v3, s77
    ds_write_b32 v2, v3
    s_waitcnt lgkmcnt(0)
role_wait:
    s_barrier
    v_mov_b32 v2, 0
    ds_read_b32 v3, v2
    s_waitcnt lgkmcnt(0)
    v_readfirstlane_b32 s3, v3
    s_barrier
    s_cmp_eq_u32 s3, -1
    s_cbranch_scc0 role_ok
    s_endpgm
role_ok:
    s_cmp_ge_u32 s3, 224
    s_cbranch_scc1 is_chain
    v_lshlrev_b32 v3, 7, v0
    s_mov_b32 s79, s3
    s_mul_i32 s67, s3, 24576
    v_add_u32 v3, s67, v3
    buffer_load_dword v200, v3, s[20:23], 0 offen
    s_lshl_b32 s66, s6, 1
    v_and_b32 v2, 63, v0
    v_lshrrev_b32 v3, 3, v0
    v_bfe_u32 v4, v3, 1, 3
    v_and_b32 v5, 7, v0
    v_xor_b32 v4, v4, v5
    v_mul_u32_u24 v3, 1152, v3
    v_lshl_add_u32 v8, v4, 4, v3
    v_and_b32 v3, 15, v0
    v_bfe_u32 v4, v0, 4, 2
    v_bfe_u32 v5, v0, 1, 3
    v_xor_b32 v4, v4, v5
    v_lshlrev_b32 v3, 7, v3
    v_lshl_add_u32 v9, v4, 4, v3
    v_xor_b32 v10, 64, v9
    v_add_u32 v3, 0, v0
    v_lshrrev_b32 v4, 4, v3
    v_and_b32 v5, 15, v3
    v_bfe_u32 v6, v4, 3, 1
    v_and_b32 v7, 3, v4
    v_lshl_or_b32 v6, v6, 2, v7
    v_lshlrev_b32 v6, 1, v6
    v_xor_b32 v5, v5, v6
    v_mul_u32_u24 v4, 8192, v4
    v_lshl_add_u32 v11, v5, 4, v4
    v_add_u32 v3, 256, v0
    v_lshrrev_b32 v4, 4, v3
    v_and_b32 v5, 15, v3
    v_bfe_u32 v6, v4, 3, 1
    v_and_b32 v7, 3, v4
    v_lshl_or_b32 v6, v6, 2, v7
    v_lshlrev_b32 v6, 1, v6
    v_xor_b32 v5, v5, v6
    v_mul_u32_u24 v4, 8192, v4
    v_lshl_add_u32 v12, v5, 4, v4
    v_add_u32 v3, 512, v0
    v_lshrrev_b32 v4, 4, v3
    v_and_b32 v5, 15, v3
    v_bfe_u32 v6, v4, 3, 1
    v_and_b32 v7, 3, v4
    v_lshl_or_b32 v6, v6, 2, v7
    v_lshlrev_b32 v6, 1, v6
    v_xor_b32 v5, v5, v6
    v_mul_u32_u24 v4, 8192, v4
    v_lshl_add_u32 v13, v5, 4, v4
    v_add_u32 v3, 768, v0
    v_lshrrev_b32 v4, 4, v3
    v_and_b32 v5, 15, v3
    v_bfe_u32 v6, v4, 3, 1
    v_and_b32 v7, 3, v4
    v_lshl_or_b32 v6, v6, 2, v7
    v_lshlrev_b32 v6, 1, v6
    v_xor_b32 v5, v5, v6
    v_mul_u32_u24 v4, 8192, v4
    v_lshl_add_u32 v14, v5, 4, v4
    v_bfe_u32 v3, v0, 4, 2
    v_bfe_u32 v4, v0, 2, 2
    v_lshl_add_u32 v3, v3, 3, v4
    v_bfe_u32 v6, v3, 3, 1
    v_and_b32 v7, 3, v3
    v_lshl_or_b32 v6, v6, 2, v7
    v_mul_u32_u24 v3, 256, v3
    v_and_b32 v4, 3, v0
    v_lshl_add_u32 v3, v4, 3, v3
    v_mov_b32 v4, s66
    v_add_u32 v4, 0, v4
    v_xor_b32 v4, v4, v6
    v_lshl_add_u32 v15, v4, 5, v3
    v_mov_b32 v4, s66
    v_add_u32 v4, 1, v4
    v_xor_b32 v4, v4, v6
    v_lshl_add_u32 v16, v4, 5, v3
    v_and_b32 v30, 63, v0
    v_lshlrev_b32 v30, 4, v30
wk_task:
    s_and_b32 s71, s79, 7
    s_bfe_u32 s72, s79, 0x20005
    s_lshl_b32 s72, s72, 3
    s_add_u32 s71, s71, s72
    s_bfe_u32 s72, s79, 0x20003
    s_lshr_b32 s67, s79, 7
    s_lshl_b32 s67, s67, 2
    s_add_u32 s72, s72, s67
    s_mul_i32 s67, s72, 147456
    s_lshl_b32 s68, s71, 8
    s_mov_b32 s69, s68
    s_mov_b32 s70, s68
    v_accvgpr_write_b32 a0, 0
    v_accvgpr_write_b32 a1, 0
    v_accvgpr_write_b32 a2, 0
    v_accvgpr_write_b32 a3, 0
    v_accvgpr_write_b32 a4, 0
    v_accvgpr_write_b32 a5, 0
    v_accvgpr_write_b32 a6, 0
    v_accvgpr_write_b32 a7, 0
    v_accvgpr_write_b32 a8, 0
    v_accvgpr_write_b32 a9, 0
    v_accvgpr_write_b32 a10, 0
    v_accvgpr_write_b32 a11, 0
    v_accvgpr_write_b32 a12, 0
    v_accvgpr_write_b32 a13, 0
    v_accvgpr_write_b32 a14, 0
    v_accvgpr_write_b32 a15, 0
    v_accvgpr_write_b32 a16, 0
    v_accvgpr_write_b32 a17, 0
    v_accvgpr_write_b32 a18, 0
    v_accvgpr_write_b32 a19, 0
    v_accvgpr_write_b32 a20, 0
    v_accvgpr_write_b32 a21, 0
    v_accvgpr_write_b32 a22, 0
    v_accvgpr_write_b32 a23, 0
    v_accvgpr_write_b32 a24, 0
    v_accvgpr_write_b32 a25, 0
    v_accvgpr_write_b32 a26, 0
    v_accvgpr_write_b32 a27, 0
    v_accvgpr_write_b32 a28, 0
    v_accvgpr_write_b32 a29, 0
    v_accvgpr_write_b32 a30, 0
    v_accvgpr_write_b32 a31, 0
    v_accvgpr_write_b32 a32, 0
    v_accvgpr_write_b32 a33, 0
    v_accvgpr_write_b32 a34, 0
    v_accvgpr_write_b32 a35, 0
    v_accvgpr_write_b32 a36, 0
    v_accvgpr_write_b32 a37, 0
    v_accvgpr_write_b32 a38, 0
    v_accvgpr_write_b32 a39, 0
    v_accvgpr_write_b32 a40, 0
    v_accvgpr_write_b32 a41, 0
    v_accvgpr_write_b32 a42, 0
    v_accvgpr_write_b32 a43, 0
    v_accvgpr_write_b32 a44, 0
    v_accvgpr_write_b32 a45, 0
    v_accvgpr_write_b32 a46, 0
    v_accvgpr_write_b32 a47, 0
    v_accvgpr_write_b32 a48, 0
    v_accvgpr_write_b32 a49, 0
    v_accvgpr_write_b32 a50, 0
    v_accvgpr_write_b32 a51, 0
    v_accvgpr_write_b32 a52, 0
    v_accvgpr_write_b32 a53, 0
    v_accvgpr_write_b32 a54, 0
    v_accvgpr_write_b32 a55, 0
    v_accvgpr_write_b32 a56, 0
    v_accvgpr_write_b32 a57, 0
    v_accvgpr_write_b32 a58, 0
    v_accvgpr_write_b32 a59, 0
    v_accvgpr_write_b32 a60, 0
    v_accvgpr_write_b32 a61, 0
    v_accvgpr_write_b32 a62, 0
    v_accvgpr_write_b32 a63, 0
    v_accvgpr_write_b32 a64, 0
    v_accvgpr_write_b32 a65, 0
    v_accvgpr_write_b32 a66, 0
    v_accvgpr_write_b32 a67, 0
    v_accvgpr_write_b32 a68, 0
    v_accvgpr_write_b32 a69, 0
    v_accvgpr_write_b32 a70, 0
    v_accvgpr_write_b32 a71, 0
    v_accvgpr_write_b32 a72, 0
    v_accvgpr_write_b32 a73, 0
    v_accvgpr_write_b32 a74, 0
    v_accvgpr_write_b32 a75, 0
    v_accvgpr_write_b32 a76, 0
    v_accvgpr_write_b32 a77, 0
    v_accvgpr_write_b32 a78, 0
    v_accvgpr_write_b32 a79, 0
    v_accvgpr_write_b32 a80, 0
    v_accvgpr_write_b32 a81, 0
    v_accvgpr_write_b32 a82, 0
    v_accvgpr_write_b32 a83, 0
    v_accvgpr_write_b32 a84, 0
    v_accvgpr_write_b32 a85, 0
    v_accvgpr_write_b32 a86, 0
    v_accvgpr_write_b32 a87, 0
    v_accvgpr_write_b32 a88, 0
    v_accvgpr_write_b32 a89, 0
    v_accvgpr_write_b32 a90, 0
    v_accvgpr_write_b32 a91, 0
    v_accvgpr_write_b32 a92, 0
    v_accvgpr_write_b32 a93, 0
    v_accvgpr_write_b32 a94, 0
    v_accvgpr_write_b32 a95, 0
    v_accvgpr_write_b32 a96, 0
    v_accvgpr_write_b32 a97, 0
    v_accvgpr_write_b32 a98, 0
    v_accvgpr_write_b32 a99, 0
    v_accvgpr_write_b32 a100, 0
    v_accvgpr_write_b32 a101, 0
    v_accvgpr_write_b32 a102, 0
    v_accvgpr_write_b32 a103, 0
    v_accvgpr_write_b32 a104, 0
    v_accvgpr_write_b32 a105, 0
    v_accvgpr_write_b32 a106, 0
    v_accvgpr_write_b32 a107, 0
    v_accvgpr_write_b32 a108, 0
    v_accvgpr_write_b32 a109, 0
    v_accvgpr_write_b32 a110, 0
    v_accvgpr_write_b32 a111, 0
    v_accvgpr_write_b32 a112, 0
    v_accvgpr_write_b32 a113, 0
    v_accvgpr_write_b32 a114, 0
    v_accvgpr_write_b32 a115, 0
    v_accvgpr_write_b32 a116, 0
    v_accvgpr_write_b32 a117, 0
    v_accvgpr_write_b32 a118, 0
    v_accvgpr_write_b32 a119, 0
    v_accvgpr_write_b32 a120, 0
    v_accvgpr_write_b32 a121, 0
    v_accvgpr_write_b32 a122, 0
    v_accvgpr_write_b32 a123, 0
    v_accvgpr_write_b32 a124, 0
    v_accvgpr_write_b32 a125, 0
    v_accvgpr_write_b32 a126, 0
    v_accvgpr_write_b32 a127, 0
    v_accvgpr_write_b32 a128, 0
    v_accvgpr_write_b32 a129, 0
    v_accvgpr_write_b32 a130, 0
    v_accvgpr_write_b32 a131, 0
    v_accvgpr_write_b32 a132, 0
    v_accvgpr_write_b32 a133, 0
    v_accvgpr_write_b32 a134, 0
    v_accvgpr_write_b32 a135, 0
    v_accvgpr_write_b32 a136, 0
    v_accvgpr_write_b32 a137, 0
    v_accvgpr_write_b32 a138, 0
    v_accvgpr_write_b32 a139, 0
    v_accvgpr_write_b32 a140, 0
    v_accvgpr_write_b32 a141, 0
    v_accvgpr_write_b32 a142, 0
    v_accvgpr_write_b32 a143, 0
    v_accvgpr_write_b32 a144, 0
    v_accvgpr_write_b32 a145, 0
    v_accvgpr_write_b32 a146, 0
    v_accvgpr_write_b32 a147, 0
    v_accvgpr_write_b32 a148, 0
    v_accvgpr_write_b32 a149, 0
    v_accvgpr_write_b32 a150, 0
    v_accvgpr_write_b32 a151, 0
    v_accvgpr_write_b32 a152, 0
    v_accvgpr_write_b32 a153, 0
    v_accvgpr_write_b32 a154, 0
    v_accvgpr_write_b32 a155, 0
    v_accvgpr_write_b32 a156, 0
    v_accvgpr_write_b32 a157, 0
    v_accvgpr_write_b32 a158, 0
    v_accvgpr_write_b32 a159, 0
    v_accvgpr_write_b32 a160, 0
    v_accvgpr_write_b32 a161, 0
    v_accvgpr_write_b32 a162, 0
    v_accvgpr_write_b32 a163, 0
    v_accvgpr_write_b32 a164, 0
    v_accvgpr_write_b32 a165, 0
    v_accvgpr_write_b32 a166, 0
    v_accvgpr_write_b32 a167, 0
    v_accvgpr_write_b32 a168, 0
    v_accvgpr_write_b32 a169, 0
    v_accvgpr_write_b32 a170, 0
    v_accvgpr_write_b32 a171, 0
    v_accvgpr_write_b32 a172, 0
    v_accvgpr_write_b32 a173, 0
    v_accvgpr_write_b32 a174, 0
    v_accvgpr_write_b32 a175, 0
    v_accvgpr_write_b32 a176, 0
    v_accvgpr_write_b32 a177, 0
    v_accvgpr_write_b32 a178, 0
    v_accvgpr_write_b32 a179, 0
    v_accvgpr_write_b32 a180, 0
    v_accvgpr_write_b32 a181, 0
    v_accvgpr_write_b32 a182, 0
    v_accvgpr_write_b32 a183, 0
    v_accvgpr_write_b32 a184, 0
    v_accvgpr_write_b32 a185, 0
    v_accvgpr_write_b32 a186, 0
    v_accvgpr_write_b32 a187, 0
    v_accvgpr_write_b32 a188, 0
    v_accvgpr_write_b32 a189, 0
    v_accvgpr_write_b32 a190, 0
    v_accvgpr_write_b32 a191, 0
    s_add_u32 m0, s7, 0
    s_add_u32 s73, s67, 0
    buffer_load_dwordx4 v8, s[24:27], s73 offen  lds
    s_add_u32 m0, s7, 4096
    s_add_u32 s73, s67, 36864
    buffer_load_dwordx4 v8, s[24:27], s73 offen  lds
    s_add_u32 m0, s7, 8192
    s_add_u32 s73, s67, 73728
    buffer_load_dwordx4 v8, s[24:27], s73 offen  lds
    s_add_u32 m0, s7, 12288
    s_add_u32 s73, s67, 110592
    buffer_load_dwordx4 v8, s[24:27], s73 offen  lds
    s_add_u32 s67, s67, 128
    s_add_u32 m0, s7, 16384
    s_nop 0
    buffer_load_dwordx4 v11, s[8:11], s68 offen  lds
    s_add_u32 m0, s7, 20480
    s_nop 0
    buffer_load_dwordx4 v12, s[8:11], s68 offen  lds
    s_add_u32 m0, s7, 24576
    s_nop 0
    buffer_load_dwordx4 v13, s[8:11], s68 offen  lds
    s_add_u32 m0, s7, 28672
    s_nop 0
    buffer_load_dwordx4 v14, s[8:11], s68 offen  lds
    s_add_u32 s68, s68, 524288
    s_add_u32 m0, s7, 32768
    s_nop 0
    buffer_load_dwordx4 v11, s[12:15], s69 offen  lds
    s_add_u32 m0, s7, 36864
    s_nop 0
    buffer_load_dwordx4 v12, s[12:15], s69 offen  lds
    s_add_u32 m0, s7, 40960
    s_nop 0
    buffer_load_dwordx4 v13, s[12:15], s69 offen  lds
    s_add_u32 m0, s7, 45056
    s_nop 0
    buffer_load_dwordx4 v14, s[12:15], s69 offen  lds
    s_add_u32 s69, s69, 524288
    s_add_u32 m0, s7, 49152
    s_nop 0
    buffer_load_dwordx4 v11, s[16:19], s70 offen  lds
    s_add_u32 m0, s7, 53248
    s_nop 0
    buffer_load_dwordx4 v12, s[16:19], s70 offen  lds
    s_add_u32 m0, s7, 57344
    s_nop 0
    buffer_load_dwordx4 v13, s[16:19], s70 offen  lds
    s_add_u32 m0, s7, 61440
    s_nop 0
    buffer_load_dwordx4 v14, s[16:19], s70 offen  lds
    s_add_u32 s70, s70, 524288
    s_mov_b32 s74, 4
kl_3:
    s_waitcnt vmcnt(0)
    s_barrier
    ds_read_b64_tr_b16 v[32:33], v15 offset:16384
    ds_read_b64_tr_b16 v[34:35], v15 offset:17408
    ds_read_b128 v[36:39], v9 offset:0
    ds_read_b64_tr_b16 v[40:41], v16 offset:16384
    ds_read_b64_tr_b16 v[42:43], v16 offset:17408
    ds_read_b64_tr_b16 v[44:45], v15 offset:32768
    ds_read_b64_tr_b16 v[46:47], v15 offset:33792
    ds_read_b64_tr_b16 v[48:49], v16 offset:32768
    ds_read_b64_tr_b16 v[50:51], v16 offset:33792
    ds_read_b64_tr_b16 v[52:53], v15 offset:49152
    ds_read_b64_tr_b16 v[54:55], v15 offset:50176
    s_waitcnt lgkmcnt(8)
    v_mfma_f32_16x16x32_bf16 a[0:3], v[32:35], v[36:39], a[0:3]
    ds_read_b64_tr_b16 v[56:57], v16 offset:49152
    ds_read_b64_tr_b16 v[58:59], v16 offset:50176
    s_add_u32 m0, s7, 65536
    s_add_u32 s73, s67, 0
    buffer_load_dwordx4 v8, s[24:27], s73 offen  lds
    s_waitcnt lgkmcnt(8)
    v_mfma_f32_16x16x32_bf16 a[32:35], v[40:43], v[36:39], a[32:35]
    ds_read_b128 v[60:63], v9 offset:2048
    s_waitcnt lgkmcnt(7)
    v_mfma_f32_16x16x32_bf16 a[64:67], v[44:47], v[36:39], a[64:67]
    ds_read_b128 v[64:67], v9 offset:4096
    s_waitcnt lgkmcnt(6)
    v_mfma_f32_16x16x32_bf16 a[96:99], v[48:51], v[36:39], a[96:99]
    ds_read_b128 v[68:71], v9 offset:6144
    s_waitcnt lgkmcnt(5)
    v_mfma_f32_16x16x32_bf16 a[128:131], v[36:39], v[52:55], a[128:131]
    ds_read_b128 v[72:75], v9 offset:8192
    s_add_u32 m0, s7, 69632
    s_add_u32 s73, s67, 36864
    buffer_load_dwordx4 v8, s[24:27], s73 offen  lds
    s_waitcnt lgkmcnt(4)
    v_mfma_f32_16x16x32_bf16 a[160:163], v[36:39], v[56:59], a[160:163]
    ds_read_b128 v[76:79], v9 offset:10240
    s_waitcnt lgkmcnt(4)
    v_mfma_f32_16x16x32_bf16 a[4:7], v[32:35], v[60:63], a[4:7]
    ds_read_b128 v[80:83], v9 offset:12288
    v_mfma_f32_16x16x32_bf16 a[36:39], v[40:43], v[60:63], a[36:39]
    ds_read_b128 v[84:87], v9 offset:14336
    v_mfma_f32_16x16x32_bf16 a[68:71], v[44:47], v[60:63], a[68:71]
    ds_read_b64_tr_b16 v[88:89], v15 offset:24576
    ds_read_b64_tr_b16 v[90:91], v15 offset:25600
    s_add_u32 m0, s7, 73728
    s_add_u32 s73, s67, 73728
    buffer_load_dwordx4 v8, s[24:27], s73 offen  lds
    v_mfma_f32_16x16x32_bf16 a[100:103], v[48:51], v[60:63], a[100:103]
    ds_read_b128 v[92:95], v10 offset:0
    v_mfma_f32_16x16x32_bf16 a[132:135], v[60:63], v[52:55], a[132:135]
    ds_read_b64_tr_b16 v[96:97], v16 offset:24576
    ds_read_b64_tr_b16 v[98:99], v16 offset:25600
    v_mfma_f32_16x16x32_bf16 a[164:167], v[60:63], v[56:59], a[164:167]
    ds_read_b64_tr_b16 v[100:101], v15 offset:40960
    ds_read_b64_tr_b16 v[102:103], v15 offset:41984
    s_waitcnt lgkmcnt(12)
    v_mfma_f32_16x16x32_bf16 a[8:11], v[32:35], v[64:67], a[8:11]
    ds_read_b64_tr_b16 v[36:37], v16 offset:40960
    ds_read_b64_tr_b16 v[38:39], v16 offset:41984
    s_add_u32 m0, s7, 77824
    s_add_u32 s73, s67, 110592
    buffer_load_dwordx4 v8, s[24:27], s73 offen  lds
    v_mfma_f32_16x16x32_bf16 a[40:43], v[40:43], v[64:67], a[40:43]
    ds_read_b64_tr_b16 v[60:61], v15 offset:57344
    ds_read_b64_tr_b16 v[62:63], v15 offset:58368
    v_mfma_f32_16x16x32_bf16 a[72:75], v[44:47], v[64:67], a[72:75]
    v_mfma_f32_16x16x32_bf16 a[104:107], v[48:51], v[64:67], a[104:107]
    v_mfma_f32_16x16x32_bf16 a[136:139], v[64:67], v[52:55], a[136:139]
    s_add_u32 s67, s67, 128
    s_add_u32 m0, s7, 81920
    s_nop 0
    buffer_load_dwordx4 v11, s[8:11], s68 offen  lds
    v_mfma_f32_16x16x32_bf16 a[168:171], v[64:67], v[56:59], a[168:171]
    ds_read_b64_tr_b16 v[64:65], v16 offset:57344
    ds_read_b64_tr_b16 v[66:67], v16 offset:58368
    s_waitcnt lgkmcnt(15)
    v_mfma_f32_16x16x32_bf16 a[12:15], v[32:35], v[68:71], a[12:15]
    v_mfma_f32_16x16x32_bf16 a[44:47], v[40:43], v[68:71], a[44:47]
    v_mfma_f32_16x16x32_bf16 a[76:79], v[44:47], v[68:71], a[76:79]
    s_add_u32 m0, s7, 86016
    s_nop 0
    buffer_load_dwordx4 v12, s[8:11], s68 offen  lds
    v_mfma_f32_16x16x32_bf16 a[108:111], v[48:51], v[68:71], a[108:111]
    v_mfma_f32_16x16x32_bf16 a[140:143], v[68:71], v[52:55], a[140:143]
    v_mfma_f32_16x16x32_bf16 a[172:175], v[68:71], v[56:59], a[172:175]
    ds_read_b128 v[68:71], v10 offset:2048
    v_mfma_f32_16x16x32_bf16 a[16:19], v[32:35], v[72:75], a[16:19]
    s_add_u32 m0, s7, 90112
    s_nop 0
    buffer_load_dwordx4 v13, s[8:11], s68 offen  lds
    v_mfma_f32_16x16x32_bf16 a[48:51], v[40:43], v[72:75], a[48:51]
    v_mfma_f32_16x16x32_bf16 a[80:83], v[44:47], v[72:75], a[80:83]
    v_mfma_f32_16x16x32_bf16 a[112:115], v[48:51], v[72:75], a[112:115]
    v_mfma_f32_16x16x32_bf16 a[144:147], v[72:75], v[52:55], a[144:147]
    s_add_u32 m0, s7, 94208
    s_nop 0
    buffer_load_dwordx4 v14, s[8:11], s68 offen  lds
    v_mfma_f32_16x16x32_bf16 a[176:179], v[72:75], v[56:59], a[176:179]
    ds_read_b128 v[72:75], v10 offset:4096
    v_mfma_f32_16x16x32_bf16 a[20:23], v[32:35], v[76:79], a[20:23]
    v_mfma_f32_16x16x32_bf16 a[52:55], v[40:43], v[76:79], a[52:55]
    v_mfma_f32_16x16x32_bf16 a[84:87], v[44:47], v[76:79], a[84:87]
    s_add_u32 s68, s68, 524288
    s_add_u32 m0, s7, 98304
    s_nop 0
    buffer_load_dwordx4 v11, s[12:15], s69 offen  lds
    v_mfma_f32_16x16x32_bf16 a[116:119], v[48:51], v[76:79], a[116:119]
    v_mfma_f32_16x16x32_bf16 a[148:151], v[76:79], v[52:55], a[148:151]
    v_mfma_f32_16x16x32_bf16 a[180:183], v[76:79], v[56:59], a[180:183]
    ds_read_b128 v[76:79], v10 offset:6144
    s_waitcnt lgkmcnt(15)
    v_mfma_f32_16x16x32_bf16 a[24:27], v[32:35], v[80:83], a[24:27]
    s_add_u32 m0, s7, 102400
    s_nop 0
    buffer_load_dwordx4 v12, s[12:15], s69 offen  lds
    v_mfma_f32_16x16x32_bf16 a[56:59], v[40:43], v[80:83], a[56:59]
    v_mfma_f32_16x16x32_bf16 a[88:91], v[44:47], v[80:83], a[88:91]
    v_mfma_f32_16x16x32_bf16 a[120:123], v[48:51], v[80:83], a[120:123]
    v_mfma_f32_16x16x32_bf16 a[152:155], v[80:83], v[52:55], a[152:155]
    s_add_u32 m0, s7, 106496
    s_nop 0
    buffer_load_dwordx4 v13, s[12:15], s69 offen  lds
    v_mfma_f32_16x16x32_bf16 a[184:187], v[80:83], v[56:59], a[184:187]
    ds_read_b128 v[80:83], v10 offset:8192
    v_mfma_f32_16x16x32_bf16 a[28:31], v[32:35], v[84:87], a[28:31]
    ds_read_b128 v[32:35], v10 offset:10240
    v_mfma_f32_16x16x32_bf16 a[60:63], v[40:43], v[84:87], a[60:63]
    ds_read_b128 v[40:43], v10 offset:12288
    v_mfma_f32_16x16x32_bf16 a[92:95], v[44:47], v[84:87], a[92:95]
    ds_read_b128 v[44:47], v10 offset:14336
    s_add_u32 m0, s7, 110592
    s_nop 0
    buffer_load_dwordx4 v14, s[12:15], s69 offen  lds
    v_mfma_f32_16x16x32_bf16 a[124:127], v[48:51], v[84:87], a[124:127]
    v_mfma_f32_16x16x32_bf16 a[156:159], v[84:87], v[52:55], a[156:159]
    v_mfma_f32_16x16x32_bf16 a[188:191], v[84:87], v[56:59], a[188:191]
    s_waitcnt lgkmcnt(15)
    v_mfma_f32_16x16x32_bf16 a[0:3], v[88:91], v[92:95], a[0:3]
    s_add_u32 s69, s69, 524288
    s_add_u32 m0, s7, 114688
    s_nop 0
    buffer_load_dwordx4 v11, s[16:19], s70 offen  lds
    v_mfma_f32_16x16x32_bf16 a[32:35], v[96:99], v[92:95], a[32:35]
    s_waitcnt lgkmcnt(13)
    v_mfma_f32_16x16x32_bf16 a[64:67], v[100:103], v[92:95], a[64:67]
    s_waitcnt lgkmcnt(11)
    v_mfma_f32_16x16x32_bf16 a[96:99], v[36:39], v[92:95], a[96:99]
    s_waitcnt lgkmcnt(9)
    v_mfma_f32_16x16x32_bf16 a[128:131], v[92:95], v[60:63], a[128:131]
    s_add_u32 m0, s7, 118784
    s_nop 0
    buffer_load_dwordx4 v12, s[16:19], s70 offen  lds
    s_waitcnt lgkmcnt(7)
    v_mfma_f32_16x16x32_bf16 a[160:163], v[92:95], v[64:67], a[160:163]
    s_waitcnt lgkmcnt(6)
    v_mfma_f32_16x16x32_bf16 a[4:7], v[88:91], v[68:71], a[4:7]
    v_mfma_f32_16x16x32_bf16 a[36:39], v[96:99], v[68:71], a[36:39]
    v_mfma_f32_16x16x32_bf16 a[68:71], v[100:103], v[68:71], a[68:71]
    s_add_u32 m0, s7, 122880
    s_nop 0
    buffer_load_dwordx4 v13, s[16:19], s70 offen  lds
    v_mfma_f32_16x16x32_bf16 a[100:103], v[36:39], v[68:71], a[100:103]
    v_mfma_f32_16x16x32_bf16 a[132:135], v[68:71], v[60:63], a[132:135]
    v_mfma_f32_16x16x32_bf16 a[164:167], v[68:71], v[64:67], a[164:167]
    s_waitcnt lgkmcnt(5)
    v_mfma_f32_16x16x32_bf16 a[8:11], v[88:91], v[72:75], a[8:11]
    s_add_u32 m0, s7, 126976
    s_nop 0
    buffer_load_dwordx4 v14, s[16:19], s70 offen  lds
    s_add_u32 s70, s70, 524288
    v_mfma_f32_16x16x32_bf16 a[40:43], v[96:99], v[72:75], a[40:43]
    v_mfma_f32_16x16x32_bf16 a[72:75], v[100:103], v[72:75], a[72:75]
    v_mfma_f32_16x16x32_bf16 a[104:107], v[36:39], v[72:75], a[104:107]
    v_mfma_f32_16x16x32_bf16 a[136:139], v[72:75], v[60:63], a[136:139]
    v_mfma_f32_16x16x32_bf16 a[168:171], v[72:75], v[64:67], a[168:171]
    s_waitcnt lgkmcnt(4)
    v_mfma_f32_16x16x32_bf16 a[12:15], v[88:91], v[76:79], a[12:15]
    v_mfma_f32_16x16x32_bf16 a[44:47], v[96:99], v[76:79], a[44:47]
    v_mfma_f32_16x16x32_bf16 a[76:79], v[100:103], v[76:79], a[76:79]
    v_mfma_f32_16x16x32_bf16 a[108:111], v[36:39], v[76:79], a[108:111]
    v_mfma_f32_16x16x32_bf16 a[140:143], v[76:79], v[60:63], a[140:143]
    v_mfma_f32_16x16x32_bf16 a[172:175], v[76:79], v[64:67], a[172:175]
    s_waitcnt lgkmcnt(3)
    v_mfma_f32_16x16x32_bf16 a[16:19], v[88:91], v[80:83], a[16:19]
    v_mfma_f32_16x16x32_bf16 a[48:51], v[96:99], v[80:83], a[48:51]
    v_mfma_f32_16x16x32_bf16 a[80:83], v[100:103], v[80:83], a[80:83]
    v_mfma_f32_16x16x32_bf16 a[112:115], v[36:39], v[80:83], a[112:115]
    v_mfma_f32_16x16x32_bf16 a[144:147], v[80:83], v[60:63], a[144:147]
    v_mfma_f32_16x16x32_bf16 a[176:179], v[80:83], v[64:67], a[176:179]
    s_waitcnt lgkmcnt(2)
    v_mfma_f32_16x16x32_bf16 a[20:23], v[88:91], v[32:35], a[20:23]
    v_mfma_f32_16x16x32_bf16 a[52:55], v[96:99], v[32:35], a[52:55]
    v_mfma_f32_16x16x32_bf16 a[84:87], v[100:103], v[32:35], a[84:87]
    v_mfma_f32_16x16x32_bf16 a[116:119], v[36:39], v[32:35], a[116:119]
    v_mfma_f32_16x16x32_bf16 a[148:151], v[32:35], v[60:63], a[148:151]
    v_mfma_f32_16x16x32_bf16 a[180:183], v[32:35], v[64:67], a[180:183]
    s_waitcnt lgkmcnt(1)
    v_mfma_f32_16x16x32_bf16 a[24:27], v[88:91], v[40:43], a[24:27]
    v_mfma_f32_16x16x32_bf16 a[56:59], v[96:99], v[40:43], a[56:59]
    v_mfma_f32_16x16x32_bf16 a[88:91], v[100:103], v[40:43], a[88:91]
    v_mfma_f32_16x16x32_bf16 a[120:123], v[36:39], v[40:43], a[120:123]
    v_mfma_f32_16x16x32_bf16 a[152:155], v[40:43], v[60:63], a[152:155]
    v_mfma_f32_16x16x32_bf16 a[184:187], v[40:43], v[64:67], a[184:187]
    s_waitcnt lgkmcnt(0)
    v_mfma_f32_16x16x32_bf16 a[28:31], v[88:91], v[44:47], a[28:31]
    v_mfma_f32_16x16x32_bf16 a[60:63], v[96:99], v[44:47], a[60:63]
    v_mfma_f32_16x16x32_bf16 a[92:95], v[100:103], v[44:47], a[92:95]
    v_mfma_f32_16x16x32_bf16 a[124:127], v[36:39], v[44:47], a[124:127]
    v_mfma_f32_16x16x32_bf16 a[156:159], v[44:47], v[60:63], a[156:159]
    v_mfma_f32_16x16x32_bf16 a[188:191], v[44:47], v[64:67], a[188:191]
    v_add_u32 v9, 0x10000, v9
    v_add_u32 v10, 0x10000, v10
    v_add_u32 v15, 0x10000, v15
    v_add_u32 v16, 0x10000, v16
    s_waitcnt vmcnt(0)
    s_barrier
    ds_read_b64_tr_b16 v[32:33], v15 offset:16384
    ds_read_b64_tr_b16 v[34:35], v15 offset:17408
    ds_read_b128 v[36:39], v9 offset:0
    ds_read_b64_tr_b16 v[40:41], v16 offset:16384
    ds_read_b64_tr_b16 v[42:43], v16 offset:17408
    ds_read_b64_tr_b16 v[44:45], v15 offset:32768
    ds_read_b64_tr_b16 v[46:47], v15 offset:33792
    ds_read_b64_tr_b16 v[48:49], v16 offset:32768
    ds_read_b64_tr_b16 v[50:51], v16 offset:33792
    ds_read_b64_tr_b16 v[52:53], v15 offset:49152
    ds_read_b64_tr_b16 v[54:55], v15 offset:50176
    s_waitcnt lgkmcnt(8)
    v_mfma_f32_16x16x32_bf16 a[0:3], v[32:35], v[36:39], a[0:3]
    ds_read_b64_tr_b16 v[56:57], v16 offset:49152
    ds_read_b64_tr_b16 v[58:59], v16 offset:50176
    s_add_u32 m0, s7, 0
    s_add_u32 s73, s67, 0
    buffer_load_dwordx4 v8, s[24:27], s73 offen  lds
    s_waitcnt lgkmcnt(8)
    v_mfma_f32_16x16x32_bf16 a[32:35], v[40:43], v[36:39], a[32:35]
    ds_read_b128 v[60:63], v9 offset:2048
    s_waitcnt lgkmcnt(7)
    v_mfma_f32_16x16x32_bf16 a[64:67], v[44:47], v[36:39], a[64:67]
    ds_read_b128 v[64:67], v9 offset:4096
    s_waitcnt lgkmcnt(6)
    v_mfma_f32_16x16x32_bf16 a[96:99], v[48:51], v[36:39], a[96:99]
    ds_read_b128 v[68:71], v9 offset:6144
    s_waitcnt lgkmcnt(5)
    v_mfma_f32_16x16x32_bf16 a[128:131], v[36:39], v[52:55], a[128:131]
    ds_read_b128 v[72:75], v9 offset:8192
    s_add_u32 m0, s7, 4096
    s_add_u32 s73, s67, 36864
    buffer_load_dwordx4 v8, s[24:27], s73 offen  lds
    s_waitcnt lgkmcnt(4)
    v_mfma_f32_16x16x32_bf16 a[160:163], v[36:39], v[56:59], a[160:163]
    ds_read_b128 v[76:79], v9 offset:10240
    s_waitcnt lgkmcnt(4)
    v_mfma_f32_16x16x32_bf16 a[4:7], v[32:35], v[60:63], a[4:7]
    ds_read_b128 v[80:83], v9 offset:12288
    v_mfma_f32_16x16x32_bf16 a[36:39], v[40:43], v[60:63], a[36:39]
    ds_read_b128 v[84:87], v9 offset:14336
    v_mfma_f32_16x16x32_bf16 a[68:71], v[44:47], v[60:63], a[68:71]
    ds_read_b64_tr_b16 v[88:89], v15 offset:24576
    ds_read_b64_tr_b16 v[90:91], v15 offset:25600
    s_add_u32 m0, s7, 8192
    s_add_u32 s73, s67, 73728
    buffer_load_dwordx4 v8, s[24:27], s73 offen  lds
    v_mfma_f32_16x16x32_bf16 a[100:103], v[48:51], v[60:63], a[100:103]
    ds_read_b128 v[92:95], v10 offset:0
    v_mfma_f32_16x16x32_bf16 a[132:135], v[60:63], v[52:55], a[132:135]
    ds_read_b64_tr_b16 v[96:97], v16 offset:24576
    ds_read_b64_tr_b16 v[98:99], v16 offset:25600
    v_mfma_f32_16x16x32_bf16 a[164:167], v[60:63], v[56:59], a[164:167]
    ds_read_b64_tr_b16 v[100:101], v15 offset:40960
    ds_read_b64_tr_b16 v[102:103], v15 offset:41984
    s_waitcnt lgkmcnt(12)
    v_mfma_f32_16x16x32_bf16 a[8:11], v[32:35], v[64:67], a[8:11]
    ds_read_b64_tr_b16 v[36:37], v16 offset:40960
    ds_read_b64_tr_b16 v[38:39], v16 offset:41984
    s_add_u32 m0, s7, 12288
    s_add_u32 s73, s67, 110592
    buffer_load_dwordx4 v8, s[24:27], s73 offen  lds
    v_mfma_f32_16x16x32_bf16 a[40:43], v[40:43], v[64:67], a[40:43]
    ds_read_b64_tr_b16 v[60:61], v15 offset:57344
    ds_read_b64_tr_b16 v[62:63], v15 offset:58368
    v_mfma_f32_16x16x32_bf16 a[72:75], v[44:47], v[64:67], a[72:75]
    v_mfma_f32_16x16x32_bf16 a[104:107], v[48:51], v[64:67], a[104:107]
    v_mfma_f32_16x16x32_bf16 a[136:139], v[64:67], v[52:55], a[136:139]
    s_add_u32 s67, s67, 128
    s_add_u32 m0, s7, 16384
    s_nop 0
    buffer_load_dwordx4 v11, s[8:11], s68 offen  lds
    v_mfma_f32_16x16x32_bf16 a[168:171], v[64:67], v[56:59], a[168:171]
    ds_read_b64_tr_b16 v[64:65], v16 offset:57344
    ds_read_b64_tr_b16 v[66:67], v16 offset:58368
    s_waitcnt lgkmcnt(15)
    v_mfma_f32_16x16x32_bf16 a[12:15], v[32:35], v[68:71], a[12:15]
    v_mfma_f32_16x16x32_bf16 a[44:47], v[40:43], v[68:71], a[44:47]
    v_mfma_f32_16x16x32_bf16 a[76:79], v[44:47], v[68:71], a[76:79]
    s_add_u32 m0, s7, 20480
    s_nop 0
    buffer_load_dwordx4 v12, s[8:11], s68 offen  lds
    v_mfma_f32_16x16x32_bf16 a[108:111], v[48:51], v[68:71], a[108:111]
    v_mfma_f32_16x16x32_bf16 a[140:143], v[68:71], v[52:55], a[140:143]
    v_mfma_f32_16x16x32_bf16 a[172:175], v[68:71], v[56:59], a[172:175]
    ds_read_b128 v[68:71], v10 offset:2048
    v_mfma_f32_16x16x32_bf16 a[16:19], v[32:35], v[72:75], a[16:19]
    s_add_u32 m0, s7, 24576
    s_nop 0
    buffer_load_dwordx4 v13, s[8:11], s68 offen  lds
    v_mfma_f32_16x16x32_bf16 a[48:51], v[40:43], v[72:75], a[48:51]
    v_mfma_f32_16x16x32_bf16 a[80:83], v[44:47], v[72:75], a[80:83]
    v_mfma_f32_16x16x32_bf16 a[112:115], v[48:51], v[72:75], a[112:115]
    v_mfma_f32_16x16x32_bf16 a[144:147], v[72:75], v[52:55], a[144:147]
    s_add_u32 m0, s7, 28672
    s_nop 0
    buffer_load_dwordx4 v14, s[8:11], s68 offen  lds
    v_mfma_f32_16x16x32_bf16 a[176:179], v[72:75], v[56:59], a[176:179]
    ds_read_b128 v[72:75], v10 offset:4096
    v_mfma_f32_16x16x32_bf16 a[20:23], v[32:35], v[76:79], a[20:23]
    v_mfma_f32_16x16x32_bf16 a[52:55], v[40:43], v[76:79], a[52:55]
    v_mfma_f32_16x16x32_bf16 a[84:87], v[44:47], v[76:79], a[84:87]
    s_add_u32 s68, s68, 524288
    s_add_u32 m0, s7, 32768
    s_nop 0
    buffer_load_dwordx4 v11, s[12:15], s69 offen  lds
    v_mfma_f32_16x16x32_bf16 a[116:119], v[48:51], v[76:79], a[116:119]
    v_mfma_f32_16x16x32_bf16 a[148:151], v[76:79], v[52:55], a[148:151]
    v_mfma_f32_16x16x32_bf16 a[180:183], v[76:79], v[56:59], a[180:183]
    ds_read_b128 v[76:79], v10 offset:6144
    s_waitcnt lgkmcnt(15)
    v_mfma_f32_16x16x32_bf16 a[24:27], v[32:35], v[80:83], a[24:27]
    s_add_u32 m0, s7, 36864
    s_nop 0
    buffer_load_dwordx4 v12, s[12:15], s69 offen  lds
    v_mfma_f32_16x16x32_bf16 a[56:59], v[40:43], v[80:83], a[56:59]
    v_mfma_f32_16x16x32_bf16 a[88:91], v[44:47], v[80:83], a[88:91]
    v_mfma_f32_16x16x32_bf16 a[120:123], v[48:51], v[80:83], a[120:123]
    v_mfma_f32_16x16x32_bf16 a[152:155], v[80:83], v[52:55], a[152:155]
    s_add_u32 m0, s7, 40960
    s_nop 0
    buffer_load_dwordx4 v13, s[12:15], s69 offen  lds
    v_mfma_f32_16x16x32_bf16 a[184:187], v[80:83], v[56:59], a[184:187]
    ds_read_b128 v[80:83], v10 offset:8192
    v_mfma_f32_16x16x32_bf16 a[28:31], v[32:35], v[84:87], a[28:31]
    ds_read_b128 v[32:35], v10 offset:10240
    v_mfma_f32_16x16x32_bf16 a[60:63], v[40:43], v[84:87], a[60:63]
    ds_read_b128 v[40:43], v10 offset:12288
    v_mfma_f32_16x16x32_bf16 a[92:95], v[44:47], v[84:87], a[92:95]
    ds_read_b128 v[44:47], v10 offset:14336
    s_add_u32 m0, s7, 45056
    s_nop 0
    buffer_load_dwordx4 v14, s[12:15], s69 offen  lds
    v_mfma_f32_16x16x32_bf16 a[124:127], v[48:51], v[84:87], a[124:127]
    v_mfma_f32_16x16x32_bf16 a[156:159], v[84:87], v[52:55], a[156:159]
    v_mfma_f32_16x16x32_bf16 a[188:191], v[84:87], v[56:59], a[188:191]
    s_waitcnt lgkmcnt(15)
    v_mfma_f32_16x16x32_bf16 a[0:3], v[88:91], v[92:95], a[0:3]
    s_add_u32 s69, s69, 524288
    s_add_u32 m0, s7, 49152
    s_nop 0
    buffer_load_dwordx4 v11, s[16:19], s70 offen  lds
    v_mfma_f32_16x16x32_bf16 a[32:35], v[96:99], v[92:95], a[32:35]
    s_waitcnt lgkmcnt(13)
    v_mfma_f32_16x16x32_bf16 a[64:67], v[100:103], v[92:95], a[64:67]
    s_waitcnt lgkmcnt(11)
    v_mfma_f32_16x16x32_bf16 a[96:99], v[36:39], v[92:95], a[96:99]
    s_waitcnt lgkmcnt(9)
    v_mfma_f32_16x16x32_bf16 a[128:131], v[92:95], v[60:63], a[128:131]
    s_add_u32 m0, s7, 53248
    s_nop 0
    buffer_load_dwordx4 v12, s[16:19], s70 offen  lds
    s_waitcnt lgkmcnt(7)
    v_mfma_f32_16x16x32_bf16 a[160:163], v[92:95], v[64:67], a[160:163]
    s_waitcnt lgkmcnt(6)
    v_mfma_f32_16x16x32_bf16 a[4:7], v[88:91], v[68:71], a[4:7]
    v_mfma_f32_16x16x32_bf16 a[36:39], v[96:99], v[68:71], a[36:39]
    v_mfma_f32_16x16x32_bf16 a[68:71], v[100:103], v[68:71], a[68:71]
    s_add_u32 m0, s7, 57344
    s_nop 0
    buffer_load_dwordx4 v13, s[16:19], s70 offen  lds
    v_mfma_f32_16x16x32_bf16 a[100:103], v[36:39], v[68:71], a[100:103]
    v_mfma_f32_16x16x32_bf16 a[132:135], v[68:71], v[60:63], a[132:135]
    v_mfma_f32_16x16x32_bf16 a[164:167], v[68:71], v[64:67], a[164:167]
    s_waitcnt lgkmcnt(5)
    v_mfma_f32_16x16x32_bf16 a[8:11], v[88:91], v[72:75], a[8:11]
    s_add_u32 m0, s7, 61440
    s_nop 0
    buffer_load_dwordx4 v14, s[16:19], s70 offen  lds
    s_add_u32 s70, s70, 524288
    v_mfma_f32_16x16x32_bf16 a[40:43], v[96:99], v[72:75], a[40:43]
    v_mfma_f32_16x16x32_bf16 a[72:75], v[100:103], v[72:75], a[72:75]
    v_mfma_f32_16x16x32_bf16 a[104:107], v[36:39], v[72:75], a[104:107]
    v_mfma_f32_16x16x32_bf16 a[136:139], v[72:75], v[60:63], a[136:139]
    v_mfma_f32_16x16x32_bf16 a[168:171], v[72:75], v[64:67], a[168:171]
    s_waitcnt lgkmcnt(4)
    v_mfma_f32_16x16x32_bf16 a[12:15], v[88:91], v[76:79], a[12:15]
    v_mfma_f32_16x16x32_bf16 a[44:47], v[96:99], v[76:79], a[44:47]
    v_mfma_f32_16x16x32_bf16 a[76:79], v[100:103], v[76:79], a[76:79]
    v_mfma_f32_16x16x32_bf16 a[108:111], v[36:39], v[76:79], a[108:111]
    v_mfma_f32_16x16x32_bf16 a[140:143], v[76:79], v[60:63], a[140:143]
    v_mfma_f32_16x16x32_bf16 a[172:175], v[76:79], v[64:67], a[172:175]
    s_waitcnt lgkmcnt(3)
    v_mfma_f32_16x16x32_bf16 a[16:19], v[88:91], v[80:83], a[16:19]
    v_mfma_f32_16x16x32_bf16 a[48:51], v[96:99], v[80:83], a[48:51]
    v_mfma_f32_16x16x32_bf16 a[80:83], v[100:103], v[80:83], a[80:83]
    v_mfma_f32_16x16x32_bf16 a[112:115], v[36:39], v[80:83], a[112:115]
    v_mfma_f32_16x16x32_bf16 a[144:147], v[80:83], v[60:63], a[144:147]
    v_mfma_f32_16x16x32_bf16 a[176:179], v[80:83], v[64:67], a[176:179]
    s_waitcnt lgkmcnt(2)
    v_mfma_f32_16x16x32_bf16 a[20:23], v[88:91], v[32:35], a[20:23]
    v_mfma_f32_16x16x32_bf16 a[52:55], v[96:99], v[32:35], a[52:55]
    v_mfma_f32_16x16x32_bf16 a[84:87], v[100:103], v[32:35], a[84:87]
    v_mfma_f32_16x16x32_bf16 a[116:119], v[36:39], v[32:35], a[116:119]
    v_mfma_f32_16x16x32_bf16 a[148:151], v[32:35], v[60:63], a[148:151]
    v_mfma_f32_16x16x32_bf16 a[180:183], v[32:35], v[64:67], a[180:183]
    s_waitcnt lgkmcnt(1)
    v_mfma_f32_16x16x32_bf16 a[24:27], v[88:91], v[40:43], a[24:27]
    v_mfma_f32_16x16x32_bf16 a[56:59], v[96:99], v[40:43], a[56:59]
    v_mfma_f32_16x16x32_bf16 a[88:91], v[100:103], v[40:43], a[88:91]
    v_mfma_f32_16x16x32_bf16 a[120:123], v[36:39], v[40:43], a[120:123]
    v_mfma_f32_16x16x32_bf16 a[152:155], v[40:43], v[60:63], a[152:155]
    v_mfma_f32_16x16x32_bf16 a[184:187], v[40:43], v[64:67], a[184:187]
    s_waitcnt lgkmcnt(0)
    v_mfma_f32_16x16x32_bf16 a[28:31], v[88:91], v[44:47], a[28:31]
    v_mfma_f32_16x16x32_bf16 a[60:63], v[96:99], v[44:47], a[60:63]
    v_mfma_f32_16x16x32_bf16 a[92:95], v[100:103], v[44:47], a[92:95]
    v_mfma_f32_16x16x32_bf16 a[124:127], v[36:39], v[44:47], a[124:127]
    v_mfma_f32_16x16x32_bf16 a[156:159], v[44:47], v[60:63], a[156:159]
    v_mfma_f32_16x16x32_bf16 a[188:191], v[44:47], v[64:67], a[188:191]
    v_add_u32 v9, 0xffff0000, v9
    v_add_u32 v10, 0xffff0000, v10
    v_add_u32 v15, 0xffff0000, v15
    v_add_u32 v16, 0xffff0000, v16
    s_sub_u32 s74, s74, 1
    s_cmp_lg_u32 s74, 0
    s_cbranch_scc1 kl_3
    s_waitcnt vmcnt(0)
    s_barrier
    ds_read_b64_tr_b16 v[32:33], v15 offset:16384
    ds_read_b64_tr_b16 v[34:35], v15 offset:17408
    ds_read_b128 v[36:39], v9 offset:0
    ds_read_b64_tr_b16 v[40:41], v16 offset:16384
    ds_read_b64_tr_b16 v[42:43], v16 offset:17408
    ds_read_b64_tr_b16 v[44:45], v15 offset:32768
    ds_read_b64_tr_b16 v[46:47], v15 offset:33792
    ds_read_b64_tr_b16 v[48:49], v16 offset:32768
    ds_read_b64_tr_b16 v[50:51], v16 offset:33792
    ds_read_b64_tr_b16 v[52:53], v15 offset:49152
    ds_read_b64_tr_b16 v[54:55], v15 offset:50176
    s_waitcnt lgkmcnt(8)
    v_mfma_f32_16x16x32_bf16 a[0:3], v[32:35], v[36:39], a[0:3]
    ds_read_b64_tr_b16 v[56:57], v16 offset:49152
    ds_read_b64_tr_b16 v[58:59], v16 offset:50176
    s_waitcnt lgkmcnt(8)
    v_mfma_f32_16x16x32_bf16 a[32:35], v[40:43], v[36:39], a[32:35]
    ds_read_b128 v[60:63], v9 offset:2048
    s_waitcnt lgkmcnt(7)
    v_mfma_f32_16x16x32_bf16 a[64:67], v[44:47], v[36:39], a[64:67]
    ds_read_b128 v[64:67], v9 offset:4096
    s_waitcnt lgkmcnt(6)
    v_mfma_f32_16x16x32_bf16 a[96:99], v[48:51], v[36:39], a[96:99]
    ds_read_b128 v[68:71], v9 offset:6144
    s_waitcnt lgkmcnt(5)
    v_mfma_f32_16x16x32_bf16 a[128:131], v[36:39], v[52:55], a[128:131]
    ds_read_b128 v[72:75], v9 offset:8192
    s_waitcnt lgkmcnt(4)
    v_mfma_f32_16x16x32_bf16 a[160:163], v[36:39], v[56:59], a[160:163]
    ds_read_b128 v[76:79], v9 offset:10240
    s_waitcnt lgkmcnt(4)
    v_mfma_f32_16x16x32_bf16 a[4:7], v[32:35], v[60:63], a[4:7]
    ds_read_b128 v[80:83], v9 offset:12288
    v_mfma_f32_16x16x32_bf16 a[36:39], v[40:43], v[60:63], a[36:39]
    ds_read_b128 v[84:87], v9 offset:14336
    v_mfma_f32_16x16x32_bf16 a[68:71], v[44:47], v[60:63], a[68:71]
    ds_read_b64_tr_b16 v[88:89], v15 offset:24576
    ds_read_b64_tr_b16 v[90:91], v15 offset:25600
    v_mfma_f32_16x16x32_bf16 a[100:103], v[48:51], v[60:63], a[100:103]
    ds_read_b128 v[92:95], v10 offset:0
    v_mfma_f32_16x16x32_bf16 a[132:135], v[60:63], v[52:55], a[132:135]
    ds_read_b64_tr_b16 v[96:97], v16 offset:24576
    ds_read_b64_tr_b16 v[98:99], v16 offset:25600
    v_mfma_f32_16x16x32_bf16 a[164:167], v[60:63], v[56:59], a[164:167]
    ds_read_b64_tr_b16 v[100:101], v15 offset:40960
    ds_read_b64_tr_b16 v[102:103], v15 offset:41984
    s_waitcnt lgkmcnt(12)
    v_mfma_f32_16x16x32_bf16 a[8:11], v[32:35], v[64:67], a[8:11]
    ds_read_b64_tr_b16 v[36:37], v16 offset:40960
    ds_read_b64_tr_b16 v[38:39], v16 offset:41984
    v_mfma_f32_16x16x32_bf16 a[40:43], v[40:43], v[64:67], a[40:43]
    ds_read_b64_tr_b16 v[60:61], v15 offset:57344
    ds_read_b64_tr_b16 v[62:63], v15 offset:58368
    v_mfma_f32_16x16x32_bf16 a[72:75], v[44:47], v[64:67], a[72:75]
    v_mfma_f32_16x16x32_bf16 a[104:107], v[48:51], v[64:67], a[104:107]
    v_mfma_f32_16x16x32_bf16 a[136:139], v[64:67], v[52:55], a[136:139]
    v_mfma_f32_16x16x32_bf16 a[168:171], v[64:67], v[56:59], a[168:171]
    ds_read_b64_tr_b16 v[64:65], v16 offset:57344
    ds_read_b64_tr_b16 v[66:67], v16 offset:58368
    s_waitcnt lgkmcnt(15)
    v_mfma_f32_16x16x32_bf16 a[12:15], v[32:35], v[68:71], a[12:15]
    v_mfma_f32_16x16x32_bf16 a[44:47], v[40:43], v[68:71], a[44:47]
    v_mfma_f32_16x16x32_bf16 a[76:79], v[44:47], v[68:71], a[76:79]
    v_mfma_f32_16x16x32_bf16 a[108:111], v[48:51], v[68:71], a[108:111]
    v_mfma_f32_16x16x32_bf16 a[140:143], v[68:71], v[52:55], a[140:143]
    v_mfma_f32_16x16x32_bf16 a[172:175], v[68:71], v[56:59], a[172:175]
    ds_read_b128 v[68:71], v10 offset:2048
    v_mfma_f32_16x16x32_bf16 a[16:19], v[32:35], v[72:75], a[16:19]
    v_mfma_f32_16x16x32_bf16 a[48:51], v[40:43], v[72:75], a[48:51]
    v_mfma_f32_16x16x32_bf16 a[80:83], v[44:47], v[72:75], a[80:83]
    v_mfma_f32_16x16x32_bf16 a[112:115], v[48:51], v[72:75], a[112:115]
    v_mfma_f32_16x16x32_bf16 a[144:147], v[72:75], v[52:55], a[144:147]
    v_mfma_f32_16x16x32_bf16 a[176:179], v[72:75], v[56:59], a[176:179]
    ds_read_b128 v[72:75], v10 offset:4096
    v_mfma_f32_16x16x32_bf16 a[20:23], v[32:35], v[76:79], a[20:23]
    v_mfma_f32_16x16x32_bf16 a[52:55], v[40:43], v[76:79], a[52:55]
    v_mfma_f32_16x16x32_bf16 a[84:87], v[44:47], v[76:79], a[84:87]
    v_mfma_f32_16x16x32_bf16 a[116:119], v[48:51], v[76:79], a[116:119]
    v_mfma_f32_16x16x32_bf16 a[148:151], v[76:79], v[52:55], a[148:151]
    v_mfma_f32_16x16x32_bf16 a[180:183], v[76:79], v[56:59], a[180:183]
    ds_read_b128 v[76:79], v10 offset:6144
    s_waitcnt lgkmcnt(15)
    v_mfma_f32_16x16x32_bf16 a[24:27], v[32:35], v[80:83], a[24:27]
    v_mfma_f32_16x16x32_bf16 a[56:59], v[40:43], v[80:83], a[56:59]
    v_mfma_f32_16x16x32_bf16 a[88:91], v[44:47], v[80:83], a[88:91]
    v_mfma_f32_16x16x32_bf16 a[120:123], v[48:51], v[80:83], a[120:123]
    v_mfma_f32_16x16x32_bf16 a[152:155], v[80:83], v[52:55], a[152:155]
    v_mfma_f32_16x16x32_bf16 a[184:187], v[80:83], v[56:59], a[184:187]
    ds_read_b128 v[80:83], v10 offset:8192
    v_mfma_f32_16x16x32_bf16 a[28:31], v[32:35], v[84:87], a[28:31]
    ds_read_b128 v[32:35], v10 offset:10240
    v_mfma_f32_16x16x32_bf16 a[60:63], v[40:43], v[84:87], a[60:63]
    ds_read_b128 v[40:43], v10 offset:12288
    v_mfma_f32_16x16x32_bf16 a[92:95], v[44:47], v[84:87], a[92:95]
    ds_read_b128 v[44:47], v10 offset:14336
    v_mfma_f32_16x16x32_bf16 a[124:127], v[48:51], v[84:87], a[124:127]
    v_mfma_f32_16x16x32_bf16 a[156:159], v[84:87], v[52:55], a[156:159]
    v_mfma_f32_16x16x32_bf16 a[188:191], v[84:87], v[56:59], a[188:191]
    s_waitcnt lgkmcnt(15)
    v_mfma_f32_16x16x32_bf16 a[0:3], v[88:91], v[92:95], a[0:3]
    v_mfma_f32_16x16x32_bf16 a[32:35], v[96:99], v[92:95], a[32:35]
    s_waitcnt lgkmcnt(13)
    v_mfma_f32_16x16x32_bf16 a[64:67], v[100:103], v[92:95], a[64:67]
    s_waitcnt lgkmcnt(11)
    v_mfma_f32_16x16x32_bf16 a[96:99], v[36:39], v[92:95], a[96:99]
    s_waitcnt lgkmcnt(9)
    v_mfma_f32_16x16x32_bf16 a[128:131], v[92:95], v[60:63], a[128:131]
    s_waitcnt lgkmcnt(7)
    v_mfma_f32_16x16x32_bf16 a[160:163], v[92:95], v[64:67], a[160:163]
    s_waitcnt lgkmcnt(6)
    v_mfma_f32_16x16x32_bf16 a[4:7], v[88:91], v[68:71], a[4:7]
    v_mfma_f32_16x16x32_bf16 a[36:39], v[96:99], v[68:71], a[36:39]
    v_mfma_f32_16x16x32_bf16 a[68:71], v[100:103], v[68:71], a[68:71]
    v_mfma_f32_16x16x32_bf16 a[100:103], v[36:39], v[68:71], a[100:103]
    v_mfma_f32_16x16x32_bf16 a[132:135], v[68:71], v[60:63], a[132:135]
    v_mfma_f32_16x16x32_bf16 a[164:167], v[68:71], v[64:67], a[164:167]
    s_waitcnt lgkmcnt(5)
    v_mfma_f32_16x16x32_bf16 a[8:11], v[88:91], v[72:75], a[8:11]
    v_mfma_f32_16x16x32_bf16 a[40:43], v[96:99], v[72:75], a[40:43]
    v_mfma_f32_16x16x32_bf16 a[72:75], v[100:103], v[72:75], a[72:75]
    v_mfma_f32_16x16x32_bf16 a[104:107], v[36:39], v[72:75], a[104:107]
    v_mfma_f32_16x16x32_bf16 a[136:139], v[72:75], v[60:63], a[136:139]
    v_mfma_f32_16x16x32_bf16 a[168:171], v[72:75], v[64:67], a[168:171]
    s_waitcnt lgkmcnt(4)
    v_mfma_f32_16x16x32_bf16 a[12:15], v[88:91], v[76:79], a[12:15]
    v_mfma_f32_16x16x32_bf16 a[44:47], v[96:99], v[76:79], a[44:47]
    v_mfma_f32_16x16x32_bf16 a[76:79], v[100:103], v[76:79], a[76:79]
    v_mfma_f32_16x16x32_bf16 a[108:111], v[36:39], v[76:79], a[108:111]
    v_mfma_f32_16x16x32_bf16 a[140:143], v[76:79], v[60:63], a[140:143]
    v_mfma_f32_16x16x32_bf16 a[172:175], v[76:79], v[64:67], a[172:175]
    s_waitcnt lgkmcnt(3)
    v_mfma_f32_16x16x32_bf16 a[16:19], v[88:91], v[80:83], a[16:19]
    v_mfma_f32_16x16x32_bf16 a[48:51], v[96:99], v[80:83], a[48:51]
    v_mfma_f32_16x16x32_bf16 a[80:83], v[100:103], v[80:83], a[80:83]
    v_mfma_f32_16x16x32_bf16 a[112:115], v[36:39], v[80:83], a[112:115]
    v_mfma_f32_16x16x32_bf16 a[144:147], v[80:83], v[60:63], a[144:147]
    v_mfma_f32_16x16x32_bf16 a[176:179], v[80:83], v[64:67], a[176:179]
    s_waitcnt lgkmcnt(2)
    v_mfma_f32_16x16x32_bf16 a[20:23], v[88:91], v[32:35], a[20:23]
    v_mfma_f32_16x16x32_bf16 a[52:55], v[96:99], v[32:35], a[52:55]
    v_mfma_f32_16x16x32_bf16 a[84:87], v[100:103], v[32:35], a[84:87]
    v_mfma_f32_16x16x32_bf16 a[116:119], v[36:39], v[32:35], a[116:119]
    v_mfma_f32_16x16x32_bf16 a[148:151], v[32:35], v[60:63], a[148:151]
    v_mfma_f32_16x16x32_bf16 a[180:183], v[32:35], v[64:67], a[180:183]
    s_waitcnt lgkmcnt(1)
    v_mfma_f32_16x16x32_bf16 a[24:27], v[88:91], v[40:43], a[24:27]
    v_mfma_f32_16x16x32_bf16 a[56:59], v[96:99], v[40:43], a[56:59]
    v_mfma_f32_16x16x32_bf16 a[88:91], v[100:103], v[40:43], a[88:91]
    v_mfma_f32_16x16x32_bf16 a[120:123], v[36:39], v[40:43], a[120:123]
    v_mfma_f32_16x16x32_bf16 a[152:155], v[40:43], v[60:63], a[152:155]
    v_mfma_f32_16x16x32_bf16 a[184:187], v[40:43], v[64:67], a[184:187]
    s_waitcnt lgkmcnt(0)
    v_mfma_f32_16x16x32_bf16 a[28:31], v[88:91], v[44:47], a[28:31]
    v_mfma_f32_16x16x32_bf16 a[60:63], v[96:99], v[44:47], a[60:63]
    v_mfma_f32_16x16x32_bf16 a[92:95], v[100:103], v[44:47], a[92:95]
    v_mfma_f32_16x16x32_bf16 a[124:127], v[36:39], v[44:47], a[124:127]
    v_mfma_f32_16x16x32_bf16 a[156:159], v[44:47], v[60:63], a[156:159]
    v_mfma_f32_16x16x32_bf16 a[188:191], v[44:47], v[64:67], a[188:191]
    v_add_u32 v9, 0x10000, v9
    v_add_u32 v10, 0x10000, v10
    v_add_u32 v15, 0x10000, v15
    v_add_u32 v16, 0x10000, v16
    v_add_u32 v9, 0xffff0000, v9
    v_add_u32 v10, 0xffff0000, v10
    v_add_u32 v15, 0xffff0000, v15
    v_add_u32 v16, 0xffff0000, v16
    s_lshl_b32 s75, s72, 7
    s_add_u32 s75, s75, s71
    s_lshl_b32 s75, s75, 13
    s_lshl_b32 s76, s7, 1
    s_add_u32 s75, s75, s76
    s_add_u32 s76, s75, 262144
    s_add_u32 s77, s75, 524288
    s_add_u32 s78, s75, 786432
    s_nop 7
    s_lshl_b32 s84, s72, 5
    s_add_u32 s84, s84, s71
    s_lshl_b32 s84, s84, 7
    s_bitset1_b32 s84, 16
    v_accvgpr_read_b32 v32, a64
    v_accvgpr_read_b32 v36, a96
    v_accvgpr_read_b32 v33, a65
    v_accvgpr_read_b32 v37, a97
    v_accvgpr_read_b32 v34, a66
    v_accvgpr_read_b32 v38, a98
    v_accvgpr_read_b32 v35, a67
    v_accvgpr_read_b32 v39, a99
    v_cvt_pk_bf16_f32 v32, v32, v33
    v_cvt_pk_bf16_f32 v33, v34, v35
    v_cvt_pk_bf16_f32 v34, v36, v37
    v_cvt_pk_bf16_f32 v35, v38, v39
    buffer_store_dwordx4 v[32:35], v30, s[32:35], s75 offen offset:0 sc1
    v_accvgpr_read_b32 v40, a68
    v_accvgpr_read_b32 v44, a100
    v_accvgpr_read_b32 v41, a69
    v_accvgpr_read_b32 v45, a101
    v_accvgpr_read_b32 v42, a70
    v_accvgpr_read_b32 v46, a102
    v_accvgpr_read_b32 v43, a71
    v_accvgpr_read_b32 v47, a103
    v_cvt_pk_bf16_f32 v40, v40, v41
    v_cvt_pk_bf16_f32 v41, v42, v43
    v_cvt_pk_bf16_f32 v42, v44, v45
    v_cvt_pk_bf16_f32 v43, v46, v47
    buffer_store_dwordx4 v[40:43], v30, s[32:35], s75 offen offset:1024 sc1
    v_accvgpr_read_b32 v48, a72
    v_accvgpr_read_b32 v52, a104
    v_accvgpr_read_b32 v49, a73
    v_accvgpr_read_b32 v53, a105
    v_accvgpr_read_b32 v50, a74
    v_accvgpr_read_b32 v54, a106
    v_accvgpr_read_b32 v51, a75
    v_accvgpr_read_b32 v55, a107
    v_cvt_pk_bf16_f32 v48, v48, v49
    v_cvt_pk_bf16_f32 v49, v50, v51
    v_cvt_pk_bf16_f32 v50, v52, v53
    v_cvt_pk_bf16_f32 v51, v54, v55
    buffer_store_dwordx4 v[48:51], v30, s[32:35], s76 offen offset:0 sc1
    v_accvgpr_read_b32 v56, a76
    v_accvgpr_read_b32 v60, a108
    v_accvgpr_read_b32 v57, a77
    v_accvgpr_read_b32 v61, a109
    v_accvgpr_read_b32 v58, a78
    v_accvgpr_read_b32 v62, a110
    v_accvgpr_read_b32 v59, a79
    v_accvgpr_read_b32 v63, a111
    v_cvt_pk_bf16_f32 v56, v56, v57
    v_cvt_pk_bf16_f32 v57, v58, v59
    v_cvt_pk_bf16_f32 v58, v60, v61
    v_cvt_pk_bf16_f32 v59, v62, v63
    buffer_store_dwordx4 v[56:59], v30, s[32:35], s76 offen offset:1024 sc1
    v_accvgpr_read_b32 v64, a80
    v_accvgpr_read_b32 v68, a112
    v_accvgpr_read_b32 v65, a81
    v_accvgpr_read_b32 v69, a113
    v_accvgpr_read_b32 v66, a82
    v_accvgpr_read_b32 v70, a114
    v_accvgpr_read_b32 v67, a83
    v_accvgpr_read_b32 v71, a115
    v_cvt_pk_bf16_f32 v64, v64, v65
    v_cvt_pk_bf16_f32 v65, v66, v67
    v_cvt_pk_bf16_f32 v66, v68, v69
    v_cvt_pk_bf16_f32 v67, v70, v71
    buffer_store_dwordx4 v[64:67], v30, s[32:35], s77 offen offset:0 sc1
    v_accvgpr_read_b32 v72, a84
    v_accvgpr_read_b32 v76, a116
    v_accvgpr_read_b32 v73, a85
    v_accvgpr_read_b32 v77, a117
    v_accvgpr_read_b32 v74, a86
    v_accvgpr_read_b32 v78, a118
    v_accvgpr_read_b32 v75, a87
    v_accvgpr_read_b32 v79, a119
    v_cvt_pk_bf16_f32 v72, v72, v73
    v_cvt_pk_bf16_f32 v73, v74, v75
    v_cvt_pk_bf16_f32 v74, v76, v77
    v_cvt_pk_bf16_f32 v75, v78, v79
    buffer_store_dwordx4 v[72:75], v30, s[32:35], s77 offen offset:1024 sc1
    v_accvgpr_read_b32 v80, a88
    v_accvgpr_read_b32 v84, a120
    v_accvgpr_read_b32 v81, a89
    v_accvgpr_read_b32 v85, a121
    v_accvgpr_read_b32 v82, a90
    v_accvgpr_read_b32 v86, a122
    v_accvgpr_read_b32 v83, a91
    v_accvgpr_read_b32 v87, a123
    v_cvt_pk_bf16_f32 v80, v80, v81
    v_cvt_pk_bf16_f32 v81, v82, v83
    v_cvt_pk_bf16_f32 v82, v84, v85
    v_cvt_pk_bf16_f32 v83, v86, v87
    buffer_store_dwordx4 v[80:83], v30, s[32:35], s78 offen offset:0 sc1
    v_accvgpr_read_b32 v88, a92
    v_accvgpr_read_b32 v92, a124
    v_accvgpr_read_b32 v89, a93
    v_accvgpr_read_b32 v93, a125
    v_accvgpr_read_b32 v90, a94
    v_accvgpr_read_b32 v94, a126
    v_accvgpr_read_b32 v91, a95
    v_accvgpr_read_b32 v95, a127
    v_cvt_pk_bf16_f32 v88, v88, v89
    v_cvt_pk_bf16_f32 v89, v90, v91
    v_cvt_pk_bf16_f32 v90, v92, v93
    v_cvt_pk_bf16_f32 v91, v94, v95
    buffer_store_dwordx4 v[88:91], v30, s[32:35], s78 offen offset:1024 sc1
    v_accvgpr_read_b32 v96, a128
    v_accvgpr_read_b32 v100, a132
    v_accvgpr_read_b32 v97, a129
    v_accvgpr_read_b32 v101, a133
    v_accvgpr_read_b32 v98, a130
    v_accvgpr_read_b32 v102, a134
    v_accvgpr_read_b32 v99, a131
    v_accvgpr_read_b32 v103, a135
    v_cvt_pk_bf16_f32 v96, v96, v97
    v_cvt_pk_bf16_f32 v97, v98, v99
    v_cvt_pk_bf16_f32 v98, v100, v101
    v_cvt_pk_bf16_f32 v99, v102, v103
    buffer_store_dwordx4 v[96:99], v30, s[36:39], s75 offen offset:0 sc1
    v_accvgpr_read_b32 v104, a160
    v_accvgpr_read_b32 v108, a164
    v_accvgpr_read_b32 v105, a161
    v_accvgpr_read_b32 v109, a165
    v_accvgpr_read_b32 v106, a162
    v_accvgpr_read_b32 v110, a166
    v_accvgpr_read_b32 v107, a163
    v_accvgpr_read_b32 v111, a167
    v_cvt_pk_bf16_f32 v104, v104, v105
    v_cvt_pk_bf16_f32 v105, v106, v107
    v_cvt_pk_bf16_f32 v106, v108, v109
    v_cvt_pk_bf16_f32 v107, v110, v111
    buffer_store_dwordx4 v[104:107], v30, s[36:39], s75 offen offset:1024 sc1
    v_accvgpr_read_b32 v112, a136
    v_accvgpr_read_b32 v116, a140
    v_accvgpr_read_b32 v113, a137
    v_accvgpr_read_b32 v117, a141
    v_accvgpr_read_b32 v114, a138
    v_accvgpr_read_b32 v118, a142
    v_accvgpr_read_b32 v115, a139
    v_accvgpr_read_b32 v119, a143
    v_cvt_pk_bf16_f32 v112, v112, v113
    v_cvt_pk_bf16_f32 v113, v114, v115
    v_cvt_pk_bf16_f32 v114, v116, v117
    v_cvt_pk_bf16_f32 v115, v118, v119
    buffer_store_dwordx4 v[112:115], v30, s[36:39], s76 offen offset:0 sc1
    v_accvgpr_read_b32 v120, a168
    v_accvgpr_read_b32 v124, a172
    v_accvgpr_read_b32 v121, a169
    v_accvgpr_read_b32 v125, a173
    v_accvgpr_read_b32 v122, a170
    v_accvgpr_read_b32 v126, a174
    v_accvgpr_read_b32 v123, a171
    v_accvgpr_read_b32 v127, a175
    v_cvt_pk_bf16_f32 v120, v120, v121
    v_cvt_pk_bf16_f32 v121, v122, v123
    v_cvt_pk_bf16_f32 v122, v124, v125
    v_cvt_pk_bf16_f32 v123, v126, v127
    buffer_store_dwordx4 v[120:123], v30, s[36:39], s76 offen offset:1024 sc1
    v_accvgpr_read_b32 v128, a144
    v_accvgpr_read_b32 v132, a148
    v_accvgpr_read_b32 v129, a145
    v_accvgpr_read_b32 v133, a149
    v_accvgpr_read_b32 v130, a146
    v_accvgpr_read_b32 v134, a150
    v_accvgpr_read_b32 v131, a147
    v_accvgpr_read_b32 v135, a151
    v_cvt_pk_bf16_f32 v128, v128, v129
    v_cvt_pk_bf16_f32 v129, v130, v131
    v_cvt_pk_bf16_f32 v130, v132, v133
    v_cvt_pk_bf16_f32 v131, v134, v135
    buffer_store_dwordx4 v[128:131], v30, s[36:39], s77 offen offset:0 sc1
    v_accvgpr_read_b32 v136, a176
    v_accvgpr_read_b32 v140, a180
    v_accvgpr_read_b32 v137, a177
    v_accvgpr_read_b32 v141, a181
    v_accvgpr_read_b32 v138, a178
    v_accvgpr_read_b32 v142, a182
    v_accvgpr_read_b32 v139, a179
    v_accvgpr_read_b32 v143, a183
    v_cvt_pk_bf16_f32 v136, v136, v137
    v_cvt_pk_bf16_f32 v137, v138, v139
    v_cvt_pk_bf16_f32 v138, v140, v141
    v_cvt_pk_bf16_f32 v139, v142, v143
    buffer_store_dwordx4 v[136:139], v30, s[36:39], s77 offen offset:1024 sc1
    v_accvgpr_read_b32 v144, a152
    v_accvgpr_read_b32 v148, a156
    v_accvgpr_read_b32 v145, a153
    v_accvgpr_read_b32 v149, a157
    v_accvgpr_read_b32 v146, a154
    v_accvgpr_read_b32 v150, a158
    v_accvgpr_read_b32 v147, a155
    v_accvgpr_read_b32 v151, a159
    v_cvt_pk_bf16_f32 v144, v144, v145
    v_cvt_pk_bf16_f32 v145, v146, v147
    v_cvt_pk_bf16_f32 v146, v148, v149
    v_cvt_pk_bf16_f32 v147, v150, v151
    buffer_store_dwordx4 v[144:147], v30, s[36:39], s78 offen offset:0 sc1
    v_accvgpr_read_b32 v152, a184
    v_accvgpr_read_b32 v156, a188
    v_accvgpr_read_b32 v153, a185
    v_accvgpr_read_b32 v157, a189
    v_accvgpr_read_b32 v154, a186
    v_accvgpr_read_b32 v158, a190
    v_accvgpr_read_b32 v155, a187
    v_accvgpr_read_b32 v159, a191
    v_cvt_pk_bf16_f32 v152, v152, v153
    v_cvt_pk_bf16_f32 v153, v154, v155
    v_cvt_pk_bf16_f32 v154, v156, v157
    v_cvt_pk_bf16_f32 v155, v158, v159
    buffer_store_dwordx4 v[152:155], v30, s[36:39], s78 offen offset:1024 sc1
    s_waitcnt vmcnt(0)
    s_barrier
    s_cmp_lg_u32 s6, 0
    s_cbranch_scc1 wk_n1
    v_mov_b32 v194, 0
    v_mov_b32 v195, 1
    s_mov_b64 exec, 1
    buffer_store_dword v195, v194, s[48:51], s84 offen sc1
    s_mov_b64 exec, -1
wk_n1:
    v_accvgpr_read_b32 v32, a0
    v_accvgpr_read_b32 v36, a32
    v_accvgpr_read_b32 v33, a1
    v_accvgpr_read_b32 v37, a33
    v_accvgpr_read_b32 v34, a2
    v_accvgpr_read_b32 v38, a34
    v_accvgpr_read_b32 v35, a3
    v_accvgpr_read_b32 v39, a35
    v_cvt_pk_bf16_f32 v32, v32, v33
    v_cvt_pk_bf16_f32 v33, v34, v35
    v_cvt_pk_bf16_f32 v34, v36, v37
    v_cvt_pk_bf16_f32 v35, v38, v39
    buffer_store_dwordx4 v[32:35], v30, s[28:31], s75 offen offset:0 sc1
    v_accvgpr_read_b32 v40, a4
    v_accvgpr_read_b32 v44, a36
    v_accvgpr_read_b32 v41, a5
    v_accvgpr_read_b32 v45, a37
    v_accvgpr_read_b32 v42, a6
    v_accvgpr_read_b32 v46, a38
    v_accvgpr_read_b32 v43, a7
    v_accvgpr_read_b32 v47, a39
    v_cvt_pk_bf16_f32 v40, v40, v41
    v_cvt_pk_bf16_f32 v41, v42, v43
    v_cvt_pk_bf16_f32 v42, v44, v45
    v_cvt_pk_bf16_f32 v43, v46, v47
    buffer_store_dwordx4 v[40:43], v30, s[28:31], s75 offen offset:1024 sc1
    v_accvgpr_read_b32 v48, a8
    v_accvgpr_read_b32 v52, a40
    v_accvgpr_read_b32 v49, a9
    v_accvgpr_read_b32 v53, a41
    v_accvgpr_read_b32 v50, a10
    v_accvgpr_read_b32 v54, a42
    v_accvgpr_read_b32 v51, a11
    v_accvgpr_read_b32 v55, a43
    v_cvt_pk_bf16_f32 v48, v48, v49
    v_cvt_pk_bf16_f32 v49, v50, v51
    v_cvt_pk_bf16_f32 v50, v52, v53
    v_cvt_pk_bf16_f32 v51, v54, v55
    buffer_store_dwordx4 v[48:51], v30, s[28:31], s76 offen offset:0 sc1
    v_accvgpr_read_b32 v56, a12
    v_accvgpr_read_b32 v60, a44
    v_accvgpr_read_b32 v57, a13
    v_accvgpr_read_b32 v61, a45
    v_accvgpr_read_b32 v58, a14
    v_accvgpr_read_b32 v62, a46
    v_accvgpr_read_b32 v59, a15
    v_accvgpr_read_b32 v63, a47
    v_cvt_pk_bf16_f32 v56, v56, v57
    v_cvt_pk_bf16_f32 v57, v58, v59
    v_cvt_pk_bf16_f32 v58, v60, v61
    v_cvt_pk_bf16_f32 v59, v62, v63
    buffer_store_dwordx4 v[56:59], v30, s[28:31], s76 offen offset:1024 sc1
    v_accvgpr_read_b32 v64, a16
    v_accvgpr_read_b32 v68, a48
    v_accvgpr_read_b32 v65, a17
    v_accvgpr_read_b32 v69, a49
    v_accvgpr_read_b32 v66, a18
    v_accvgpr_read_b32 v70, a50
    v_accvgpr_read_b32 v67, a19
    v_accvgpr_read_b32 v71, a51
    v_cvt_pk_bf16_f32 v64, v64, v65
    v_cvt_pk_bf16_f32 v65, v66, v67
    v_cvt_pk_bf16_f32 v66, v68, v69
    v_cvt_pk_bf16_f32 v67, v70, v71
    buffer_store_dwordx4 v[64:67], v30, s[28:31], s77 offen offset:0 sc1
    v_accvgpr_read_b32 v72, a20
    v_accvgpr_read_b32 v76, a52
    v_accvgpr_read_b32 v73, a21
    v_accvgpr_read_b32 v77, a53
    v_accvgpr_read_b32 v74, a22
    v_accvgpr_read_b32 v78, a54
    v_accvgpr_read_b32 v75, a23
    v_accvgpr_read_b32 v79, a55
    v_cvt_pk_bf16_f32 v72, v72, v73
    v_cvt_pk_bf16_f32 v73, v74, v75
    v_cvt_pk_bf16_f32 v74, v76, v77
    v_cvt_pk_bf16_f32 v75, v78, v79
    buffer_store_dwordx4 v[72:75], v30, s[28:31], s77 offen offset:1024 sc1
    v_accvgpr_read_b32 v80, a24
    v_accvgpr_read_b32 v84, a56
    v_accvgpr_read_b32 v81, a25
    v_accvgpr_read_b32 v85, a57
    v_accvgpr_read_b32 v82, a26
    v_accvgpr_read_b32 v86, a58
    v_accvgpr_read_b32 v83, a27
    v_accvgpr_read_b32 v87, a59
    v_cvt_pk_bf16_f32 v80, v80, v81
    v_cvt_pk_bf16_f32 v81, v82, v83
    v_cvt_pk_bf16_f32 v82, v84, v85
    v_cvt_pk_bf16_f32 v83, v86, v87
    buffer_store_dwordx4 v[80:83], v30, s[28:31], s78 offen offset:0 sc1
    v_accvgpr_read_b32 v88, a28
    v_accvgpr_read_b32 v92, a60
    v_accvgpr_read_b32 v89, a29
    v_accvgpr_read_b32 v93, a61
    v_accvgpr_read_b32 v90, a30
    v_accvgpr_read_b32 v94, a62
    v_accvgpr_read_b32 v91, a31
    v_accvgpr_read_b32 v95, a63
    v_cvt_pk_bf16_f32 v88, v88, v89
    v_cvt_pk_bf16_f32 v89, v90, v91
    v_cvt_pk_bf16_f32 v90, v92, v93
    v_cvt_pk_bf16_f32 v91, v94, v95
    buffer_store_dwordx4 v[88:91], v30, s[28:31], s78 offen offset:1024 sc1
    s_waitcnt vmcnt(0)
    s_barrier
    s_lshl_b32 s75, s72, 5
    s_add_u32 s75, s75, s71
    s_lshl_b32 s75, s75, 7
    s_bitset1_b32 s75, 16
    s_cmp_lg_u32 s6, 0
    s_cbranch_scc1 wk_nof
    v_mov_b32 v2, 0
    v_mov_b32 v3, 2
    s_mov_b64 exec, 1
    buffer_store_dword v3, v2, s[48:51], s75 offen sc1
    s_mov_b64 exec, -1
wk_nof:
    s_add_u32 s79, s79, 224
    s_cmp_lt_u32 s79, 512
    s_cbranch_scc1 wk_task
    s_load_dwordx2 s[16:17], s[0:1], 64
    s_mov_b32 s18, 18874368
    s_mov_b32 s19, 0x00020000
    s_load_dwordx2 s[52:53], s[0:1], 72
    s_mov_b32 s54, 9216
    s_mov_b32 s55, 0x00020000
    s_load_dwordx2 s[56:57], s[0:1], 0
    s_mov_b32 s58, 2359296
    s_mov_b32 s59, 0x00020000
    s_add_u32 s8, s4, 71987200
    s_addc_u32 s9, s5, 0
    s_mov_b32 s10, 37748736
    s_mov_b32 s11, 0x00020000
    s_add_u32 s12, s4, 112095232
    s_addc_u32 s13, s5, 0
    s_mov_b32 s14, 2359296
    s_mov_b32 s15, 0x00020000
    s_add_u32 s24, s4, 114454528
    s_addc_u32 s25, s5, 0
    s_mov_b32 s26, 5308416
    s_mov_b32 s27, 0x00020000
    s_add_u32 s76, s4, 109735936
    s_addc_u32 s77, s5, 0
    s_mov_b32 s78, 2359296
    s_mov_b32 s79, 0x00020000
    s_mov_b32 s64, 400000
    s_waitcnt lgkmcnt(0)
    s_mul_i32 s66, s3, 10923
    s_lshr_b32 s66, s66, 16
    s_mul_i32 s67, s66, 6
    s_sub_u32 s67, s3, s67
    s_and_b32 s68, s6, 1
    s_mul_i32 s68, s68, 3
    s_lshr_b32 s69, s6, 1
    s_lshl_b32 s69, s69, 2
    s_and_b32 s72, s66, 7
    s_lshr_b32 s73, s66, 3
    s_cmp_lt_u32 s3, 192
    s_cbranch_scc1 p2_wo
    s_bfe_u32 s73, s3, 0x20003
p2_wo:
    v_and_b32 v2, 63, v0
    v_add_u32 v3, 0, v0
    v_mul_u32_u24 v4, 5462, v3
    v_lshrrev_b32 v4, 16, v4
    v_mul_u32_u24 v5, 12, v4
    v_sub_u32 v5, v3, v5
    v_bfe_u32 v6, v4, 2, 1
    v_lshlrev_b32 v6, 1, v6
    v_xor_b32 v5, v5, v6
    v_mul_u32_u24 v4, 1152, v4
    v_lshl_add_u32 v8, v5, 4, v4
    v_add_u32 v3, 256, v0
    v_mul_u32_u24 v4, 5462, v3
    v_lshrrev_b32 v4, 16, v4
    v_mul_u32_u24 v5, 12, v4
    v_sub_u32 v5, v3, v5
    v_bfe_u32 v6, v4, 2, 1
    v_lshlrev_b32 v6, 1, v6
    v_xor_b32 v5, v5, v6
    v_mul_u32_u24 v4, 1152, v4
    v_lshl_add_u32 v9, v5, 4, v4
    v_add_u32 v3, 512, v0
    v_mul_u32_u24 v4, 5462, v3
    v_lshrrev_b32 v4, 16, v4
    v_mul_u32_u24 v5, 12, v4
    v_sub_u32 v5, v3, v5
    v_bfe_u32 v6, v4, 2, 1
    v_lshlrev_b32 v6, 1, v6
    v_xor_b32 v5, v5, v6
    v_mul_u32_u24 v4, 1152, v4
    v_lshl_add_u32 v10, v5, 4, v4
    v_bfe_u32 v3, v0, 4, 2
    v_bfe_u32 v4, v0, 2, 2
    v_lshl_add_u32 v3, v3, 2, v4
    v_bfe_u32 v6, v3, 2, 1
    v_mul_u32_u24 v3, 192, v3
    v_and_b32 v4, 3, v0
    v_lshl_add_u32 v3, v4, 3, v3
    v_mov_b32 v4, 0
    v_xor_b32 v4, v4, v6
    v_lshl_add_u32 v11, v4, 5, v3
    v_mov_b32 v4, 1
    v_xor_b32 v4, v4, v6
    v_lshl_add_u32 v12, v4, 5, v3
    s_mul_i32 s70, s72, 589824
    s_mul_i32 s71, s67, 192
    s_add_u32 s70, s70, s71
    s_add_u32 m0, s7, 0
    s_nop 0
    buffer_load_dwordx4 v8, s[20:23], s70 offen  lds
    s_add_u32 m0, s7, 4096
    s_nop 0
    buffer_load_dwordx4 v9, s[20:23], s70 offen  lds
    s_add_u32 m0, s7, 8192
    s_nop 0
    buffer_load_dwordx4 v10, s[20:23], s70 offen  lds
    s_add_u32 s70, s70, 73728
    s_add_u32 m0, s7, 12288
    s_nop 0
    buffer_load_dwordx4 v8, s[20:23], s70 offen  lds
    s_add_u32 m0, s7, 16384
    s_nop 0
    buffer_load_dwordx4 v9, s[20:23], s70 offen  lds
    s_add_u32 m0, s7, 20480
    s_nop 0
    buffer_load_dwordx4 v10, s[20:23], s70 offen  lds
    s_add_u32 s70, s70, 73728
    s_add_u32 m0, s7, 24576
    s_nop 0
    buffer_load_dwordx4 v8, s[20:23], s70 offen  lds
    s_add_u32 m0, s7, 28672
    s_nop 0
    buffer_load_dwordx4 v9, s[20:23], s70 offen  lds
    s_add_u32 m0, s7, 32768
    s_nop 0
    buffer_load_dwordx4 v10, s[20:23], s70 offen  lds
    s_add_u32 s70, s70, 73728
    s_add_u32 m0, s7, 36864
    s_nop 0
    buffer_load_dwordx4 v8, s[20:23], s70 offen  lds
    s_add_u32 m0, s7, 40960
    s_nop 0
    buffer_load_dwordx4 v9, s[20:23], s70 offen  lds
    s_add_u32 m0, s7, 45056
    s_nop 0
    buffer_load_dwordx4 v10, s[20:23], s70 offen  lds
    s_add_u32 s70, s70, 73728
    s_add_u32 m0, s7, 49152
    s_nop 0
    buffer_load_dwordx4 v8, s[20:23], s70 offen  lds
    s_add_u32 m0, s7, 53248
    s_nop 0
    buffer_load_dwordx4 v9, s[20:23], s70 offen  lds
    s_add_u32 m0, s7, 57344
    s_nop 0
    buffer_load_dwordx4 v10, s[20:23], s70 offen  lds
    s_add_u32 s70, s70, 73728
    s_add_u32 m0, s7, 61440
    s_nop 0
    buffer_load_dwordx4 v8, s[20:23], s70 offen  lds
    s_add_u32 m0, s7, 65536
    s_nop 0
    buffer_load_dwordx4 v9, s[20:23], s70 offen  lds
    s_add_u32 m0, s7, 69632
    s_nop 0
    buffer_load_dwordx4 v10, s[20:23], s70 offen  lds
    s_add_u32 s70, s70, 73728
    s_add_u32 m0, s7, 73728
    s_nop 0
    buffer_load_dwordx4 v8, s[20:23], s70 offen  lds
    s_add_u32 m0, s7, 77824
    s_nop 0
    buffer_load_dwordx4 v9, s[20:23], s70 offen  lds
    s_add_u32 m0, s7, 81920
    s_nop 0
    buffer_load_dwordx4 v10, s[20:23], s70 offen  lds
    s_add_u32 s70, s70, 73728
    s_add_u32 m0, s7, 86016
    s_nop 0
    buffer_load_dwordx4 v8, s[20:23], s70 offen  lds
    s_add_u32 m0, s7, 90112
    s_nop 0
    buffer_load_dwordx4 v9, s[20:23], s70 offen  lds
    s_add_u32 m0, s7, 94208
    s_nop 0
    buffer_load_dwordx4 v10, s[20:23], s70 offen  lds
    s_add_u32 s70, s70, 73728
    s_mul_i32 s71, s6, 24576
    v_add_u32 v11, s71, v11
    v_add_u32 v12, s71, v12
    s_waitcnt vmcnt(0)
    s_barrier
    ds_read_b64_tr_b16 a[64:65], v11 offset:0
    ds_read_b64_tr_b16 a[66:67], v11 offset:3072
    ds_read_b64_tr_b16 a[68:69], v12 offset:0
    ds_read_b64_tr_b16 a[70:71], v12 offset:3072
    ds_read_b64_tr_b16 a[72:73], v11 offset:64
    ds_read_b64_tr_b16 a[74:75], v11 offset:3136
    ds_read_b64_tr_b16 a[76:77], v12 offset:64
    ds_read_b64_tr_b16 a[78:79], v12 offset:3136
    ds_read_b64_tr_b16 a[80:81], v11 offset:128
    ds_read_b64_tr_b16 a[82:83], v11 offset:3200
    ds_read_b64_tr_b16 a[84:85], v12 offset:128
    ds_read_b64_tr_b16 a[86:87], v12 offset:3200
    ds_read_b64_tr_b16 a[88:89], v11 offset:6144
    ds_read_b64_tr_b16 a[90:91], v11 offset:9216
    ds_read_b64_tr_b16 a[92:93], v12 offset:6144
    ds_read_b64_tr_b16 a[94:95], v12 offset:9216
    ds_read_b64_tr_b16 a[96:97], v11 offset:6208
    ds_read_b64_tr_b16 a[98:99], v11 offset:9280
    ds_read_b64_tr_b16 a[100:101], v12 offset:6208
    ds_read_b64_tr_b16 a[102:103], v12 offset:9280
    ds_read_b64_tr_b16 a[104:105], v11 offset:6272
    ds_read_b64_tr_b16 a[106:107], v11 offset:9344
    ds_read_b64_tr_b16 a[108:109], v12 offset:6272
    ds_read_b64_tr_b16 a[110:111], v12 offset:9344
    ds_read_b64_tr_b16 a[112:113], v11 offset:12288
    ds_read_b64_tr_b16 a[114:115], v11 offset:15360
    ds_read_b64_tr_b16 a[116:117], v12 offset:12288
    ds_read_b64_tr_b16 a[118:119], v12 offset:15360
    ds_read_b64_tr_b16 a[120:121], v11 offset:12352
    ds_read_b64_tr_b16 a[122:123], v11 offset:15424
    ds_read_b64_tr_b16 a[124:125], v12 offset:12352
    ds_read_b64_tr_b16 a[126:127], v12 offset:15424
    ds_read_b64_tr_b16 a[128:129], v11 offset:12416
    ds_read_b64_tr_b16 a[130:131], v11 offset:15488
    ds_read_b64_tr_b16 a[132:133], v12 offset:12416
    ds_read_b64_tr_b16 a[134:135], v12 offset:15488
    ds_read_b64_tr_b16 a[136:137], v11 offset:18432
    ds_read_b64_tr_b16 a[138:139], v11 offset:21504
    ds_read_b64_tr_b16 a[140:141], v12 offset:18432
    ds_read_b64_tr_b16 a[142:143], v12 offset:21504
    ds_read_b64_tr_b16 a[144:145], v11 offset:18496
    ds_read_b64_tr_b16 a[146:147], v11 offset:21568
    ds_read_b64_tr_b16 a[148:149], v12 offset:18496
    ds_read_b64_tr_b16 a[150:151], v12 offset:21568
    ds_read_b64_tr_b16 a[152:153], v11 offset:18560
    ds_read_b64_tr_b16 a[154:155], v11 offset:21632
    ds_read_b64_tr_b16 a[156:157], v12 offset:18560
    ds_read_b64_tr_b16 a[158:159], v12 offset:21632
    v_and_b32 v2, 15, v0
    v_bfe_u32 v3, v0, 4, 2
    v_mul_u32_u24 v2, 400, v2
    v_lshl_add_u32 v2, v3, 4, v2
    s_mul_i32 s71, s6, 12800
    s_add_u32 s71, s71, 57344
    v_add_u32 v196, s71, v2
    s_mul_i32 s70, s72, 2304
    s_mul_i32 s71, s67, 384
    s_add_u32 s70, s70, s71
    v_add_u32 v2, 0, v0
    v_mul_u32_u24 v3, 2731, v2
    v_lshrrev_b32 v3, 16, v3
    v_mul_u32_u24 v4, 24, v3
    v_sub_u32 v4, v2, v4
    v_lshlrev_b32 v4, 4, v4
    v_mul_u32_u24 v5, 400, v3
    v_add_u32 v5, 57344, v5
    v_add_u32 v197, v5, v4
    v_mul_u32_u24 v5, 18432, v3
    v_add3_u32 v200, v5, v4, s70
    v_add_u32 v2, 256, v0
    v_mul_u32_u24 v3, 2731, v2
    v_lshrrev_b32 v3, 16, v3
    v_mul_u32_u24 v4, 24, v3
    v_sub_u32 v4, v2, v4
    v_lshlrev_b32 v4, 4, v4
    v_mul_u32_u24 v5, 400, v3
    v_add_u32 v5, 57344, v5
    v_add_u32 v198, v5, v4
    v_mul_u32_u24 v5, 18432, v3
    v_add3_u32 v201, v5, v4, s70
    v_add_u32 v2, 512, v0
    v_mul_u32_u24 v3, 2731, v2
    v_lshrrev_b32 v3, 16, v3
    v_mul_u32_u24 v4, 24, v3
    v_sub_u32 v4, v2, v4
    v_lshlrev_b32 v4, 4, v4
    v_mul_u32_u24 v5, 400, v3
    v_add_u32 v5, 57344, v5
    v_add_u32 v199, v5, v4
    v_mul_u32_u24 v5, 18432, v3
    v_add3_u32 v202, v5, v4, s70
    s_waitcnt lgkmcnt(0)
    s_barrier
    s_load_dwordx2 s[20:21], s[0:1], 80
    s_mov_b32 s22, 18874368
    s_mov_b32 s23, 0x00020000
    s_waitcnt lgkmcnt(0)
    v_and_b32 v2, 63, v0
    v_add_u32 v3, 0, v0
    v_mul_u32_u24 v4, 5462, v3
    v_lshrrev_b32 v4, 16, v4
    v_mul_u32_u24 v5, 12, v4
    v_sub_u32 v5, v3, v5
    v_bfe_u32 v6, v4, 3, 1
    v_lshlrev_b32 v6, 1, v6
    v_xor_b32 v5, v5, v6
    v_mul_u32_u24 v4, 1152, v4
    v_lshl_add_u32 v204, v5, 4, v4
    v_add_u32 v3, 256, v0
    v_mul_u32_u24 v4, 5462, v3
    v_lshrrev_b32 v4, 16, v4
    v_mul_u32_u24 v5, 12, v4
    v_sub_u32 v5, v3, v5
    v_bfe_u32 v6, v4, 3, 1
    v_lshlrev_b32 v6, 1, v6
    v_xor_b32 v5, v5, v6
    v_mul_u32_u24 v4, 1152, v4
    v_lshl_add_u32 v205, v5, 4, v4
    v_add_u32 v3, 512, v0
    v_mul_u32_u24 v4, 5462, v3
    v_lshrrev_b32 v4, 16, v4
    v_mul_u32_u24 v5, 12, v4
    v_sub_u32 v5, v3, v5
    v_bfe_u32 v6, v4, 3, 1
    v_lshlrev_b32 v6, 1, v6
    v_xor_b32 v5, v5, v6
    v_mul_u32_u24 v4, 1152, v4
    v_lshl_add_u32 v206, v5, 4, v4
    v_bfe_u32 v3, v0, 4, 2
    v_bfe_u32 v4, v0, 2, 2
    v_lshl_add_u32 v3, v3, 3, v4
    v_bfe_u32 v6, v3, 3, 1
    v_mul_u32_u24 v3, 192, v3
    v_and_b32 v4, 3, v0
    v_lshl_add_u32 v3, v4, 3, v3
    v_mov_b32 v4, s68
    v_add_u32 v4, 0, v4
    v_xor_b32 v4, v4, v6
    v_lshl_add_u32 v207, v4, 5, v3
    v_mov_b32 v4, s68
    v_add_u32 v4, 1, v4
    v_xor_b32 v4, v4, v6
    v_lshl_add_u32 v208, v4, 5, v3
    v_add_u32 v3, 0, v0
    v_lshrrev_b32 v4, 4, v3
    v_and_b32 v5, 15, v3
    v_bfe_u32 v6, v4, 3, 1
    v_and_b32 v7, 3, v4
    v_lshl_or_b32 v6, v6, 2, v7
    v_lshlrev_b32 v6, 1, v6
    v_xor_b32 v5, v5, v6
    v_mul_u32_u24 v4, 9216, v4
    v_lshl_add_u32 v209, v5, 4, v4
    v_add_u32 v3, 256, v0
    v_lshrrev_b32 v4, 4, v3
    v_and_b32 v5, 15, v3
    v_bfe_u32 v6, v4, 3, 1
    v_and_b32 v7, 3, v4
    v_lshl_or_b32 v6, v6, 2, v7
    v_lshlrev_b32 v6, 1, v6
    v_xor_b32 v5, v5, v6
    v_mul_u32_u24 v4, 9216, v4
    v_lshl_add_u32 v210, v5, 4, v4
    v_add_u32 v3, 512, v0
    v_lshrrev_b32 v4, 4, v3
    v_and_b32 v5, 15, v3
    v_bfe_u32 v6, v4, 3, 1
    v_and_b32 v7, 3, v4
    v_lshl_or_b32 v6, v6, 2, v7
    v_lshlrev_b32 v6, 1, v6
    v_xor_b32 v5, v5, v6
    v_mul_u32_u24 v4, 9216, v4
    v_lshl_add_u32 v211, v5, 4, v4
    v_add_u32 v3, 768, v0
    v_lshrrev_b32 v4, 4, v3
    v_and_b32 v5, 15, v3
    v_bfe_u32 v6, v4, 3, 1
    v_and_b32 v7, 3, v4
    v_lshl_or_b32 v6, v6, 2, v7
    v_lshlrev_b32 v6, 1, v6
    v_xor_b32 v5, v5, v6
    v_mul_u32_u24 v4, 9216, v4
    v_lshl_add_u32 v212, v5, 4, v4
    v_bfe_u32 v3, v0, 4, 2
    v_bfe_u32 v4, v0, 2, 2
    v_lshl_add_u32 v3, v3, 3, v4
    v_bfe_u32 v6, v3, 3, 1
    v_and_b32 v7, 3, v3
    v_lshl_or_b32 v6, v6, 2, v7
    v_mul_u32_u24 v3, 256, v3
    v_and_b32 v4, 3, v0
    v_lshl_add_u32 v3, v4, 3, v3
    v_mov_b32 v4, s69
    v_add_u32 v4, 0, v4
    v_xor_b32 v4, v4, v6
    v_lshl_add_u32 v213, v4, 5, v3
    v_mov_b32 v4, s69
    v_add_u32 v4, 1, v4
    v_xor_b32 v4, v4, v6
    v_lshl_add_u32 v214, v4, 5, v3
    v_mov_b32 v4, s69
    v_add_u32 v4, 2, v4
    v_xor_b32 v4, v4, v6
    v_lshl_add_u32 v215, v4, 5, v3
    v_mov_b32 v4, s69
    v_add_u32 v4, 3, v4
    v_xor_b32 v4, v4, v6
    v_lshl_add_u32 v216, v4, 5, v3
    s_mul_i32 s70, s67, 192
    s_lshl_b32 s71, s66, 8
    v_accvgpr_write_b32 a0, 0
    v_accvgpr_write_b32 a1, 0
    v_accvgpr_write_b32 a2, 0
    v_accvgpr_write_b32 a3, 0
    v_accvgpr_write_b32 a4, 0
    v_accvgpr_write_b32 a5, 0
    v_accvgpr_write_b32 a6, 0
    v_accvgpr_write_b32 a7, 0
    v_accvgpr_write_b32 a8, 0
    v_accvgpr_write_b32 a9, 0
    v_accvgpr_write_b32 a10, 0
    v_accvgpr_write_b32 a11, 0
    v_accvgpr_write_b32 a12, 0
    v_accvgpr_write_b32 a13, 0
    v_accvgpr_write_b32 a14, 0
    v_accvgpr_write_b32 a15, 0
    v_accvgpr_write_b32 a16, 0
    v_accvgpr_write_b32 a17, 0
    v_accvgpr_write_b32 a18, 0
    v_accvgpr_write_b32 a19, 0
    v_accvgpr_write_b32 a20, 0
    v_accvgpr_write_b32 a21, 0
    v_accvgpr_write_b32 a22, 0
    v_accvgpr_write_b32 a23, 0
    v_accvgpr_write_b32 a24, 0
    v_accvgpr_write_b32 a25, 0
    v_accvgpr_write_b32 a26, 0
    v_accvgpr_write_b32 a27, 0
    v_accvgpr_write_b32 a28, 0
    v_accvgpr_write_b32 a29, 0
    v_accvgpr_write_b32 a30, 0
    v_accvgpr_write_b32 a31, 0
    v_accvgpr_write_b32 a32, 0
    v_accvgpr_write_b32 a33, 0
    v_accvgpr_write_b32 a34, 0
    v_accvgpr_write_b32 a35, 0
    v_accvgpr_write_b32 a36, 0
    v_accvgpr_write_b32 a37, 0
    v_accvgpr_write_b32 a38, 0
    v_accvgpr_write_b32 a39, 0
    v_accvgpr_write_b32 a40, 0
    v_accvgpr_write_b32 a41, 0
    v_accvgpr_write_b32 a42, 0
    v_accvgpr_write_b32 a43, 0
    v_accvgpr_write_b32 a44, 0
    v_accvgpr_write_b32 a45, 0
    v_accvgpr_write_b32 a46, 0
    v_accvgpr_write_b32 a47, 0
    s_mov_b32 s80, 0
    s_and_b32 s81, s3, 15
    s_lshl_b32 s81, s81, 7
    s_add_u32 s81, s81, 131072
    s_lshl_b32 s82, s72, 2
    s_add_u32 s82, s82, s6
    s_mul_i32 s83, s72, 6
    s_add_u32 s83, s83, s67
    s_lshl_b32 s83, s83, 2
    s_add_u32 s83, s83, 4096
    v_bfe_u32 v3, v0, 4, 2
    s_min_u32 s84, s66, 35
    s_lshl_b32 s42, s84, 3
    s_add_u32 s42, s42, s69
    s_lshl_b32 s42, s42, 5
    v_lshlrev_b32 v4, 3, v3
    buffer_load_dwordx2 v[176:177], v4, s[52:55], s42 offen offset:0
    buffer_load_dwordx2 v[178:179], v4, s[52:55], s42 offen offset:32
    buffer_load_dwordx2 v[180:181], v4, s[52:55], s42 offen offset:64
    buffer_load_dwordx2 v[182:183], v4, s[52:55], s42 offen offset:96
p2_loop:
    s_cmp_eq_u32 s80, 0
    s_cbranch_scc1 p2_noy
    s_cmp_ge_u32 s3, 216
    s_cbranch_scc1 p2_noy
    s_add_u32 m0, s7, 12288
    s_nop 0
    buffer_load_dwordx4 v209, s[16:19], s71 offen  lds
    s_add_u32 m0, s7, 16384
    s_nop 0
    buffer_load_dwordx4 v210, s[16:19], s71 offen  lds
    s_add_u32 m0, s7, 20480
    s_nop 0
    buffer_load_dwordx4 v211, s[16:19], s71 offen  lds
    s_add_u32 m0, s7, 24576
    s_nop 0
    buffer_load_dwordx4 v212, s[16:19], s71 offen  lds
    s_add_u32 s71, s71, 589824
    s_add_u32 m0, s7, 40960
    s_nop 0
    buffer_load_dwordx4 v209, s[16:19], s71 offen  lds
    s_add_u32 m0, s7, 45056
    s_nop 0
    buffer_load_dwordx4 v210, s[16:19], s71 offen  lds
    s_add_u32 m0, s7, 49152
    s_nop 0
    buffer_load_dwordx4 v211, s[16:19], s71 offen  lds
    s_add_u32 m0, s7, 53248
    s_nop 0
    buffer_load_dwordx4 v212, s[16:19], s71 offen  lds
    s_add_u32 s71, s71, 589824
p2_noy:
    s_cmp_eq_u32 s80, 16
    s_cbranch_scc1 p2_noat
    s_cmp_lt_u32 s3, 192
    s_cbranch_scc1 p2_at
    s_and_b32 s86, s3, 7
    s_lshl_b32 s86, s86, 2
    s_add_u32 s86, s86, s6
    s_lshl_b32 s87, s73, 5
    s_add_u32 s86, s86, s87
    v_and_b32 v1, 63, v0
    v_lshlrev_b32 v2, 4, v1
    v_lshlrev_b32 v3, 3, v1
    s_lshl_b32 s87, s73, 8
    s_add_u32 s87, s87, 4096
    s_mov_b32 s88, -1
    s_mov_b32 s89, 0xffff
    s_mul_i32 s90, s86, 18432
    s_mul_i32 s91, s86, 1152
    v_mov_b32 v4, 0
    v_mov_b32 v5, 0
    s_mov_b64 exec, s[88:89]
    buffer_load_dwordx2 v[8:9], v3, s[56:59], s91 offen offset:0
    buffer_load_dwordx2 v[10:11], v3, s[56:59], s91 offen offset:384
    buffer_load_dwordx2 v[12:13], v3, s[56:59], s91 offen offset:768
    v_lshlrev_b32 v194, 2, v1
    s_cmp_lg_u32 s6, 0
    s_cbranch_scc1 pvo_5
pv_4:
    buffer_load_dword v195, v194, s[48:51], s87 offen sc1
    s_waitcnt vmcnt(0)
    v_cmp_eq_u32 vcc, 0, v195
    s_cbranch_vccz pvo_5
    s_cmp_eq_u32 s64, 0
    s_cbranch_scc1 pvo_5
    s_sub_u32 s64, s64, 1
    s_branch pv_4
pvo_5:
    s_barrier
    buffer_load_dwordx4 v[32:35], v2, s[8:11], s90 offen offset:0 sc1
    buffer_load_dwordx4 v[36:39], v2, s[8:11], s90 offen offset:768 sc1
    buffer_load_dwordx4 v[40:43], v2, s[8:11], s90 offen offset:1536 sc1
    s_add_u32 s90, s90, 2304
    buffer_load_dwordx4 v[44:47], v2, s[8:11], s90 offen offset:0 sc1
    buffer_load_dwordx4 v[48:51], v2, s[8:11], s90 offen offset:768 sc1
    buffer_load_dwordx4 v[52:55], v2, s[8:11], s90 offen offset:1536 sc1
    s_add_u32 s90, s90, 2304
    buffer_load_dwordx4 v[56:59], v2, s[8:11], s90 offen offset:0 sc1
    buffer_load_dwordx4 v[60:63], v2, s[8:11], s90 offen offset:768 sc1
    buffer_load_dwordx4 v[64:67], v2, s[8:11], s90 offen offset:1536 sc1
    s_add_u32 s90, s90, 2304
    buffer_load_dwordx4 v[68:71], v2, s[8:11], s90 offen offset:0 sc1
    buffer_load_dwordx4 v[72:75], v2, s[8:11], s90 offen offset:768 sc1
    buffer_load_dwordx4 v[76:79], v2, s[8:11], s90 offen offset:1536 sc1
    s_add_u32 s90, s90, 2304
    buffer_load_dwordx4 v[80:83], v2, s[8:11], s90 offen offset:0 sc1
    buffer_load_dwordx4 v[84:87], v2, s[8:11], s90 offen offset:768 sc1
    buffer_load_dwordx4 v[88:91], v2, s[8:11], s90 offen offset:1536 sc1
    s_add_u32 s90, s90, 2304
    buffer_load_dwordx4 v[92:95], v2, s[8:11], s90 offen offset:0 sc1
    buffer_load_dwordx4 v[96:99], v2, s[8:11], s90 offen offset:768 sc1
    buffer_load_dwordx4 v[100:103], v2, s[8:11], s90 offen offset:1536 sc1
    s_add_u32 s90, s90, 2304
    buffer_load_dwordx4 v[104:107], v2, s[8:11], s90 offen offset:0 sc1
    buffer_load_dwordx4 v[108:111], v2, s[8:11], s90 offen offset:768 sc1
    buffer_load_dwordx4 v[112:115], v2, s[8:11], s90 offen offset:1536 sc1
    s_add_u32 s90, s90, 2304
    buffer_load_dwordx4 v[116:119], v2, s[8:11], s90 offen offset:0 sc1
    buffer_load_dwordx4 v[120:123], v2, s[8:11], s90 offen offset:768 sc1
    buffer_load_dwordx4 v[124:127], v2, s[8:11], s90 offen offset:1536 sc1
    s_add_u32 s90, s90, 2304
    v_lshlrev_b32 v16, 16, v8
    v_and_b32 v17, 0xffff0000, v8
    v_lshlrev_b32 v18, 16, v9
    v_and_b32 v19, 0xffff0000, v9
    v_lshlrev_b32 v20, 16, v10
    v_and_b32 v21, 0xffff0000, v10
    v_lshlrev_b32 v22, 16, v11
    v_and_b32 v23, 0xffff0000, v11
    v_lshlrev_b32 v24, 16, v12
    v_and_b32 v25, 0xffff0000, v12
    v_lshlrev_b32 v26, 16, v13
    v_and_b32 v27, 0xffff0000, v13
    s_waitcnt vmcnt(21)
    v_pk_add_f32 v[16:17], v[16:17], v[32:33]
    v_pk_add_f32 v[18:19], v[18:19], v[34:35]
    v_pk_add_f32 v[20:21], v[20:21], v[36:37]
    v_pk_add_f32 v[22:23], v[22:23], v[38:39]
    v_pk_add_f32 v[24:25], v[24:25], v[40:41]
    v_pk_add_f32 v[26:27], v[26:27], v[42:43]
    s_waitcnt vmcnt(18)
    v_pk_add_f32 v[16:17], v[16:17], v[44:45]
    v_pk_add_f32 v[18:19], v[18:19], v[46:47]
    v_pk_add_f32 v[20:21], v[20:21], v[48:49]
    v_pk_add_f32 v[22:23], v[22:23], v[50:51]
    v_pk_add_f32 v[24:25], v[24:25], v[52:53]
    v_pk_add_f32 v[26:27], v[26:27], v[54:55]
    s_waitcnt vmcnt(15)
    v_pk_add_f32 v[16:17], v[16:17], v[56:57]
    v_pk_add_f32 v[18:19], v[18:19], v[58:59]
    v_pk_add_f32 v[20:21], v[20:21], v[60:61]
    v_pk_add_f32 v[22:23], v[22:23], v[62:63]
    v_pk_add_f32 v[24:25], v[24:25], v[64:65]
    v_pk_add_f32 v[26:27], v[26:27], v[66:67]
    s_waitcnt vmcnt(12)
    v_pk_add_f32 v[16:17], v[16:17], v[68:69]
    v_pk_add_f32 v[18:19], v[18:19], v[70:71]
    v_pk_add_f32 v[20:21], v[20:21], v[72:73]
    v_pk_add_f32 v[22:23], v[22:23], v[74:75]
    v_pk_add_f32 v[24:25], v[24:25], v[76:77]
    v_pk_add_f32 v[26:27], v[26:27], v[78:79]
    s_waitcnt vmcnt(9)
    v_pk_add_f32 v[16:17], v[16:17], v[80:81]
    v_pk_add_f32 v[18:19], v[18:19], v[82:83]
    v_pk_add_f32 v[20:21], v[20:21], v[84:85]
    v_pk_add_f32 v[22:23], v[22:23], v[86:87]
    v_pk_add_f32 v[24:25], v[24:25], v[88:89]
    v_pk_add_f32 v[26:27], v[26:27], v[90:91]
    s_waitcnt vmcnt(6)
    v_pk_add_f32 v[16:17], v[16:17], v[92:93]
    v_pk_add_f32 v[18:19], v[18:19], v[94:95]
    v_pk_add_f32 v[20:21], v[20:21], v[96:97]
    v_pk_add_f32 v[22:23], v[22:23], v[98:99]
    v_pk_add_f32 v[24:25], v[24:25], v[100:101]
    v_pk_add_f32 v[26:27], v[26:27], v[102:103]
    s_waitcnt vmcnt(3)
    v_pk_add_f32 v[16:17], v[16:17], v[104:105]
    v_pk_add_f32 v[18:19], v[18:19], v[106:107]
    v_pk_add_f32 v[20:21], v[20:21], v[108:109]
    v_pk_add_f32 v[22:23], v[22:23], v[110:111]
    v_pk_add_f32 v[24:25], v[24:25], v[112:113]
    v_pk_add_f32 v[26:27], v[26:27], v[114:115]
    s_waitcnt vmcnt(0)
    v_pk_add_f32 v[16:17], v[16:17], v[116:117]
    v_pk_add_f32 v[18:19], v[18:19], v[118:119]
    v_pk_add_f32 v[20:21], v[20:21], v[120:121]
    v_pk_add_f32 v[22:23], v[22:23], v[122:123]
    v_pk_add_f32 v[24:25], v[24:25], v[124:125]
    v_pk_add_f32 v[26:27], v[26:27], v[126:127]
    v_cvt_pk_bf16_f32 v8, v16, v17
    v_cvt_pk_bf16_f32 v9, v18, v19
    v_cvt_pk_bf16_f32 v10, v20, v21
    v_cvt_pk_bf16_f32 v11, v22, v23
    v_cvt_pk_bf16_f32 v12, v24, v25
    v_cvt_pk_bf16_f32 v13, v26, v27
    v_lshlrev_b32 v16, 16, v8
    v_and_b32 v17, 0xffff0000, v8
    v_lshlrev_b32 v18, 16, v9
    v_and_b32 v19, 0xffff0000, v9
    v_lshlrev_b32 v20, 16, v10
    v_and_b32 v21, 0xffff0000, v10
    v_lshlrev_b32 v22, 16, v11
    v_and_b32 v23, 0xffff0000, v11
    v_lshlrev_b32 v24, 16, v12
    v_and_b32 v25, 0xffff0000, v12
    v_lshlrev_b32 v26, 16, v13
    v_and_b32 v27, 0xffff0000, v13
    v_add_f32 v4, v4, v16
    v_add_f32 v4, v4, v17
    v_add_f32 v4, v4, v18
    v_add_f32 v4, v4, v19
    v_add_f32 v4, v4, v20
    v_add_f32 v4, v4, v21
    v_add_f32 v4, v4, v22
    v_add_f32 v4, v4, v23
    v_add_f32 v4, v4, v24
    v_add_f32 v4, v4, v25
    v_add_f32 v4, v4, v26
    v_add_f32 v4, v4, v27
    s_mov_b64 exec, -1
    s_nop 1
    v_add_f32_dpp v4, v4, v4 row_ror:8 row_mask:0xf bank_mask:0xf
    s_nop 1
    v_add_f32_dpp v4, v4, v4 row_ror:4 row_mask:0xf bank_mask:0xf
    s_nop 1
    v_add_f32_dpp v4, v4, v4 row_ror:2 row_mask:0xf bank_mask:0xf
    s_nop 1
    v_add_f32_dpp v4, v4, v4 row_ror:1 row_mask:0xf bank_mask:0xf
    v_mov_b32 v6, v4
    s_nop 1
    v_permlane16_swap_b32 v4, v6
    s_nop 0
    v_add_f32 v4, v4, v6
    v_mov_b32 v6, v4
    s_nop 1
    v_permlane32_swap_b32 v4, v6
    s_nop 0
    v_add_f32 v4, v4, v6
    v_mul_f32 v4, 0x3ae38e39, v4
    s_mov_b64 exec, s[88:89]
    v_sub_f32 v16, v16, v4
    v_fmac_f32 v5, v16, v16
    v_sub_f32 v17, v17, v4
    v_fmac_f32 v5, v17, v17
    v_sub_f32 v18, v18, v4
    v_fmac_f32 v5, v18, v18
    v_sub_f32 v19, v19, v4
    v_fmac_f32 v5, v19, v19
    v_sub_f32 v20, v20, v4
    v_fmac_f32 v5, v20, v20
    v_sub_f32 v21, v21, v4
    v_fmac_f32 v5, v21, v21
    v_sub_f32 v22, v22, v4
    v_fmac_f32 v5, v22, v22
    v_sub_f32 v23, v23, v4
    v_fmac_f32 v5, v23, v23
    v_sub_f32 v24, v24, v4
    v_fmac_f32 v5, v24, v24
    v_sub_f32 v25, v25, v4
    v_fmac_f32 v5, v25, v25
    v_sub_f32 v26, v26, v4
    v_fmac_f32 v5, v26, v26
    v_sub_f32 v27, v27, v4
    v_fmac_f32 v5, v27, v27
    s_mov_b64 exec, -1
    s_nop 1
    v_add_f32_dpp v5, v5, v5 row_ror:8 row_mask:0xf bank_mask:0xf
    s_nop 1
    v_add_f32_dpp v5, v5, v5 row_ror:4 row_mask:0xf bank_mask:0xf
    s_nop 1
    v_add_f32_dpp v5, v5, v5 row_ror:2 row_mask:0xf bank_mask:0xf
    s_nop 1
    v_add_f32_dpp v5, v5, v5 row_ror:1 row_mask:0xf bank_mask:0xf
    v_mov_b32 v6, v5
    s_nop 1
    v_permlane16_swap_b32 v5, v6
    s_nop 0
    v_add_f32 v5, v5, v6
    v_mov_b32 v6, v5
    s_nop 1
    v_permlane32_swap_b32 v5, v6
    s_nop 0
    v_add_f32 v5, v5, v6
    v_mul_f32 v5, 0x3ae38e39, v5
    s_mov_b64 exec, s[88:89]
    v_add_f32 v4, 0x3727c5ac, v5
    v_rsq_f32 v4, v4
    s_nop 0
    v_mul_f32 v5, v5, v4
    v_mul_f32 v5, v5, v4
    v_add_f32 v5, 0x3727c5ac, v5
    v_rsq_f32 v5, v5
    s_nop 0
    v_mul_f32 v4, v4, v5
    v_mul_f32 v16, v16, v4
    v_mul_f32 v17, v17, v4
    v_mul_f32 v18, v18, v4
    v_mul_f32 v19, v19, v4
    v_mul_f32 v20, v20, v4
    v_mul_f32 v21, v21, v4
    v_mul_f32 v22, v22, v4
    v_mul_f32 v23, v23, v4
    v_mul_f32 v24, v24, v4
    v_mul_f32 v25, v25, v4
    v_mul_f32 v26, v26, v4
    v_mul_f32 v27, v27, v4
    v_cvt_pk_bf16_f32 v16, v16, v17
    v_cvt_pk_bf16_f32 v17, v18, v19
    v_cvt_pk_bf16_f32 v18, v20, v21
    v_cvt_pk_bf16_f32 v19, v22, v23
    v_cvt_pk_bf16_f32 v20, v24, v25
    v_cvt_pk_bf16_f32 v21, v26, v27
    buffer_store_dwordx2 v[16:17], v3, s[12:15], s91 offen offset:0 sc1
    buffer_store_dwordx2 v[18:19], v3, s[12:15], s91 offen offset:384 sc1
    buffer_store_dwordx2 v[20:21], v3, s[12:15], s91 offen offset:768 sc1
    s_lshl_b32 s92, s3, 2
    s_lshl_b32 s93, s80, 13
    s_add_u32 s92, s92, s93
    s_add_u32 s92, s92, 130304
    s_mov_b64 exec, -1
    v_lshlrev_b32 v194, 7, v1
    v_mov_b32 v195, 1
    s_waitcnt vmcnt(0)
    s_barrier
    s_cmp_lg_u32 s6, 0
    s_cbranch_scc1 ln_nf
    s_mov_b64 exec, 65535
    buffer_store_dword v195, v194, s[48:51], s92 offen sc1
ln_nf:
    s_mov_b64 exec, s[88:89]
    buffer_store_dwordx2 v[8:9], v3, s[76:79], s91 offen offset:0
    buffer_store_dwordx2 v[10:11], v3, s[76:79], s91 offen offset:384
    buffer_store_dwordx2 v[12:13], v3, s[76:79], s91 offen offset:768
    s_mov_b64 exec, -1
    s_and_b32 s90, s3, 7
    s_lshl_b32 s91, s73, 3
    s_add_u32 s90, s90, s91
    s_mul_i32 s91, s90, 2304
    s_mul_i32 s90, s90, 36864
    v_lshlrev_b32 v2, 4, v0
    buffer_load_dwordx4 v[32:35], v2, s[20:23], s90 offen
    s_add_u32 s90, s90, 4096
    buffer_load_dwordx4 v[36:39], v2, s[20:23], s90 offen
    s_add_u32 s90, s90, 4096
    buffer_load_dwordx4 v[40:43], v2, s[20:23], s90 offen
    s_add_u32 s90, s90, 4096
    buffer_load_dwordx4 v[44:47], v2, s[20:23], s90 offen
    s_add_u32 s90, s90, 4096
    buffer_load_dwordx4 v[48:51], v2, s[20:23], s90 offen
    s_add_u32 s90, s90, 4096
    buffer_load_dwordx4 v[52:55], v2, s[20:23], s90 offen
    s_add_u32 s90, s90, 4096
    buffer_load_dwordx4 v[56:59], v2, s[20:23], s90 offen
    s_add_u32 s90, s90, 4096
    buffer_load_dwordx4 v[60:63], v2, s[20:23], s90 offen
    s_add_u32 s90, s90, 4096
    buffer_load_dwordx4 v[64:67], v2, s[20:23], s90 offen
    s_add_u32 s90, s90, 4096
    v_lshrrev_b32 v3, 4, v0
    v_mul_u32_u24 v3, 1179648, v3
    v_and_b32 v2, 0xf0, v2
    v_add_u32 v2, v2, v3
    s_add_u32 s40, s4, 119762944
    s_addc_u32 s41, s5, 0
    s_mov_b32 s42, 18874368
    s_mov_b32 s43, 0x00020000
    s_waitcnt vmcnt(8)
    buffer_store_dwordx4 v[32:35], v2, s[40:43], s91 offen offset:0
    s_waitcnt vmcnt(8)
    buffer_store_dwordx4 v[36:39], v2, s[40:43], s91 offen offset:256
    s_waitcnt vmcnt(8)
    buffer_store_dwordx4 v[40:43], v2, s[40:43], s91 offen offset:512
    s_waitcnt vmcnt(8)
    buffer_store_dwordx4 v[44:47], v2, s[40:43], s91 offen offset:768
    s_waitcnt vmcnt(8)
    buffer_store_dwordx4 v[48:51], v2, s[40:43], s91 offen offset:1024
    s_waitcnt vmcnt(8)
    buffer_store_dwordx4 v[52:55], v2, s[40:43], s91 offen offset:1280
    s_waitcnt vmcnt(8)
    buffer_store_dwordx4 v[56:59], v2, s[40:43], s91 offen offset:1536
    s_waitcnt vmcnt(8)
    buffer_store_dwordx4 v[60:63], v2, s[40:43], s91 offen offset:1792
    s_waitcnt vmcnt(8)
    buffer_store_dwordx4 v[64:67], v2, s[40:43], s91 offen offset:2048
    s_add_u32 s73, s73, 4
    s_branch p2_noat
p2_at:
    s_lshl_b32 s84, s80, 5
    s_add_u32 s84, s84, s82
    s_lshl_b32 s84, s84, 7
    s_bitset1_b32 s84, 16
    v_mov_b32 v194, 0
pv_6:
    buffer_load_dword v195, v194, s[48:51], s84 offen sc1
    s_waitcnt vmcnt(0)
    v_cmp_ne_u32 vcc, 2, v195
    s_cbranch_vccz pvo_7
    s_cmp_eq_u32 s64, 0
    s_cbranch_scc1 pvo_7
    s_sub_u32 s64, s64, 1
    s_branch pv_6
pvo_7:
    s_lshl_b32 s84, s73, 5
    s_add_u32 s84, s84, s82
    s_lshl_b32 s85, s82, 7
    s_add_u32 s85, s85, 28672
    v_and_b32 v1, 63, v0
    v_lshlrev_b32 v2, 4, v1
    s_lshl_b32 s40, s84, 13
    s_add_u32 s41, s40, 4096
    buffer_load_dwordx4 v[40:43], v2, s[32:35], s40 offen offset:0 sc1
    buffer_load_dwordx4 v[44:47], v2, s[32:35], s40 offen offset:1024 sc1
    buffer_load_dwordx4 v[48:51], v2, s[32:35], s40 offen offset:2048 sc1
    buffer_load_dwordx4 v[52:55], v2, s[32:35], s40 offen offset:3072 sc1
    buffer_load_dwordx4 v[56:59], v2, s[32:35], s41 offen offset:0 sc1
    buffer_load_dwordx4 v[60:63], v2, s[32:35], s41 offen offset:1024 sc1
    buffer_load_dwordx4 v[64:67], v2, s[32:35], s41 offen offset:2048 sc1
    buffer_load_dwordx4 v[68:71], v2, s[32:35], s41 offen offset:3072 sc1
    buffer_load_dwordx4 v[8:11], v2, s[28:31], s40 offen offset:0 sc1
    buffer_load_dwordx4 v[12:15], v2, s[28:31], s40 offen offset:1024 sc1
    buffer_load_dwordx4 v[16:19], v2, s[28:31], s40 offen offset:2048 sc1
    buffer_load_dwordx4 v[20:23], v2, s[28:31], s40 offen offset:3072 sc1
    buffer_load_dwordx4 v[24:27], v2, s[28:31], s41 offen offset:0 sc1
    buffer_load_dwordx4 v[28:31], v2, s[28:31], s41 offen offset:1024 sc1
    buffer_load_dwordx4 v[32:35], v2, s[28:31], s41 offen offset:2048 sc1
    buffer_load_dwordx4 v[36:39], v2, s[28:31], s41 offen offset:3072 sc1
    buffer_load_dwordx4 v[72:75], v2, s[36:39], s40 offen offset:0 sc1
    buffer_load_dwordx4 v[76:79], v2, s[36:39], s40 offen offset:1024 sc1
    buffer_load_dwordx4 v[80:83], v2, s[36:39], s40 offen offset:2048 sc1
    buffer_load_dwordx4 v[84:87], v2, s[36:39], s40 offen offset:3072 sc1
    buffer_load_dwordx4 v[88:91], v2, s[36:39], s41 offen offset:0 sc1
    buffer_load_dwordx4 v[92:95], v2, s[36:39], s41 offen offset:1024 sc1
    buffer_load_dwordx4 v[96:99], v2, s[36:39], s41 offen offset:2048 sc1
    buffer_load_dwordx4 v[100:103], v2, s[36:39], s41 offen offset:3072 sc1
    v_and_b32 v3, 15, v1
    v_lshrrev_b32 v4, 4, v1
    v_lshlrev_b32 v5, 2, v4
    v_sub_u32 v5, v3, v5
    s_waitcnt vmcnt(8)
    v_mfma_f32_16x16x32_bf16 v[140:143], v[40:43], v[8:11], 0
    v_mfma_f32_16x16x32_bf16 v[148:151], v[40:43], v[12:15], 0
    v_mfma_f32_16x16x32_bf16 v[152:155], v[44:47], v[12:15], 0
    v_mfma_f32_16x16x32_bf16 v[140:143], v[48:51], v[16:19], v[140:143]
    v_mfma_f32_16x16x32_bf16 v[148:151], v[48:51], v[20:23], v[148:151]
    v_mfma_f32_16x16x32_bf16 v[152:155], v[52:55], v[20:23], v[152:155]
    v_mfma_f32_16x16x32_bf16 v[140:143], v[56:59], v[24:27], v[140:143]
    v_mfma_f32_16x16x32_bf16 v[148:151], v[56:59], v[28:31], v[148:151]
    v_mfma_f32_16x16x32_bf16 v[152:155], v[60:63], v[28:31], v[152:155]
    v_mfma_f32_16x16x32_bf16 v[140:143], v[64:67], v[32:35], v[140:143]
    v_mfma_f32_16x16x32_bf16 v[148:151], v[64:67], v[36:39], v[148:151]
    v_mfma_f32_16x16x32_bf16 v[152:155], v[68:71], v[36:39], v[152:155]
pv_8:
    buffer_load_dword v195, v194, s[48:51], s85 offen sc1
    s_waitcnt vmcnt(0)
    v_cmp_ge_u32 vcc, s73, v195
    s_cbranch_vccz pvo_9
    s_cmp_eq_u32 s64, 0
    s_cbranch_scc1 pvo_9
    s_sub_u32 s64, s64, 1
    s_branch pv_8
pvo_9:
    buffer_load_dwordx4 v[104:107], v2, s[60:63], s40 offen offset:0 sc1
    buffer_load_dwordx4 v[108:111], v2, s[60:63], s40 offen offset:2048 sc1
    buffer_load_dwordx4 v[112:115], v2, s[60:63], s41 offen offset:0 sc1
    buffer_load_dwordx4 v[116:119], v2, s[60:63], s41 offen offset:2048 sc1
    buffer_load_dwordx4 v[120:123], v2, s[60:63], s40 offen offset:1024 sc1
    buffer_load_dwordx4 v[124:127], v2, s[60:63], s40 offen offset:3072 sc1
    buffer_load_dwordx4 v[128:131], v2, s[60:63], s41 offen offset:1024 sc1
    buffer_load_dwordx4 v[132:135], v2, s[60:63], s41 offen offset:3072 sc1
    s_waitcnt vmcnt(4)
    v_mfma_f32_16x16x32_bf16 v[136:139], v[104:107], v[8:11], 0
    v_mfma_f32_16x16x32_bf16 v[144:147], v[104:107], v[12:15], 0
    v_mfma_f32_16x16x32_bf16 v[136:139], v[108:111], v[16:19], v[136:139]
    v_mfma_f32_16x16x32_bf16 v[144:147], v[108:111], v[20:23], v[144:147]
    v_mfma_f32_16x16x32_bf16 v[136:139], v[112:115], v[24:27], v[136:139]
    v_mfma_f32_16x16x32_bf16 v[144:147], v[112:115], v[28:31], v[144:147]
    v_mfma_f32_16x16x32_bf16 v[136:139], v[116:119], v[32:35], v[136:139]
    v_mfma_f32_16x16x32_bf16 v[144:147], v[116:119], v[36:39], v[144:147]
    s_nop 7
    v_mov_b32 v7, 0xf149f2ca
    v_cmp_le_i32 vcc, 0, v5
    s_nop 1
    v_cndmask_b32 v140, v7, v140, vcc
    v_cndmask_b32 v152, v7, v152, vcc
    v_cmp_le_i32 vcc, 1, v5
    s_nop 1
    v_cndmask_b32 v141, v7, v141, vcc
    v_cndmask_b32 v153, v7, v153, vcc
    v_cmp_le_i32 vcc, 2, v5
    s_nop 1
    v_cndmask_b32 v142, v7, v142, vcc
    v_cndmask_b32 v154, v7, v154, vcc
    v_cmp_le_i32 vcc, 3, v5
    s_nop 1
    v_cndmask_b32 v143, v7, v143, vcc
    v_cndmask_b32 v155, v7, v155, vcc
    s_mov_b32 s44, 0x3e0293ee
    v_max_f32 v156, v136, v137
    v_max3_f32 v156, v156, v138, v139
    v_max3_f32 v156, v156, v140, v141
    v_max3_f32 v156, v156, v142, v143
    v_mov_b32 v157, v156
    s_nop 1
    v_permlane32_swap_b32 v156, v157
    s_nop 0
    v_max_f32 v156, v156, v157
    v_mov_b32 v157, v156
    s_nop 1
    v_permlane16_swap_b32 v156, v157
    s_nop 0
    v_max_f32 v156, v156, v157
    v_mul_f32 v156, s44, v156
    v_fma_f32 v136, v136, s44, -v156
    v_fma_f32 v137, v137, s44, -v156
    v_fma_f32 v138, v138, s44, -v156
    v_fma_f32 v139, v139, s44, -v156
    v_fma_f32 v140, v140, s44, -v156
    v_fma_f32 v141, v141, s44, -v156
    v_fma_f32 v142, v142, s44, -v156
    v_fma_f32 v143, v143, s44, -v156
    v_exp_f32 v136, v136
    v_exp_f32 v137, v137
    v_exp_f32 v138, v138
    v_exp_f32 v139, v139
    v_exp_f32 v140, v140
    v_exp_f32 v141, v141
    v_exp_f32 v142, v142
    v_exp_f32 v143, v143
    v_add_f32 v158, v136, v137
    v_add_f32 v158, v158, v138
    v_add_f32 v158, v158, v139
    v_mul_f32 v158, 0.5, v158
    v_add_f32 v158, v158, v140
    v_add_f32 v158, v158, v141
    v_add_f32 v158, v158, v142
    v_add_f32 v158, v158, v143
    v_mov_b32 v157, v158
    s_nop 1
    v_permlane32_swap_b32 v158, v157
    s_nop 0
    v_add_f32 v158, v158, v157
    v_mov_b32 v157, v158
    s_nop 1
    v_permlane16_swap_b32 v158, v157
    s_nop 0
    v_add_f32 v158, v158, v157
    v_rcp_f32 v158, v158
    s_nop 0
    v_mul_f32 v136, v136, v158
    v_mul_f32 v137, v137, v158
    v_mul_f32 v138, v138, v158
    v_mul_f32 v139, v139, v158
    v_mul_f32 v140, v140, v158
    v_mul_f32 v141, v141, v158
    v_mul_f32 v142, v142, v158
    v_mul_f32 v143, v143, v158
    v_cvt_pk_bf16_f32 v164, v136, v137
    v_cvt_pk_bf16_f32 v165, v138, v139
    v_cvt_pk_bf16_f32 v160, v140, v141
    v_cvt_pk_bf16_f32 v161, v142, v143
    v_mov_b32 v162, 0
    v_mov_b32 v163, 0
    v_max_f32 v156, v144, v145
    v_max3_f32 v156, v156, v146, v147
    v_max3_f32 v156, v156, v148, v149
    v_max3_f32 v156, v156, v150, v151
    v_max3_f32 v156, v156, v152, v153
    v_max3_f32 v156, v156, v154, v155
    v_mov_b32 v157, v156
    s_nop 1
    v_permlane32_swap_b32 v156, v157
    s_nop 0
    v_max_f32 v156, v156, v157
    v_mov_b32 v157, v156
    s_nop 1
    v_permlane16_swap_b32 v156, v157
    s_nop 0
    v_max_f32 v156, v156, v157
    v_mul_f32 v156, s44, v156
    v_fma_f32 v144, v144, s44, -v156
    v_fma_f32 v145, v145, s44, -v156
    v_fma_f32 v146, v146, s44, -v156
    v_fma_f32 v147, v147, s44, -v156
    v_fma_f32 v148, v148, s44, -v156
    v_fma_f32 v149, v149, s44, -v156
    v_fma_f32 v150, v150, s44, -v156
    v_fma_f32 v151, v151, s44, -v156
    v_fma_f32 v152, v152, s44, -v156
    v_fma_f32 v153, v153, s44, -v156
    v_fma_f32 v154, v154, s44, -v156
    v_fma_f32 v155, v155, s44, -v156
    v_exp_f32 v144, v144
    v_exp_f32 v145, v145
    v_exp_f32 v146, v146
    v_exp_f32 v147, v147
    v_exp_f32 v148, v148
    v_exp_f32 v149, v149
    v_exp_f32 v150, v150
    v_exp_f32 v151, v151
    v_exp_f32 v152, v152
    v_exp_f32 v153, v153
    v_exp_f32 v154, v154
    v_exp_f32 v155, v155
    v_add_f32 v158, v144, v145
    v_add_f32 v158, v158, v146
    v_add_f32 v158, v158, v147
    v_mul_f32 v158, 0.5, v158
    v_add_f32 v158, v158, v148
    v_add_f32 v158, v158, v149
    v_add_f32 v158, v158, v150
    v_add_f32 v158, v158, v151
    v_add_f32 v158, v158, v152
    v_add_f32 v158, v158, v153
    v_add_f32 v158, v158, v154
    v_add_f32 v158, v158, v155
    v_mov_b32 v157, v158
    s_nop 1
    v_permlane32_swap_b32 v158, v157
    s_nop 0
    v_add_f32 v158, v158, v157
    v_mov_b32 v157, v158
    s_nop 1
    v_permlane16_swap_b32 v158, v157
    s_nop 0
    v_add_f32 v158, v158, v157
    v_rcp_f32 v158, v158
    s_nop 0
    v_mul_f32 v144, v144, v158
    v_mul_f32 v145, v145, v158
    v_mul_f32 v146, v146, v158
    v_mul_f32 v147, v147, v158
    v_mul_f32 v148, v148, v158
    v_mul_f32 v149, v149, v158
    v_mul_f32 v150, v150, v158
    v_mul_f32 v151, v151, v158
    v_mul_f32 v152, v152, v158
    v_mul_f32 v153, v153, v158
    v_mul_f32 v154, v154, v158
    v_mul_f32 v155, v155, v158
    v_cvt_pk_bf16_f32 v172, v144, v145
    v_cvt_pk_bf16_f32 v173, v146, v147
    v_cvt_pk_bf16_f32 v168, v148, v149
    v_cvt_pk_bf16_f32 v169, v150, v151
    v_cvt_pk_bf16_f32 v170, v152, v153
    v_cvt_pk_bf16_f32 v171, v154, v155
    s_waitcnt vmcnt(0)
    s_nop 1
    v_mfma_f32_16x16x32_bf16 v[8:11], v[72:75], v[160:163], 0
    v_mfma_f32_16x16x32_bf16 v[12:15], v[76:79], v[160:163], 0
    v_mfma_f32_16x16x32_bf16 v[16:19], v[80:83], v[160:163], 0
    v_mfma_f32_16x16x32_bf16 v[20:23], v[84:87], v[160:163], 0
    v_mfma_f32_16x16x32_bf16 v[24:27], v[88:91], v[160:163], 0
    v_mfma_f32_16x16x32_bf16 v[28:31], v[92:95], v[160:163], 0
    v_mfma_f32_16x16x32_bf16 v[32:35], v[96:99], v[160:163], 0
    v_mfma_f32_16x16x32_bf16 v[36:39], v[100:103], v[160:163], 0
    v_mfma_f32_16x16x16_bf16 v[8:11], v[120:121], v[164:165], v[8:11]
    v_mfma_f32_16x16x16_bf16 v[12:15], v[124:125], v[164:165], v[12:15]
    v_mfma_f32_16x16x16_bf16 v[16:19], v[128:129], v[164:165], v[16:19]
    v_mfma_f32_16x16x16_bf16 v[20:23], v[132:133], v[164:165], v[20:23]
    v_mfma_f32_16x16x16_bf16 v[24:27], v[122:123], v[164:165], v[24:27]
    v_mfma_f32_16x16x16_bf16 v[28:31], v[126:127], v[164:165], v[28:31]
    v_mfma_f32_16x16x16_bf16 v[32:35], v[130:131], v[164:165], v[32:35]
    v_mfma_f32_16x16x16_bf16 v[36:39], v[134:135], v[164:165], v[36:39]
    v_mfma_f32_16x16x32_bf16 v[40:43], v[72:75], v[168:171], 0
    v_mfma_f32_16x16x32_bf16 v[44:47], v[76:79], v[168:171], 0
    v_mfma_f32_16x16x32_bf16 v[48:51], v[80:83], v[168:171], 0
    v_mfma_f32_16x16x32_bf16 v[52:55], v[84:87], v[168:171], 0
    v_mfma_f32_16x16x32_bf16 v[56:59], v[88:91], v[168:171], 0
    v_mfma_f32_16x16x32_bf16 v[60:63], v[92:95], v[168:171], 0
    v_mfma_f32_16x16x32_bf16 v[64:67], v[96:99], v[168:171], 0
    v_mfma_f32_16x16x32_bf16 v[68:71], v[100:103], v[168:171], 0
    v_mfma_f32_16x16x16_bf16 v[40:43], v[120:121], v[172:173], v[40:43]
    v_mfma_f32_16x16x16_bf16 v[44:47], v[124:125], v[172:173], v[44:47]
    v_mfma_f32_16x16x16_bf16 v[48:51], v[128:129], v[172:173], v[48:51]
    v_mfma_f32_16x16x16_bf16 v[52:55], v[132:133], v[172:173], v[52:55]
    v_mfma_f32_16x16x16_bf16 v[56:59], v[122:123], v[172:173], v[56:59]
    v_mfma_f32_16x16x16_bf16 v[60:63], v[126:127], v[172:173], v[60:63]
    v_mfma_f32_16x16x16_bf16 v[64:67], v[130:131], v[172:173], v[64:67]
    v_mfma_f32_16x16x16_bf16 v[68:71], v[134:135], v[172:173], v[68:71]
    s_nop 7
    v_cvt_pk_bf16_f32 v72, v8, v9
    v_cvt_pk_bf16_f32 v73, v10, v11
    v_cvt_pk_bf16_f32 v74, v12, v13
    v_cvt_pk_bf16_f32 v75, v14, v15
    v_cvt_pk_bf16_f32 v76, v16, v17
    v_cvt_pk_bf16_f32 v77, v18, v19
    v_cvt_pk_bf16_f32 v78, v20, v21
    v_cvt_pk_bf16_f32 v79, v22, v23
    v_cvt_pk_bf16_f32 v80, v24, v25
    v_cvt_pk_bf16_f32 v81, v26, v27
    v_cvt_pk_bf16_f32 v82, v28, v29
    v_cvt_pk_bf16_f32 v83, v30, v31
    v_cvt_pk_bf16_f32 v84, v32, v33
    v_cvt_pk_bf16_f32 v85, v34, v35
    v_cvt_pk_bf16_f32 v86, v36, v37
    v_cvt_pk_bf16_f32 v87, v38, v39
    v_cvt_pk_bf16_f32 v88, v40, v41
    v_cvt_pk_bf16_f32 v89, v42, v43
    v_cvt_pk_bf16_f32 v90, v44, v45
    v_cvt_pk_bf16_f32 v91, v46, v47
    v_cvt_pk_bf16_f32 v92, v48, v49
    v_cvt_pk_bf16_f32 v93, v50, v51
    v_cvt_pk_bf16_f32 v94, v52, v53
    v_cvt_pk_bf16_f32 v95, v54, v55
    v_cvt_pk_bf16_f32 v96, v56, v57
    v_cvt_pk_bf16_f32 v97, v58, v59
    v_cvt_pk_bf16_f32 v98, v60, v61
    v_cvt_pk_bf16_f32 v99, v62, v63
    v_cvt_pk_bf16_f32 v100, v64, v65
    v_cvt_pk_bf16_f32 v101, v66, v67
    v_cvt_pk_bf16_f32 v102, v68, v69
    v_cvt_pk_bf16_f32 v103, v70, v71
    s_nop 0
    v_mfma_f32_16x16x32_bf16 v[104:107], a[64:67], v[72:75], 0
    v_mfma_f32_16x16x32_bf16 v[108:111], a[68:71], v[72:75], 0
    v_mfma_f32_16x16x32_bf16 v[112:115], a[72:75], v[72:75], 0
    v_mfma_f32_16x16x32_bf16 v[116:119], a[76:79], v[72:75], 0
    v_mfma_f32_16x16x32_bf16 v[120:123], a[80:83], v[72:75], 0
    v_mfma_f32_16x16x32_bf16 v[124:127], a[84:87], v[72:75], 0
    v_mfma_f32_16x16x32_bf16 v[128:131], a[64:67], v[88:91], 0
    v_mfma_f32_16x16x32_bf16 v[132:135], a[68:71], v[88:91], 0
    v_mfma_f32_16x16x32_bf16 v[136:139], a[72:75], v[88:91], 0
    v_mfma_f32_16x16x32_bf16 v[140:143], a[76:79], v[88:91], 0
    v_mfma_f32_16x16x32_bf16 v[144:147], a[80:83], v[88:91], 0
    v_mfma_f32_16x16x32_bf16 v[148:151], a[84:87], v[88:91], 0
    v_mfma_f32_16x16x32_bf16 v[104:107], a[88:91], v[76:79], v[104:107]
    v_mfma_f32_16x16x32_bf16 v[108:111], a[92:95], v[76:79], v[108:111]
    v_mfma_f32_16x16x32_bf16 v[112:115], a[96:99], v[76:79], v[112:115]
    v_mfma_f32_16x16x32_bf16 v[116:119], a[100:103], v[76:79], v[116:119]
    v_mfma_f32_16x16x32_bf16 v[120:123], a[104:107], v[76:79], v[120:123]
    v_mfma_f32_16x16x32_bf16 v[124:127], a[108:111], v[76:79], v[124:127]
    v_mfma_f32_16x16x32_bf16 v[128:131], a[88:91], v[92:95], v[128:131]
    v_mfma_f32_16x16x32_bf16 v[132:135], a[92:95], v[92:95], v[132:135]
    v_mfma_f32_16x16x32_bf16 v[136:139], a[96:99], v[92:95], v[136:139]
    v_mfma_f32_16x16x32_bf16 v[140:143], a[100:103], v[92:95], v[140:143]
    v_mfma_f32_16x16x32_bf16 v[144:147], a[104:107], v[92:95], v[144:147]
    v_mfma_f32_16x16x32_bf16 v[148:151], a[108:111], v[92:95], v[148:151]
    v_mfma_f32_16x16x32_bf16 v[104:107], a[112:115], v[80:83], v[104:107]
    v_mfma_f32_16x16x32_bf16 v[108:111], a[116:119], v[80:83], v[108:111]
    v_mfma_f32_16x16x32_bf16 v[112:115], a[120:123], v[80:83], v[112:115]
    v_mfma_f32_16x16x32_bf16 v[116:119], a[124:127], v[80:83], v[116:119]
    v_mfma_f32_16x16x32_bf16 v[120:123], a[128:131], v[80:83], v[120:123]
    v_mfma_f32_16x16x32_bf16 v[124:127], a[132:135], v[80:83], v[124:127]
    v_mfma_f32_16x16x32_bf16 v[128:131], a[112:115], v[96:99], v[128:131]
    v_mfma_f32_16x16x32_bf16 v[132:135], a[116:119], v[96:99], v[132:135]
    v_mfma_f32_16x16x32_bf16 v[136:139], a[120:123], v[96:99], v[136:139]
    v_mfma_f32_16x16x32_bf16 v[140:143], a[124:127], v[96:99], v[140:143]
    v_mfma_f32_16x16x32_bf16 v[144:147], a[128:131], v[96:99], v[144:147]
    v_mfma_f32_16x16x32_bf16 v[148:151], a[132:135], v[96:99], v[148:151]
    v_mfma_f32_16x16x32_bf16 v[104:107], a[136:139], v[84:87], v[104:107]
    v_mfma_f32_16x16x32_bf16 v[108:111], a[140:143], v[84:87], v[108:111]
    v_mfma_f32_16x16x32_bf16 v[112:115], a[144:147], v[84:87], v[112:115]
    v_mfma_f32_16x16x32_bf16 v[116:119], a[148:151], v[84:87], v[116:119]
    v_mfma_f32_16x16x32_bf16 v[120:123], a[152:155], v[84:87], v[120:123]
    v_mfma_f32_16x16x32_bf16 v[124:127], a[156:159], v[84:87], v[124:127]
    v_mfma_f32_16x16x32_bf16 v[128:131], a[136:139], v[100:103], v[128:131]
    v_mfma_f32_16x16x32_bf16 v[132:135], a[140:143], v[100:103], v[132:135]
    v_mfma_f32_16x16x32_bf16 v[136:139], a[144:147], v[100:103], v[136:139]
    v_mfma_f32_16x16x32_bf16 v[140:143], a[148:151], v[100:103], v[140:143]
    v_mfma_f32_16x16x32_bf16 v[144:147], a[152:155], v[100:103], v[144:147]
    v_mfma_f32_16x16x32_bf16 v[148:151], a[156:159], v[100:103], v[148:151]
    s_mul_i32 s84, s73, 589824
    s_lshl_b32 s85, s73, 8
    s_add_u32 s85, s85, s83
    s_nop 2
    ds_write_b128 v196, v[104:107] offset:0
    ds_write_b128 v196, v[108:111] offset:64
    ds_write_b128 v196, v[112:115] offset:128
    ds_write_b128 v196, v[116:119] offset:192
    ds_write_b128 v196, v[120:123] offset:256
    ds_write_b128 v196, v[124:127] offset:320
    ds_write_b128 v196, v[128:131] offset:6400
    ds_write_b128 v196, v[132:135] offset:6464
    ds_write_b128 v196, v[136:139] offset:6528
    ds_write_b128 v196, v[140:143] offset:6592
    ds_write_b128 v196, v[144:147] offset:6656
    ds_write_b128 v196, v[148:151] offset:6720
    s_waitcnt lgkmcnt(0)
    s_barrier
    ds_read_b128 v[8:11], v197 offset:0
    ds_read_b128 v[12:15], v197 offset:12800
    ds_read_b128 v[16:19], v197 offset:25600
    ds_read_b128 v[20:23], v197 offset:38400
    ds_read_b128 v[24:27], v198 offset:0
    ds_read_b128 v[28:31], v198 offset:12800
    ds_read_b128 v[32:35], v198 offset:25600
    ds_read_b128 v[36:39], v198 offset:38400
    ds_read_b128 v[40:43], v199 offset:0
    ds_read_b128 v[44:47], v199 offset:12800
    ds_read_b128 v[48:51], v199 offset:25600
    ds_read_b128 v[52:55], v199 offset:38400
    s_waitcnt lgkmcnt(8)
    v_pk_add_f32 v[8:9], v[8:9], v[12:13]
    v_pk_add_f32 v[10:11], v[10:11], v[14:15]
    v_pk_add_f32 v[16:17], v[16:17], v[20:21]
    v_pk_add_f32 v[18:19], v[18:19], v[22:23]
    v_pk_add_f32 v[8:9], v[8:9], v[16:17]
    v_pk_add_f32 v[10:11], v[10:11], v[18:19]
    buffer_store_dwordx4 v[8:11], v200, s[8:11], s84 offen sc1
    s_waitcnt lgkmcnt(4)
    v_pk_add_f32 v[24:25], v[24:25], v[28:29]
    v_pk_add_f32 v[26:27], v[26:27], v[30:31]
    v_pk_add_f32 v[32:33], v[32:33], v[36:37]
    v_pk_add_f32 v[34:35], v[34:35], v[38:39]
    v_pk_add_f32 v[24:25], v[24:25], v[32:33]
    v_pk_add_f32 v[26:27], v[26:27], v[34:35]
    buffer_store_dwordx4 v[24:27], v201, s[8:11], s84 offen sc1
    s_waitcnt lgkmcnt(0)
    v_pk_add_f32 v[40:41], v[40:41], v[44:45]
    v_pk_add_f32 v[42:43], v[42:43], v[46:47]
    v_pk_add_f32 v[48:49], v[48:49], v[52:53]
    v_pk_add_f32 v[50:51], v[50:51], v[54:55]
    v_pk_add_f32 v[40:41], v[40:41], v[48:49]
    v_pk_add_f32 v[42:43], v[42:43], v[50:51]
    buffer_store_dwordx4 v[40:43], v202, s[8:11], s84 offen sc1
    s_waitcnt vmcnt(0)
    s_barrier
    s_add_u32 s73, s73, 4
    s_cmp_lg_u32 s6, 0
    s_cbranch_scc1 p2_noat
    v_mov_b32 v194, 0
    v_mov_b32 v195, 1
    s_mov_b64 exec, 1
    buffer_store_dword v195, v194, s[48:51], s85 offen sc1
    s_mov_b64 exec, -1
p2_noat:
    s_cmp_eq_u32 s80, 0
    s_cbranch_scc1 p2_next
    s_cmp_ge_u32 s3, 216
    s_cbranch_scc1 p2_next
    v_and_b32 v194, 31, v0
    v_lshlrev_b32 v194, 2, v194
    s_cmp_lg_u32 s6, 0
    s_cbranch_scc1 pvo_11
pv_10:
    buffer_load_dword v195, v194, s[48:51], s81 offen sc1
    s_waitcnt vmcnt(0)
    v_cmp_eq_u32 vcc, 0, v195
    s_cbranch_vccz pvo_11
    s_cmp_eq_u32 s64, 0
    s_cbranch_scc1 pvo_11
    s_sub_u32 s64, s64, 1
    s_branch pv_10
pvo_11:
    s_barrier
    s_add_u32 s81, s81, 8192
    s_add_u32 m0, s7, 0
    s_nop 0
    buffer_load_dwordx4 v204, s[12:15], s70 offen sc1 lds
    s_add_u32 m0, s7, 4096
    s_nop 0
    buffer_load_dwordx4 v205, s[12:15], s70 offen sc1 lds
    s_add_u32 m0, s7, 8192
    s_nop 0
    buffer_load_dwordx4 v206, s[12:15], s70 offen sc1 lds
    s_add_u32 s70, s70, 73728
    s_add_u32 m0, s7, 28672
    s_nop 0
    buffer_load_dwordx4 v204, s[12:15], s70 offen sc1 lds
    s_add_u32 m0, s7, 32768
    s_nop 0
    buffer_load_dwordx4 v205, s[12:15], s70 offen sc1 lds
    s_add_u32 m0, s7, 36864
    s_nop 0
    buffer_load_dwordx4 v206, s[12:15], s70 offen sc1 lds
    s_add_u32 s70, s70, 73728
    s_waitcnt vmcnt(0)
    s_barrier
    ds_read_b64_tr_b16 v[8:9], v213 offset:12288
    ds_read_b64_tr_b16 v[10:11], v213 offset:13312
    ds_read_b64_tr_b16 v[12:13], v207 offset:0
    ds_read_b64_tr_b16 v[14:15], v207 offset:768
    ds_read_b64_tr_b16 v[16:17], v214 offset:12288
    ds_read_b64_tr_b16 v[18:19], v214 offset:13312
    ds_read_b64_tr_b16 v[20:21], v215 offset:12288
    ds_read_b64_tr_b16 v[22:23], v215 offset:13312
    ds_read_b64_tr_b16 v[24:25], v216 offset:12288
    ds_read_b64_tr_b16 v[26:27], v216 offset:13312
    ds_read_b64_tr_b16 v[28:29], v208 offset:0
    ds_read_b64_tr_b16 v[30:31], v208 offset:768
    s_waitcnt lgkmcnt(8)
    v_mfma_f32_16x16x32_bf16 a[0:3], v[8:11], v[12:15], a[0:3]
    ds_read_b64_tr_b16 v[32:33], v207 offset:64
    ds_read_b64_tr_b16 v[34:35], v207 offset:832
    s_waitcnt lgkmcnt(8)
    v_mfma_f32_16x16x32_bf16 a[4:7], v[16:19], v[12:15], a[4:7]
    ds_read_b64_tr_b16 v[36:37], v213 offset:20480
    ds_read_b64_tr_b16 v[38:39], v213 offset:21504
    s_waitcnt lgkmcnt(8)
    v_mfma_f32_16x16x32_bf16 a[8:11], v[20:23], v[12:15], a[8:11]
    ds_read_b64_tr_b16 v[40:41], v207 offset:6144
    ds_read_b64_tr_b16 v[42:43], v207 offset:6912
    s_waitcnt lgkmcnt(8)
    v_mfma_f32_16x16x32_bf16 a[12:15], v[24:27], v[12:15], a[12:15]
    ds_read_b64_tr_b16 v[44:45], v214 offset:20480
    ds_read_b64_tr_b16 v[46:47], v214 offset:21504
    s_waitcnt lgkmcnt(8)
    v_mfma_f32_16x16x32_bf16 a[16:19], v[8:11], v[28:31], a[16:19]
    ds_read_b64_tr_b16 v[48:49], v215 offset:20480
    ds_read_b64_tr_b16 v[50:51], v215 offset:21504
    v_mfma_f32_16x16x32_bf16 a[20:23], v[16:19], v[28:31], a[20:23]
    ds_read_b64_tr_b16 v[52:53], v216 offset:20480
    ds_read_b64_tr_b16 v[54:55], v216 offset:21504
    v_mfma_f32_16x16x32_bf16 a[24:27], v[20:23], v[28:31], a[24:27]
    ds_read_b64_tr_b16 v[56:57], v208 offset:6144
    ds_read_b64_tr_b16 v[58:59], v208 offset:6912
    v_mfma_f32_16x16x32_bf16 a[28:31], v[24:27], v[28:31], a[28:31]
    ds_read_b64_tr_b16 v[60:61], v207 offset:6208
    ds_read_b64_tr_b16 v[62:63], v207 offset:6976
    s_waitcnt lgkmcnt(14)
    v_mfma_f32_16x16x32_bf16 a[32:35], v[8:11], v[32:35], a[32:35]
    v_mfma_f32_16x16x32_bf16 a[36:39], v[16:19], v[32:35], a[36:39]
    v_mfma_f32_16x16x32_bf16 a[40:43], v[20:23], v[32:35], a[40:43]
    v_mfma_f32_16x16x32_bf16 a[44:47], v[24:27], v[32:35], a[44:47]
    s_waitcnt lgkmcnt(10)
    v_mfma_f32_16x16x32_bf16 a[0:3], v[36:39], v[40:43], a[0:3]
    s_waitcnt lgkmcnt(8)
    v_mfma_f32_16x16x32_bf16 a[4:7], v[44:47], v[40:43], a[4:7]
    s_waitcnt lgkmcnt(6)
    v_mfma_f32_16x16x32_bf16 a[8:11], v[48:51], v[40:43], a[8:11]
    s_waitcnt lgkmcnt(4)
    v_mfma_f32_16x16x32_bf16 a[12:15], v[52:55], v[40:43], a[12:15]
    s_waitcnt lgkmcnt(2)
    v_mfma_f32_16x16x32_bf16 a[16:19], v[36:39], v[56:59], a[16:19]
    v_mfma_f32_16x16x32_bf16 a[20:23], v[44:47], v[56:59], a[20:23]
    v_mfma_f32_16x16x32_bf16 a[24:27], v[48:51], v[56:59], a[24:27]
    v_mfma_f32_16x16x32_bf16 a[28:31], v[52:55], v[56:59], a[28:31]
    s_waitcnt lgkmcnt(0)
    v_mfma_f32_16x16x32_bf16 a[32:35], v[36:39], v[60:63], a[32:35]
    v_mfma_f32_16x16x32_bf16 a[36:39], v[44:47], v[60:63], a[36:39]
    v_mfma_f32_16x16x32_bf16 a[40:43], v[48:51], v[60:63], a[40:43]
    v_mfma_f32_16x16x32_bf16 a[44:47], v[52:55], v[60:63], a[44:47]
    ds_read_b64_tr_b16 v[8:9], v213 offset:40960
    ds_read_b64_tr_b16 v[10:11], v213 offset:41984
    ds_read_b64_tr_b16 v[12:13], v207 offset:28672
    ds_read_b64_tr_b16 v[14:15], v207 offset:29440
    ds_read_b64_tr_b16 v[16:17], v214 offset:40960
    ds_read_b64_tr_b16 v[18:19], v214 offset:41984
    ds_read_b64_tr_b16 v[20:21], v215 offset:40960
    ds_read_b64_tr_b16 v[22:23], v215 offset:41984
    ds_read_b64_tr_b16 v[24:25], v216 offset:40960
    ds_read_b64_tr_b16 v[26:27], v216 offset:41984
    ds_read_b64_tr_b16 v[28:29], v208 offset:28672
    ds_read_b64_tr_b16 v[30:31], v208 offset:29440
    s_waitcnt lgkmcnt(8)
    v_mfma_f32_16x16x32_bf16 a[0:3], v[8:11], v[12:15], a[0:3]
    ds_read_b64_tr_b16 v[32:33], v207 offset:28736
    ds_read_b64_tr_b16 v[34:35], v207 offset:29504
    s_waitcnt lgkmcnt(8)
    v_mfma_f32_16x16x32_bf16 a[4:7], v[16:19], v[12:15], a[4:7]
    ds_read_b64_tr_b16 v[36:37], v213 offset:49152
    ds_read_b64_tr_b16 v[38:39], v213 offset:50176
    s_waitcnt lgkmcnt(8)
    v_mfma_f32_16x16x32_bf16 a[8:11], v[20:23], v[12:15], a[8:11]
    ds_read_b64_tr_b16 v[40:41], v207 offset:34816
    ds_read_b64_tr_b16 v[42:43], v207 offset:35584
    s_waitcnt lgkmcnt(8)
    v_mfma_f32_16x16x32_bf16 a[12:15], v[24:27], v[12:15], a[12:15]
    ds_read_b64_tr_b16 v[44:45], v214 offset:49152
    ds_read_b64_tr_b16 v[46:47], v214 offset:50176
    s_waitcnt lgkmcnt(8)
    v_mfma_f32_16x16x32_bf16 a[16:19], v[8:11], v[28:31], a[16:19]
    ds_read_b64_tr_b16 v[48:49], v215 offset:49152
    ds_read_b64_tr_b16 v[50:51], v215 offset:50176
    v_mfma_f32_16x16x32_bf16 a[20:23], v[16:19], v[28:31], a[20:23]
    ds_read_b64_tr_b16 v[52:53], v216 offset:49152
    ds_read_b64_tr_b16 v[54:55], v216 offset:50176
    v_mfma_f32_16x16x32_bf16 a[24:27], v[20:23], v[28:31], a[24:27]
    ds_read_b64_tr_b16 v[56:57], v208 offset:34816
    ds_read_b64_tr_b16 v[58:59], v208 offset:35584
    v_mfma_f32_16x16x32_bf16 a[28:31], v[24:27], v[28:31], a[28:31]
    ds_read_b64_tr_b16 v[60:61], v207 offset:34880
    ds_read_b64_tr_b16 v[62:63], v207 offset:35648
    s_waitcnt lgkmcnt(14)
    v_mfma_f32_16x16x32_bf16 a[32:35], v[8:11], v[32:35], a[32:35]
    v_mfma_f32_16x16x32_bf16 a[36:39], v[16:19], v[32:35], a[36:39]
    v_mfma_f32_16x16x32_bf16 a[40:43], v[20:23], v[32:35], a[40:43]
    v_mfma_f32_16x16x32_bf16 a[44:47], v[24:27], v[32:35], a[44:47]
    s_waitcnt lgkmcnt(10)
    v_mfma_f32_16x16x32_bf16 a[0:3], v[36:39], v[40:43], a[0:3]
    s_waitcnt lgkmcnt(8)
    v_mfma_f32_16x16x32_bf16 a[4:7], v[44:47], v[40:43], a[4:7]
    s_waitcnt lgkmcnt(6)
    v_mfma_f32_16x16x32_bf16 a[8:11], v[48:51], v[40:43], a[8:11]
    s_waitcnt lgkmcnt(4)
    v_mfma_f32_16x16x32_bf16 a[12:15], v[52:55], v[40:43], a[12:15]
    s_waitcnt lgkmcnt(2)
    v_mfma_f32_16x16x32_bf16 a[16:19], v[36:39], v[56:59], a[16:19]
    v_mfma_f32_16x16x32_bf16 a[20:23], v[44:47], v[56:59], a[20:23]
    v_mfma_f32_16x16x32_bf16 a[24:27], v[48:51], v[56:59], a[24:27]
    v_mfma_f32_16x16x32_bf16 a[28:31], v[52:55], v[56:59], a[28:31]
    s_waitcnt lgkmcnt(0)
    v_mfma_f32_16x16x32_bf16 a[32:35], v[36:39], v[60:63], a[32:35]
    v_mfma_f32_16x16x32_bf16 a[36:39], v[44:47], v[60:63], a[36:39]
    v_mfma_f32_16x16x32_bf16 a[40:43], v[48:51], v[60:63], a[40:43]
    v_mfma_f32_16x16x32_bf16 a[44:47], v[52:55], v[60:63], a[44:47]
    s_barrier
p2_next:
    s_add_u32 s80, s80, 1
    s_cmp_le_u32 s80, 16
    s_cbranch_scc1 p2_loop
    s_cmp_lt_u32 s3, 216
    s_cbranch_scc1 p2_epi
    s_endpgm
p2_epi:
    s_nop 7
    v_accvgpr_read_b32 v32, a0
    v_accvgpr_read_b32 v33, a1
    v_accvgpr_read_b32 v34, a2
    v_accvgpr_read_b32 v35, a3
    v_accvgpr_read_b32 v36, a4
    v_accvgpr_read_b32 v37, a5
    v_accvgpr_read_b32 v38, a6
    v_accvgpr_read_b32 v39, a7
    v_accvgpr_read_b32 v40, a8
    v_accvgpr_read_b32 v41, a9
    v_accvgpr_read_b32 v42, a10
    v_accvgpr_read_b32 v43, a11
    v_accvgpr_read_b32 v44, a12
    v_accvgpr_read_b32 v45, a13
    v_accvgpr_read_b32 v46, a14
    v_accvgpr_read_b32 v47, a15
    v_accvgpr_read_b32 v48, a16
    v_accvgpr_read_b32 v49, a17
    v_accvgpr_read_b32 v50, a18
    v_accvgpr_read_b32 v51, a19
    v_accvgpr_read_b32 v52, a20
    v_accvgpr_read_b32 v53, a21
    v_accvgpr_read_b32 v54, a22
    v_accvgpr_read_b32 v55, a23
    v_accvgpr_read_b32 v56, a24
    v_accvgpr_read_b32 v57, a25
    v_accvgpr_read_b32 v58, a26
    v_accvgpr_read_b32 v59, a27
    v_accvgpr_read_b32 v60, a28
    v_accvgpr_read_b32 v61, a29
    v_accvgpr_read_b32 v62, a30
    v_accvgpr_read_b32 v63, a31
    v_accvgpr_read_b32 v64, a32
    v_accvgpr_read_b32 v65, a33
    v_accvgpr_read_b32 v66, a34
    v_accvgpr_read_b32 v67, a35
    v_accvgpr_read_b32 v68, a36
    v_accvgpr_read_b32 v69, a37
    v_accvgpr_read_b32 v70, a38
    v_accvgpr_read_b32 v71, a39
    v_accvgpr_read_b32 v72, a40
    v_accvgpr_read_b32 v73, a41
    v_accvgpr_read_b32 v74, a42
    v_accvgpr_read_b32 v75, a43
    v_accvgpr_read_b32 v76, a44
    v_accvgpr_read_b32 v77, a45
    v_accvgpr_read_b32 v78, a46
    v_accvgpr_read_b32 v79, a47
    v_and_b32 v2, 15, v0
    v_bfe_u32 v3, v0, 4, 2
    s_lshl_b32 s42, s66, 3
    s_add_u32 s42, s42, s69
    s_lshl_b32 s42, s42, 5
    v_lshlrev_b32 v4, 3, v3
    s_lshr_b32 s43, s67, 1
    s_mul_i32 s43, s43, 72
    s_lshr_b32 s45, s42, 7
    s_add_u32 s43, s43, s45
    s_lshl_b32 s43, s43, 1
    s_and_b32 s45, s67, 1
    s_add_u32 s43, s43, s45
    s_mul_i32 s43, s43, 6
    s_add_u32 s43, s43, s68
    s_lshl_b32 s43, s43, 11
    v_lshlrev_b32 v5, 7, v2
    v_lshl_add_u32 v5, v3, 4, v5
    s_waitcnt vmcnt(0)
    v_lshlrev_b32 v88, 16, v176
    v_and_b32 v89, 0xffff0000, v176
    v_lshlrev_b32 v90, 16, v177
    v_and_b32 v91, 0xffff0000, v177
    v_lshlrev_b32 v92, 16, v178
    v_and_b32 v93, 0xffff0000, v178
    v_lshlrev_b32 v94, 16, v179
    v_and_b32 v95, 0xffff0000, v179
    v_lshlrev_b32 v96, 16, v180
    v_and_b32 v97, 0xffff0000, v180
    v_lshlrev_b32 v98, 16, v181
    v_and_b32 v99, 0xffff0000, v181
    v_lshlrev_b32 v100, 16, v182
    v_and_b32 v101, 0xffff0000, v182
    v_lshlrev_b32 v102, 16, v183
    v_and_b32 v103, 0xffff0000, v183
    s_mov_b32 s45, 0xbdd2d3e8
    v_mov_b32 v6, 0xc0135761
    v_add_f32 v32, v32, v88
    v_add_f32 v33, v33, v89
    v_add_f32 v34, v34, v90
    v_add_f32 v35, v35, v91
    v_mul_f32 v104, v32, v32
    v_mul_f32 v105, v33, v33
    v_mul_f32 v106, v34, v34
    v_mul_f32 v107, v35, v35
    v_fma_f32 v104, v104, s45, v6
    v_fma_f32 v105, v105, s45, v6
    v_fma_f32 v106, v106, s45, v6
    v_fma_f32 v107, v107, s45, v6
    v_mul_f32 v104, v104, v32
    v_mul_f32 v105, v105, v33
    v_mul_f32 v106, v106, v34
    v_mul_f32 v107, v107, v35
    v_exp_f32 v104, v104
    v_exp_f32 v105, v105
    v_exp_f32 v106, v106
    v_exp_f32 v107, v107
    v_add_f32 v104, 1.0, v104
    v_add_f32 v105, 1.0, v105
    v_add_f32 v106, 1.0, v106
    v_add_f32 v107, 1.0, v107
    v_rcp_f32 v104, v104
    v_rcp_f32 v105, v105
    v_rcp_f32 v106, v106
    v_rcp_f32 v107, v107
    v_mul_f32 v32, v32, v104
    v_mul_f32 v33, v33, v105
    v_mul_f32 v34, v34, v106
    v_mul_f32 v35, v35, v107
    v_add_f32 v36, v36, v92
    v_add_f32 v37, v37, v93
    v_add_f32 v38, v38, v94
    v_add_f32 v39, v39, v95
    v_mul_f32 v104, v36, v36
    v_mul_f32 v105, v37, v37
    v_mul_f32 v106, v38, v38
    v_mul_f32 v107, v39, v39
    v_fma_f32 v104, v104, s45, v6
    v_fma_f32 v105, v105, s45, v6
    v_fma_f32 v106, v106, s45, v6
    v_fma_f32 v107, v107, s45, v6
    v_mul_f32 v104, v104, v36
    v_mul_f32 v105, v105, v37
    v_mul_f32 v106, v106, v38
    v_mul_f32 v107, v107, v39
    v_exp_f32 v104, v104
    v_exp_f32 v105, v105
    v_exp_f32 v106, v106
    v_exp_f32 v107, v107
    v_add_f32 v104, 1.0, v104
    v_add_f32 v105, 1.0, v105
    v_add_f32 v106, 1.0, v106
    v_add_f32 v107, 1.0, v107
    v_rcp_f32 v104, v104
    v_rcp_f32 v105, v105
    v_rcp_f32 v106, v106
    v_rcp_f32 v107, v107
    v_mul_f32 v36, v36, v104
    v_mul_f32 v37, v37, v105
    v_mul_f32 v38, v38, v106
    v_mul_f32 v39, v39, v107
    v_add_f32 v40, v40, v96
    v_add_f32 v41, v41, v97
    v_add_f32 v42, v42, v98
    v_add_f32 v43, v43, v99
    v_mul_f32 v104, v40, v40
    v_mul_f32 v105, v41, v41
    v_mul_f32 v106, v42, v42
    v_mul_f32 v107, v43, v43
    v_fma_f32 v104, v104, s45, v6
    v_fma_f32 v105, v105, s45, v6
    v_fma_f32 v106, v106, s45, v6
    v_fma_f32 v107, v107, s45, v6
    v_mul_f32 v104, v104, v40
    v_mul_f32 v105, v105, v41
    v_mul_f32 v106, v106, v42
    v_mul_f32 v107, v107, v43
    v_exp_f32 v104, v104
    v_exp_f32 v105, v105
    v_exp_f32 v106, v106
    v_exp_f32 v107, v107
    v_add_f32 v104, 1.0, v104
    v_add_f32 v105, 1.0, v105
    v_add_f32 v106, 1.0, v106
    v_add_f32 v107, 1.0, v107
    v_rcp_f32 v104, v104
    v_rcp_f32 v105, v105
    v_rcp_f32 v106, v106
    v_rcp_f32 v107, v107
    v_mul_f32 v40, v40, v104
    v_mul_f32 v41, v41, v105
    v_mul_f32 v42, v42, v106
    v_mul_f32 v43, v43, v107
    v_add_f32 v44, v44, v100
    v_add_f32 v45, v45, v101
    v_add_f32 v46, v46, v102
    v_add_f32 v47, v47, v103
    v_mul_f32 v104, v44, v44
    v_mul_f32 v105, v45, v45
    v_mul_f32 v106, v46, v46
    v_mul_f32 v107, v47, v47
    v_fma_f32 v104, v104, s45, v6
    v_fma_f32 v105, v105, s45, v6
    v_fma_f32 v106, v106, s45, v6
    v_fma_f32 v107, v107, s45, v6
    v_mul_f32 v104, v104, v44
    v_mul_f32 v105, v105, v45
    v_mul_f32 v106, v106, v46
    v_mul_f32 v107, v107, v47
    v_exp_f32 v104, v104
    v_exp_f32 v105, v105
    v_exp_f32 v106, v106
    v_exp_f32 v107, v107
    v_add_f32 v104, 1.0, v104
    v_add_f32 v105, 1.0, v105
    v_add_f32 v106, 1.0, v106
    v_add_f32 v107, 1.0, v107
    v_rcp_f32 v104, v104
    v_rcp_f32 v105, v105
    v_rcp_f32 v106, v106
    v_rcp_f32 v107, v107
    v_mul_f32 v44, v44, v104
    v_mul_f32 v45, v45, v105
    v_mul_f32 v46, v46, v106
    v_mul_f32 v47, v47, v107
    v_cvt_pk_bf16_f32 v32, v32, v33
    v_cvt_pk_bf16_f32 v33, v34, v35
    v_cvt_pk_bf16_f32 v34, v36, v37
    v_cvt_pk_bf16_f32 v35, v38, v39
    buffer_store_dwordx4 v[32:35], v5, s[24:27], s43 offen offset:0
    v_cvt_pk_bf16_f32 v40, v40, v41
    v_cvt_pk_bf16_f32 v41, v42, v43
    v_cvt_pk_bf16_f32 v42, v44, v45
    v_cvt_pk_bf16_f32 v43, v46, v47
    buffer_store_dwordx4 v[40:43], v5, s[24:27], s43 offen offset:64
    s_add_u32 s43, s43, 2048
    v_add_f32 v48, v48, v88
    v_add_f32 v49, v49, v89
    v_add_f32 v50, v50, v90
    v_add_f32 v51, v51, v91
    v_mul_f32 v104, v48, v48
    v_mul_f32 v105, v49, v49
    v_mul_f32 v106, v50, v50
    v_mul_f32 v107, v51, v51
    v_fma_f32 v104, v104, s45, v6
    v_fma_f32 v105, v105, s45, v6
    v_fma_f32 v106, v106, s45, v6
    v_fma_f32 v107, v107, s45, v6
    v_mul_f32 v104, v104, v48
    v_mul_f32 v105, v105, v49
    v_mul_f32 v106, v106, v50
    v_mul_f32 v107, v107, v51
    v_exp_f32 v104, v104
    v_exp_f32 v105, v105
    v_exp_f32 v106, v106
    v_exp_f32 v107, v107
    v_add_f32 v104, 1.0, v104
    v_add_f32 v105, 1.0, v105
    v_add_f32 v106, 1.0, v106
    v_add_f32 v107, 1.0, v107
    v_rcp_f32 v104, v104
    v_rcp_f32 v105, v105
    v_rcp_f32 v106, v106
    v_rcp_f32 v107, v107
    v_mul_f32 v48, v48, v104
    v_mul_f32 v49, v49, v105
    v_mul_f32 v50, v50, v106
    v_mul_f32 v51, v51, v107
    v_add_f32 v52, v52, v92
    v_add_f32 v53, v53, v93
    v_add_f32 v54, v54, v94
    v_add_f32 v55, v55, v95
    v_mul_f32 v104, v52, v52
    v_mul_f32 v105, v53, v53
    v_mul_f32 v106, v54, v54
    v_mul_f32 v107, v55, v55
    v_fma_f32 v104, v104, s45, v6
    v_fma_f32 v105, v105, s45, v6
    v_fma_f32 v106, v106, s45, v6
    v_fma_f32 v107, v107, s45, v6
    v_mul_f32 v104, v104, v52
    v_mul_f32 v105, v105, v53
    v_mul_f32 v106, v106, v54
    v_mul_f32 v107, v107, v55
    v_exp_f32 v104, v104
    v_exp_f32 v105, v105
    v_exp_f32 v106, v106
    v_exp_f32 v107, v107
    v_add_f32 v104, 1.0, v104
    v_add_f32 v105, 1.0, v105
    v_add_f32 v106, 1.0, v106
    v_add_f32 v107, 1.0, v107
    v_rcp_f32 v104, v104
    v_rcp_f32 v105, v105
    v_rcp_f32 v106, v106
    v_rcp_f32 v107, v107
    v_mul_f32 v52, v52, v104
    v_mul_f32 v53, v53, v105
    v_mul_f32 v54, v54, v106
    v_mul_f32 v55, v55, v107
    v_add_f32 v56, v56, v96
    v_add_f32 v57, v57, v97
    v_add_f32 v58, v58, v98
    v_add_f32 v59, v59, v99
    v_mul_f32 v104, v56, v56
    v_mul_f32 v105, v57, v57
    v_mul_f32 v106, v58, v58
    v_mul_f32 v107, v59, v59
    v_fma_f32 v104, v104, s45, v6
    v_fma_f32 v105, v105, s45, v6
    v_fma_f32 v106, v106, s45, v6
    v_fma_f32 v107, v107, s45, v6
    v_mul_f32 v104, v104, v56
    v_mul_f32 v105, v105, v57
    v_mul_f32 v106, v106, v58
    v_mul_f32 v107, v107, v59
    v_exp_f32 v104, v104
    v_exp_f32 v105, v105
    v_exp_f32 v106, v106
    v_exp_f32 v107, v107
    v_add_f32 v104, 1.0, v104
    v_add_f32 v105, 1.0, v105
    v_add_f32 v106, 1.0, v106
    v_add_f32 v107, 1.0, v107
    v_rcp_f32 v104, v104
    v_rcp_f32 v105, v105
    v_rcp_f32 v106, v106
    v_rcp_f32 v107, v107
    v_mul_f32 v56, v56, v104
    v_mul_f32 v57, v57, v105
    v_mul_f32 v58, v58, v106
    v_mul_f32 v59, v59, v107
    v_add_f32 v60, v60, v100
    v_add_f32 v61, v61, v101
    v_add_f32 v62, v62, v102
    v_add_f32 v63, v63, v103
    v_mul_f32 v104, v60, v60
    v_mul_f32 v105, v61, v61
    v_mul_f32 v106, v62, v62
    v_mul_f32 v107, v63, v63
    v_fma_f32 v104, v104, s45, v6
    v_fma_f32 v105, v105, s45, v6
    v_fma_f32 v106, v106, s45, v6
    v_fma_f32 v107, v107, s45, v6
    v_mul_f32 v104, v104, v60
    v_mul_f32 v105, v105, v61
    v_mul_f32 v106, v106, v62
    v_mul_f32 v107, v107, v63
    v_exp_f32 v104, v104
    v_exp_f32 v105, v105
    v_exp_f32 v106, v106
    v_exp_f32 v107, v107
    v_add_f32 v104, 1.0, v104
    v_add_f32 v105, 1.0, v105
    v_add_f32 v106, 1.0, v106
    v_add_f32 v107, 1.0, v107
    v_rcp_f32 v104, v104
    v_rcp_f32 v105, v105
    v_rcp_f32 v106, v106
    v_rcp_f32 v107, v107
    v_mul_f32 v60, v60, v104
    v_mul_f32 v61, v61, v105
    v_mul_f32 v62, v62, v106
    v_mul_f32 v63, v63, v107
    v_cvt_pk_bf16_f32 v48, v48, v49
    v_cvt_pk_bf16_f32 v49, v50, v51
    v_cvt_pk_bf16_f32 v50, v52, v53
    v_cvt_pk_bf16_f32 v51, v54, v55
    buffer_store_dwordx4 v[48:51], v5, s[24:27], s43 offen offset:0
    v_cvt_pk_bf16_f32 v56, v56, v57
    v_cvt_pk_bf16_f32 v57, v58, v59
    v_cvt_pk_bf16_f32 v58, v60, v61
    v_cvt_pk_bf16_f32 v59, v62, v63
    buffer_store_dwordx4 v[56:59], v5, s[24:27], s43 offen offset:64
    s_add_u32 s43, s43, 2048
    v_add_f32 v64, v64, v88
    v_add_f32 v65, v65, v89
    v_add_f32 v66, v66, v90
    v_add_f32 v67, v67, v91
    v_mul_f32 v104, v64, v64
    v_mul_f32 v105, v65, v65
    v_mul_f32 v106, v66, v66
    v_mul_f32 v107, v67, v67
    v_fma_f32 v104, v104, s45, v6
    v_fma_f32 v105, v105, s45, v6
    v_fma_f32 v106, v106, s45, v6
    v_fma_f32 v107, v107, s45, v6
    v_mul_f32 v104, v104, v64
    v_mul_f32 v105, v105, v65
    v_mul_f32 v106, v106, v66
    v_mul_f32 v107, v107, v67
    v_exp_f32 v104, v104
    v_exp_f32 v105, v105
    v_exp_f32 v106, v106
    v_exp_f32 v107, v107
    v_add_f32 v104, 1.0, v104
    v_add_f32 v105, 1.0, v105
    v_add_f32 v106, 1.0, v106
    v_add_f32 v107, 1.0, v107
    v_rcp_f32 v104, v104
    v_rcp_f32 v105, v105
    v_rcp_f32 v106, v106
    v_rcp_f32 v107, v107
    v_mul_f32 v64, v64, v104
    v_mul_f32 v65, v65, v105
    v_mul_f32 v66, v66, v106
    v_mul_f32 v67, v67, v107
    v_add_f32 v68, v68, v92
    v_add_f32 v69, v69, v93
    v_add_f32 v70, v70, v94
    v_add_f32 v71, v71, v95
    v_mul_f32 v104, v68, v68
    v_mul_f32 v105, v69, v69
    v_mul_f32 v106, v70, v70
    v_mul_f32 v107, v71, v71
    v_fma_f32 v104, v104, s45, v6
    v_fma_f32 v105, v105, s45, v6
    v_fma_f32 v106, v106, s45, v6
    v_fma_f32 v107, v107, s45, v6
    v_mul_f32 v104, v104, v68
    v_mul_f32 v105, v105, v69
    v_mul_f32 v106, v106, v70
    v_mul_f32 v107, v107, v71
    v_exp_f32 v104, v104
    v_exp_f32 v105, v105
    v_exp_f32 v106, v106
    v_exp_f32 v107, v107
    v_add_f32 v104, 1.0, v104
    v_add_f32 v105, 1.0, v105
    v_add_f32 v106, 1.0, v106
    v_add_f32 v107, 1.0, v107
    v_rcp_f32 v104, v104
    v_rcp_f32 v105, v105
    v_rcp_f32 v106, v106
    v_rcp_f32 v107, v107
    v_mul_f32 v68, v68, v104
    v_mul_f32 v69, v69, v105
    v_mul_f32 v70, v70, v106
    v_mul_f32 v71, v71, v107
    v_add_f32 v72, v72, v96
    v_add_f32 v73, v73, v97
    v_add_f32 v74, v74, v98
    v_add_f32 v75, v75, v99
    v_mul_f32 v104, v72, v72
    v_mul_f32 v105, v73, v73
    v_mul_f32 v106, v74, v74
    v_mul_f32 v107, v75, v75
    v_fma_f32 v104, v104, s45, v6
    v_fma_f32 v105, v105, s45, v6
    v_fma_f32 v106, v106, s45, v6
    v_fma_f32 v107, v107, s45, v6
    v_mul_f32 v104, v104, v72
    v_mul_f32 v105, v105, v73
    v_mul_f32 v106, v106, v74
    v_mul_f32 v107, v107, v75
    v_exp_f32 v104, v104
    v_exp_f32 v105, v105
    v_exp_f32 v106, v106
    v_exp_f32 v107, v107
    v_add_f32 v104, 1.0, v104
    v_add_f32 v105, 1.0, v105
    v_add_f32 v106, 1.0, v106
    v_add_f32 v107, 1.0, v107
    v_rcp_f32 v104, v104
    v_rcp_f32 v105, v105
    v_rcp_f32 v106, v106
    v_rcp_f32 v107, v107
    v_mul_f32 v72, v72, v104
    v_mul_f32 v73, v73, v105
    v_mul_f32 v74, v74, v106
    v_mul_f32 v75, v75, v107
    v_add_f32 v76, v76, v100
    v_add_f32 v77, v77, v101
    v_add_f32 v78, v78, v102
    v_add_f32 v79, v79, v103
    v_mul_f32 v104, v76, v76
    v_mul_f32 v105, v77, v77
    v_mul_f32 v106, v78, v78
    v_mul_f32 v107, v79, v79
    v_fma_f32 v104, v104, s45, v6
    v_fma_f32 v105, v105, s45, v6
    v_fma_f32 v106, v106, s45, v6
    v_fma_f32 v107, v107, s45, v6
    v_mul_f32 v104, v104, v76
    v_mul_f32 v105, v105, v77
    v_mul_f32 v106, v106, v78
    v_mul_f32 v107, v107, v79
    v_exp_f32 v104, v104
    v_exp_f32 v105, v105
    v_exp_f32 v106, v106
    v_exp_f32 v107, v107
    v_add_f32 v104, 1.0, v104
    v_add_f32 v105, 1.0, v105
    v_add_f32 v106, 1.0, v106
    v_add_f32 v107, 1.0, v107
    v_rcp_f32 v104, v104
    v_rcp_f32 v105, v105
    v_rcp_f32 v106, v106
    v_rcp_f32 v107, v107
    v_mul_f32 v76, v76, v104
    v_mul_f32 v77, v77, v105
    v_mul_f32 v78, v78, v106
    v_mul_f32 v79, v79, v107
    v_cvt_pk_bf16_f32 v64, v64, v65
    v_cvt_pk_bf16_f32 v65, v66, v67
    v_cvt_pk_bf16_f32 v66, v68, v69
    v_cvt_pk_bf16_f32 v67, v70, v71
    buffer_store_dwordx4 v[64:67], v5, s[24:27], s43 offen offset:0
    v_cvt_pk_bf16_f32 v72, v72, v73
    v_cvt_pk_bf16_f32 v73, v74, v75
    v_cvt_pk_bf16_f32 v74, v76, v77
    v_cvt_pk_bf16_f32 v75, v78, v79
    buffer_store_dwordx4 v[72:75], v5, s[24:27], s43 offen offset:64
    s_add_u32 s43, s43, 2048
    s_endpgm
is_chain:
    s_and_b32 s3, s3, 31
    v_and_b32 v12, 63, v0
    v_lshrrev_b32 v13, 4, v12
    v_and_b32 v14, 15, v12
    s_and_b32 s66, s6, 1
    s_lshr_b32 s67, s6, 1
    s_lshl_b32 s68, s67, 5
    s_lshl_b32 s69, s66, 1
    s_add_u32 s68, s68, s69
    v_lshrrev_b32 v15, 1, v13
    v_and_b32 v16, 1, v13
    v_lshl_add_u32 v15, v15, 3, v16
    v_add_u32 v15, s68, v15
    s_lshl_b32 s69, s3, 8
    v_add_u32 v16, 0, v13
    v_lshlrev_b32 v16, 1, v16
    v_xor_b32 v16, v16, v14
    v_add_u32 v17, 0, v15
    v_lshlrev_b32 v17, 13, v17
    v_lshl_add_u32 v20, v16, 4, v17
    v_add_u32 v20, s69, v20
    v_add_u32 v16, 4, v13
    v_lshlrev_b32 v16, 1, v16
    v_xor_b32 v16, v16, v14
    v_add_u32 v17, 4, v15
    v_lshlrev_b32 v17, 13, v17
    v_lshl_add_u32 v21, v16, 4, v17
    v_add_u32 v21, s69, v21
    s_lshl_b32 s72, s6, 12
    s_mov_b32 s71, 0
    s_add_u32 m0, s72, 15360
    s_nop 0
    buffer_load_dwordx4 v20, s[8:11], s71 offen lds
    s_mov_b32 s71, 0
    s_add_u32 m0, s72, 16384
    s_nop 0
    buffer_load_dwordx4 v21, s[8:11], s71 offen lds
    s_mov_b32 s71, 131072
    s_add_u32 m0, s72, 17408
    s_nop 0
    buffer_load_dwordx4 v20, s[8:11], s71 offen lds
    s_mov_b32 s71, 131072
    s_add_u32 m0, s72, 18432
    s_nop 0
    buffer_load_dwordx4 v21, s[8:11], s71 offen lds
    s_mov_b32 s71, 524288
    s_add_u32 m0, s72, 31744
    s_nop 0
    buffer_load_dwordx4 v20, s[8:11], s71 offen lds
    s_mov_b32 s71, 524288
    s_add_u32 m0, s72, 32768
    s_nop 0
    buffer_load_dwordx4 v21, s[8:11], s71 offen lds
    s_mov_b32 s71, 655360
    s_add_u32 m0, s72, 33792
    s_nop 0
    buffer_load_dwordx4 v20, s[8:11], s71 offen lds
    s_mov_b32 s71, 655360
    s_add_u32 m0, s72, 34816
    s_nop 0
    buffer_load_dwordx4 v21, s[8:11], s71 offen lds
    s_mov_b32 s71, 1048576
    s_add_u32 m0, s72, 48128
    s_nop 0
    buffer_load_dwordx4 v20, s[8:11], s71 offen lds
    s_mov_b32 s71, 1048576
    s_add_u32 m0, s72, 49152
    s_nop 0
    buffer_load_dwordx4 v21, s[8:11], s71 offen lds
    s_mov_b32 s71, 1179648
    s_add_u32 m0, s72, 50176
    s_nop 0
    buffer_load_dwordx4 v20, s[8:11], s71 offen lds
    s_mov_b32 s71, 1179648
    s_add_u32 m0, s72, 51200
    s_nop 0
    buffer_load_dwordx4 v21, s[8:11], s71 offen lds
    s_mov_b32 s71, 1572864
    s_add_u32 m0, s72, 64512
    s_nop 0
    buffer_load_dwordx4 v20, s[8:11], s71 offen lds
    s_mov_b32 s71, 1572864
    s_add_u32 m0, s72, 65536
    s_nop 0
    buffer_load_dwordx4 v21, s[8:11], s71 offen lds
    s_mov_b32 s71, 1703936
    s_add_u32 m0, s72, 66560
    s_nop 0
    buffer_load_dwordx4 v20, s[8:11], s71 offen lds
    s_mov_b32 s71, 1703936
    s_add_u32 m0, s72, 67584
    s_nop 0
    buffer_load_dwordx4 v21, s[8:11], s71 offen lds
    s_mov_b32 s71, 2097152
    s_add_u32 m0, s72, 80896
    s_nop 0
    buffer_load_dwordx4 v20, s[8:11], s71 offen lds
    s_mov_b32 s71, 2097152
    s_add_u32 m0, s72, 81920
    s_nop 0
    buffer_load_dwordx4 v21, s[8:11], s71 offen lds
    s_mov_b32 s71, 2228224
    s_add_u32 m0, s72, 82944
    s_nop 0
    buffer_load_dwordx4 v20, s[8:11], s71 offen lds
    s_mov_b32 s71, 2228224
    s_add_u32 m0, s72, 83968
    s_nop 0
    buffer_load_dwordx4 v21, s[8:11], s71 offen lds
    s_mov_b32 s71, 2621440
    s_add_u32 m0, s72, 97280
    s_nop 0
    buffer_load_dwordx4 v20, s[8:11], s71 offen lds
    s_mov_b32 s71, 2621440
    s_add_u32 m0, s72, 98304
    s_nop 0
    buffer_load_dwordx4 v21, s[8:11], s71 offen lds
    s_mov_b32 s71, 2752512
    s_add_u32 m0, s72, 99328
    s_nop 0
    buffer_load_dwordx4 v20, s[8:11], s71 offen lds
    s_mov_b32 s71, 2752512
    s_add_u32 m0, s72, 100352
    s_nop 0
    buffer_load_dwordx4 v21, s[8:11], s71 offen lds
    s_mov_b32 s71, 3145728
    s_add_u32 m0, s72, 113664
    s_nop 0
    buffer_load_dwordx4 v20, s[8:11], s71 offen lds
    s_mov_b32 s71, 3145728
    s_add_u32 m0, s72, 114688
    s_nop 0
    buffer_load_dwordx4 v21, s[8:11], s71 offen lds
    s_mov_b32 s71, 3276800
    s_add_u32 m0, s72, 115712
    s_nop 0
    buffer_load_dwordx4 v20, s[8:11], s71 offen lds
    s_mov_b32 s71, 3276800
    s_add_u32 m0, s72, 116736
    s_nop 0
    buffer_load_dwordx4 v21, s[8:11], s71 offen lds
    s_mov_b32 s71, 3670016
    s_add_u32 m0, s72, 130048
    s_nop 0
    buffer_load_dwordx4 v20, s[8:11], s71 offen lds
    s_mov_b32 s71, 3670016
    s_add_u32 m0, s72, 131072
    s_nop 0
    buffer_load_dwordx4 v21, s[8:11], s71 offen lds
    s_mov_b32 s71, 3801088
    s_add_u32 m0, s72, 132096
    s_nop 0
    buffer_load_dwordx4 v20, s[8:11], s71 offen lds
    s_mov_b32 s71, 3801088
    s_add_u32 m0, s72, 133120
    s_nop 0
    buffer_load_dwordx4 v21, s[8:11], s71 offen lds
    s_mov_b32 s71, 4194304
    s_add_u32 m0, s72, 146432
    s_nop 0
    buffer_load_dwordx4 v20, s[8:11], s71 offen lds
    s_mov_b32 s71, 4194304
    s_add_u32 m0, s72, 147456
    s_nop 0
    buffer_load_dwordx4 v21, s[8:11], s71 offen lds
    s_mov_b32 s71, 4325376
    s_add_u32 m0, s72, 148480
    s_nop 0
    buffer_load_dwordx4 v20, s[8:11], s71 offen lds
    s_mov_b32 s71, 4325376
    s_add_u32 m0, s72, 149504
    s_nop 0
    buffer_load_dwordx4 v21, s[8:11], s71 offen lds
    v_bfe_u32 v15, v12, 4, 1
    v_bfe_u32 v16, v12, 3, 1
    v_lshl_add_u32 v15, v15, 3, v16
    v_lshrrev_b32 v16, 5, v12
    v_lshl_add_u32 v15, v16, 2, v15
    v_add_u32 v15, s68, v15
    v_lshlrev_b32 v15, 13, v15
    v_and_b32 v16, 7, v12
    v_lshlrev_b32 v17, 1, v13
    v_xor_b32 v16, v16, v17
    v_lshl_add_u32 v22, v16, 4, v15
    v_add_u32 v22, s69, v22
    s_lshl_b32 s68, s67, 3
    s_lshl_b32 s70, s66, 1
    s_add_u32 s68, s68, s70
    s_mul_i32 s70, s3, 147456
    v_add_u32 v15, 0, v12
    v_mul_u32_u24 v16, 911, v15
    v_lshrrev_b32 v16, 16, v16
    v_mul_u32_u24 v17, 72, v16
    v_sub_u32 v17, v15, v17
    v_bfe_u32 v18, v16, 1, 2
    v_lshlrev_b32 v18, 1, v18
    v_xor_b32 v17, v17, v18
    v_bfe_u32 v18, v16, 2, 1
    v_lshlrev_b32 v15, 6, v18
    v_bfe_u32 v18, v16, 1, 1
    v_lshl_add_u32 v15, v18, 4, v15
    v_bfe_u32 v18, v16, 3, 1
    v_lshl_add_u32 v15, v18, 2, v15
    v_and_b32 v18, 1, v16
    v_add3_u32 v15, v15, v18, s68
    v_mul_u32_u24 v15, 1152, v15
    v_lshl_add_u32 v24, v17, 4, v15
    v_add_u32 v24, s70, v24
    v_add_u32 v15, 64, v12
    v_mul_u32_u24 v16, 911, v15
    v_lshrrev_b32 v16, 16, v16
    v_mul_u32_u24 v17, 72, v16
    v_sub_u32 v17, v15, v17
    v_bfe_u32 v18, v16, 1, 2
    v_lshlrev_b32 v18, 1, v18
    v_xor_b32 v17, v17, v18
    v_bfe_u32 v18, v16, 2, 1
    v_lshlrev_b32 v15, 6, v18
    v_bfe_u32 v18, v16, 1, 1
    v_lshl_add_u32 v15, v18, 4, v15
    v_bfe_u32 v18, v16, 3, 1
    v_lshl_add_u32 v15, v18, 2, v15
    v_and_b32 v18, 1, v16
    v_add3_u32 v15, v15, v18, s68
    v_mul_u32_u24 v15, 1152, v15
    v_lshl_add_u32 v25, v17, 4, v15
    v_add_u32 v25, s70, v25
    v_add_u32 v15, 128, v12
    v_mul_u32_u24 v16, 911, v15
    v_lshrrev_b32 v16, 16, v16
    v_mul_u32_u24 v17, 72, v16
    v_sub_u32 v17, v15, v17
    v_bfe_u32 v18, v16, 1, 2
    v_lshlrev_b32 v18, 1, v18
    v_xor_b32 v17, v17, v18
    v_bfe_u32 v18, v16, 2, 1
    v_lshlrev_b32 v15, 6, v18
    v_bfe_u32 v18, v16, 1, 1
    v_lshl_add_u32 v15, v18, 4, v15
    v_bfe_u32 v18, v16, 3, 1
    v_lshl_add_u32 v15, v18, 2, v15
    v_and_b32 v18, 1, v16
    v_add3_u32 v15, v15, v18, s68
    v_mul_u32_u24 v15, 1152, v15
    v_lshl_add_u32 v26, v17, 4, v15
    v_add_u32 v26, s70, v26
    v_add_u32 v15, 192, v12
    v_mul_u32_u24 v16, 911, v15
    v_lshrrev_b32 v16, 16, v16
    v_mul_u32_u24 v17, 72, v16
    v_sub_u32 v17, v15, v17
    v_bfe_u32 v18, v16, 1, 2
    v_lshlrev_b32 v18, 1, v18
    v_xor_b32 v17, v17, v18
    v_bfe_u32 v18, v16, 2, 1
    v_lshlrev_b32 v15, 6, v18
    v_bfe_u32 v18, v16, 1, 1
    v_lshl_add_u32 v15, v18, 4, v15
    v_bfe_u32 v18, v16, 3, 1
    v_lshl_add_u32 v15, v18, 2, v15
    v_and_b32 v18, 1, v16
    v_add3_u32 v15, v15, v18, s68
    v_mul_u32_u24 v15, 1152, v15
    v_lshl_add_u32 v27, v17, 4, v15
    v_add_u32 v27, s70, v27
    v_add_u32 v15, 256, v12
    v_mul_u32_u24 v16, 911, v15
    v_lshrrev_b32 v16, 16, v16
    v_mul_u32_u24 v17, 72, v16
    v_sub_u32 v17, v15, v17
    v_bfe_u32 v18, v16, 1, 2
    v_lshlrev_b32 v18, 1, v18
    v_xor_b32 v17, v17, v18
    v_bfe_u32 v18, v16, 2, 1
    v_lshlrev_b32 v15, 6, v18
    v_bfe_u32 v18, v16, 1, 1
    v_lshl_add_u32 v15, v18, 4, v15
    v_bfe_u32 v18, v16, 3, 1
    v_lshl_add_u32 v15, v18, 2, v15
    v_and_b32 v18, 1, v16
    v_add3_u32 v15, v15, v18, s68
    v_mul_u32_u24 v15, 1152, v15
    v_lshl_add_u32 v28, v17, 4, v15
    v_add_u32 v28, s70, v28
    v_add_u32 v15, 320, v12
    v_mul_u32_u24 v16, 911, v15
    v_lshrrev_b32 v16, 16, v16
    v_mul_u32_u24 v17, 72, v16
    v_sub_u32 v17, v15, v17
    v_bfe_u32 v18, v16, 1, 2
    v_lshlrev_b32 v18, 1, v18
    v_xor_b32 v17, v17, v18
    v_bfe_u32 v18, v16, 2, 1
    v_lshlrev_b32 v15, 6, v18
    v_bfe_u32 v18, v16, 1, 1
    v_lshl_add_u32 v15, v18, 4, v15
    v_bfe_u32 v18, v16, 3, 1
    v_lshl_add_u32 v15, v18, 2, v15
    v_and_b32 v18, 1, v16
    v_add3_u32 v15, v15, v18, s68
    v_mul_u32_u24 v15, 1152, v15
    v_lshl_add_u32 v29, v17, 4, v15
    v_add_u32 v29, s70, v29
    v_add_u32 v15, 384, v12
    v_mul_u32_u24 v16, 911, v15
    v_lshrrev_b32 v16, 16, v16
    v_mul_u32_u24 v17, 72, v16
    v_sub_u32 v17, v15, v17
    v_bfe_u32 v18, v16, 1, 2
    v_lshlrev_b32 v18, 1, v18
    v_xor_b32 v17, v17, v18
    v_bfe_u32 v18, v16, 2, 1
    v_lshlrev_b32 v15, 6, v18
    v_bfe_u32 v18, v16, 1, 1
    v_lshl_add_u32 v15, v18, 4, v15
    v_bfe_u32 v18, v16, 3, 1
    v_lshl_add_u32 v15, v18, 2, v15
    v_and_b32 v18, 1, v16
    v_add3_u32 v15, v15, v18, s68
    v_mul_u32_u24 v15, 1152, v15
    v_lshl_add_u32 v30, v17, 4, v15
    v_add_u32 v30, s70, v30
    v_add_u32 v15, 448, v12
    v_mul_u32_u24 v16, 911, v15
    v_lshrrev_b32 v16, 16, v16
    v_mul_u32_u24 v17, 72, v16
    v_sub_u32 v17, v15, v17
    v_bfe_u32 v18, v16, 1, 2
    v_lshlrev_b32 v18, 1, v18
    v_xor_b32 v17, v17, v18
    v_bfe_u32 v18, v16, 2, 1
    v_lshlrev_b32 v15, 6, v18
    v_bfe_u32 v18, v16, 1, 1
    v_lshl_add_u32 v15, v18, 4, v15
    v_bfe_u32 v18, v16, 3, 1
    v_lshl_add_u32 v15, v18, 2, v15
    v_and_b32 v18, 1, v16
    v_add3_u32 v15, v15, v18, s68
    v_mul_u32_u24 v15, 1152, v15
    v_lshl_add_u32 v31, v17, 4, v15
    v_add_u32 v31, s70, v31
    v_add_u32 v15, 512, v12
    v_mul_u32_u24 v16, 911, v15
    v_lshrrev_b32 v16, 16, v16
    v_mul_u32_u24 v17, 72, v16
    v_sub_u32 v17, v15, v17
    v_bfe_u32 v18, v16, 1, 2
    v_lshlrev_b32 v18, 1, v18
    v_xor_b32 v17, v17, v18
    v_bfe_u32 v18, v16, 2, 1
    v_lshlrev_b32 v15, 6, v18
    v_bfe_u32 v18, v16, 1, 1
    v_lshl_add_u32 v15, v18, 4, v15
    v_bfe_u32 v18, v16, 3, 1
    v_lshl_add_u32 v15, v18, 2, v15
    v_and_b32 v18, 1, v16
    v_add3_u32 v15, v15, v18, s68
    v_mul_u32_u24 v15, 1152, v15
    v_lshl_add_u32 v32, v17, 4, v15
    v_add_u32 v32, s70, v32
    v_add_u32 v15, 576, v12
    v_mul_u32_u24 v16, 911, v15
    v_lshrrev_b32 v16, 16, v16
    v_mul_u32_u24 v17, 72, v16
    v_sub_u32 v17, v15, v17
    v_bfe_u32 v18, v16, 1, 2
    v_lshlrev_b32 v18, 1, v18
    v_xor_b32 v17, v17, v18
    v_bfe_u32 v18, v16, 2, 1
    v_lshlrev_b32 v15, 6, v18
    v_bfe_u32 v18, v16, 1, 1
    v_lshl_add_u32 v15, v18, 4, v15
    v_bfe_u32 v18, v16, 3, 1
    v_lshl_add_u32 v15, v18, 2, v15
    v_and_b32 v18, 1, v16
    v_add3_u32 v15, v15, v18, s68
    v_mul_u32_u24 v15, 1152, v15
    v_lshl_add_u32 v33, v17, 4, v15
    v_add_u32 v33, s70, v33
    v_add_u32 v15, 640, v12
    v_mul_u32_u24 v16, 911, v15
    v_lshrrev_b32 v16, 16, v16
    v_mul_u32_u24 v17, 72, v16
    v_sub_u32 v17, v15, v17
    v_bfe_u32 v18, v16, 1, 2
    v_lshlrev_b32 v18, 1, v18
    v_xor_b32 v17, v17, v18
    v_bfe_u32 v18, v16, 2, 1
    v_lshlrev_b32 v15, 6, v18
    v_bfe_u32 v18, v16, 1, 1
    v_lshl_add_u32 v15, v18, 4, v15
    v_bfe_u32 v18, v16, 3, 1
    v_lshl_add_u32 v15, v18, 2, v15
    v_and_b32 v18, 1, v16
    v_add3_u32 v15, v15, v18, s68
    v_mul_u32_u24 v15, 1152, v15
    v_lshl_add_u32 v34, v17, 4, v15
    v_add_u32 v34, s70, v34
    v_add_u32 v15, 704, v12
    v_mul_u32_u24 v16, 911, v15
    v_lshrrev_b32 v16, 16, v16
    v_mul_u32_u24 v17, 72, v16
    v_sub_u32 v17, v15, v17
    v_bfe_u32 v18, v16, 1, 2
    v_lshlrev_b32 v18, 1, v18
    v_xor_b32 v17, v17, v18
    v_bfe_u32 v18, v16, 2, 1
    v_lshlrev_b32 v15, 6, v18
    v_bfe_u32 v18, v16, 1, 1
    v_lshl_add_u32 v15, v18, 4, v15
    v_bfe_u32 v18, v16, 3, 1
    v_lshl_add_u32 v15, v18, 2, v15
    v_and_b32 v18, 1, v16
    v_add3_u32 v15, v15, v18, s68
    v_mul_u32_u24 v15, 1152, v15
    v_lshl_add_u32 v35, v17, 4, v15
    v_add_u32 v35, s70, v35
    v_add_u32 v15, 768, v12
    v_mul_u32_u24 v16, 911, v15
    v_lshrrev_b32 v16, 16, v16
    v_mul_u32_u24 v17, 72, v16
    v_sub_u32 v17, v15, v17
    v_bfe_u32 v18, v16, 1, 2
    v_lshlrev_b32 v18, 1, v18
    v_xor_b32 v17, v17, v18
    v_bfe_u32 v18, v16, 2, 1
    v_lshlrev_b32 v15, 6, v18
    v_bfe_u32 v18, v16, 1, 1
    v_lshl_add_u32 v15, v18, 4, v15
    v_bfe_u32 v18, v16, 3, 1
    v_lshl_add_u32 v15, v18, 2, v15
    v_and_b32 v18, 1, v16
    v_add3_u32 v15, v15, v18, s68
    v_mul_u32_u24 v15, 1152, v15
    v_lshl_add_u32 v36, v17, 4, v15
    v_add_u32 v36, s70, v36
    v_add_u32 v15, 832, v12
    v_mul_u32_u24 v16, 911, v15
    v_lshrrev_b32 v16, 16, v16
    v_mul_u32_u24 v17, 72, v16
    v_sub_u32 v17, v15, v17
    v_bfe_u32 v18, v16, 1, 2
    v_lshlrev_b32 v18, 1, v18
    v_xor_b32 v17, v17, v18
    v_bfe_u32 v18, v16, 2, 1
    v_lshlrev_b32 v15, 6, v18
    v_bfe_u32 v18, v16, 1, 1
    v_lshl_add_u32 v15, v18, 4, v15
    v_bfe_u32 v18, v16, 3, 1
    v_lshl_add_u32 v15, v18, 2, v15
    v_and_b32 v18, 1, v16
    v_add3_u32 v15, v15, v18, s68
    v_mul_u32_u24 v15, 1152, v15
    v_lshl_add_u32 v37, v17, 4, v15
    v_add_u32 v37, s70, v37
    v_add_u32 v15, 896, v12
    v_mul_u32_u24 v16, 911, v15
    v_lshrrev_b32 v16, 16, v16
    v_mul_u32_u24 v17, 72, v16
    v_sub_u32 v17, v15, v17
    v_bfe_u32 v18, v16, 1, 2
    v_lshlrev_b32 v18, 1, v18
    v_xor_b32 v17, v17, v18
    v_bfe_u32 v18, v16, 2, 1
    v_lshlrev_b32 v15, 6, v18
    v_bfe_u32 v18, v16, 1, 1
    v_lshl_add_u32 v15, v18, 4, v15
    v_bfe_u32 v18, v16, 3, 1
    v_lshl_add_u32 v15, v18, 2, v15
    v_and_b32 v18, 1, v16
    v_add3_u32 v15, v15, v18, s68
    v_mul_u32_u24 v15, 1152, v15
    v_lshl_add_u32 v38, v17, 4, v15
    v_add_u32 v38, s70, v38
    v_add_u32 v15, 960, v12
    v_mul_u32_u24 v16, 911, v15
    v_lshrrev_b32 v16, 16, v16
    v_mul_u32_u24 v17, 72, v16
    v_sub_u32 v17, v15, v17
    v_bfe_u32 v18, v16, 1, 2
    v_lshlrev_b32 v18, 1, v18
    v_xor_b32 v17, v17, v18
    v_bfe_u32 v18, v16, 2, 1
    v_lshlrev_b32 v15, 6, v18
    v_bfe_u32 v18, v16, 1, 1
    v_lshl_add_u32 v15, v18, 4, v15
    v_bfe_u32 v18, v16, 3, 1
    v_lshl_add_u32 v15, v18, 2, v15
    v_and_b32 v18, 1, v16
    v_add3_u32 v15, v15, v18, s68
    v_mul_u32_u24 v15, 1152, v15
    v_lshl_add_u32 v39, v17, 4, v15
    v_add_u32 v39, s70, v39
    v_add_u32 v15, 1024, v12
    v_mul_u32_u24 v16, 911, v15
    v_lshrrev_b32 v16, 16, v16
    v_mul_u32_u24 v17, 72, v16
    v_sub_u32 v17, v15, v17
    v_bfe_u32 v18, v16, 1, 2
    v_lshlrev_b32 v18, 1, v18
    v_xor_b32 v17, v17, v18
    v_bfe_u32 v18, v16, 2, 1
    v_lshlrev_b32 v15, 6, v18
    v_bfe_u32 v18, v16, 1, 1
    v_lshl_add_u32 v15, v18, 4, v15
    v_bfe_u32 v18, v16, 3, 1
    v_lshl_add_u32 v15, v18, 2, v15
    v_and_b32 v18, 1, v16
    v_add3_u32 v15, v15, v18, s68
    v_mul_u32_u24 v15, 1152, v15
    v_lshl_add_u32 v40, v17, 4, v15
    v_add_u32 v40, s70, v40
    v_add_u32 v15, 1088, v12
    v_mul_u32_u24 v16, 911, v15
    v_lshrrev_b32 v16, 16, v16
    v_mul_u32_u24 v17, 72, v16
    v_sub_u32 v17, v15, v17
    v_bfe_u32 v18, v16, 1, 2
    v_lshlrev_b32 v18, 1, v18
    v_xor_b32 v17, v17, v18
    v_bfe_u32 v18, v16, 2, 1
    v_lshlrev_b32 v15, 6, v18
    v_bfe_u32 v18, v16, 1, 1
    v_lshl_add_u32 v15, v18, 4, v15
    v_bfe_u32 v18, v16, 3, 1
    v_lshl_add_u32 v15, v18, 2, v15
    v_and_b32 v18, 1, v16
    v_add3_u32 v15, v15, v18, s68
    v_mul_u32_u24 v15, 1152, v15
    v_lshl_add_u32 v41, v17, 4, v15
    v_add_u32 v41, s70, v41
    v_lshrrev_b32 v15, 2, v12
    v_and_b32 v16, 3, v12
    v_lshlrev_b32 v16, 3, v16
    v_and_b32 v17, 7, v15
    s_lshl_b32 s68, s6, 1
    s_add_u32 s71, s68, 0
    v_xor_b32 v18, s71, v17
    v_lshl_add_u32 v18, v18, 5, v16
    v_lshl_add_u32 v42, v15, 8, v18
    v_add_u32 v42, 15360, v42
    s_add_u32 s71, s68, 1
    v_xor_b32 v18, s71, v17
    v_lshl_add_u32 v18, v18, 5, v16
    v_lshl_add_u32 v43, v15, 8, v18
    v_add_u32 v43, 15360, v43
    v_bfe_u32 v17, v15, 1, 2
    v_xor_b32 v17, s6, v17
    v_lshl_add_u32 v17, v17, 5, v16
    v_lshl_add_u32 v4, v15, 7, v17
    v_add_u32 v4, 15360, v4
    v_mul_u32_u24 v5, 1152, v15
    v_add_u32 v5, v5, v17
    v_add_u32 v5, 89088, v5
    v_add_u32 v3, 65536, v4
    s_waitcnt vmcnt(24)
    s_barrier
    v_add_u32 v11, 0, v42
    ds_read_b64_tr_b16 a[0:1], v11 offset:0
    ds_read_b64_tr_b16 a[2:3], v11 offset:4096
    ds_read_b64_tr_b16 a[4:5], v11 offset:8192
    ds_read_b64_tr_b16 a[6:7], v11 offset:12288
    ds_read_b64_tr_b16 a[16:17], v11 offset:16384
    ds_read_b64_tr_b16 a[18:19], v11 offset:20480
    ds_read_b64_tr_b16 a[20:21], v11 offset:24576
    ds_read_b64_tr_b16 a[22:23], v11 offset:28672
    ds_read_b64_tr_b16 a[32:33], v11 offset:32768
    ds_read_b64_tr_b16 a[34:35], v11 offset:36864
    ds_read_b64_tr_b16 a[36:37], v11 offset:40960
    ds_read_b64_tr_b16 a[38:39], v11 offset:45056
    v_add_u32 v11, 0, v43
    ds_read_b64_tr_b16 a[8:9], v11 offset:0
    ds_read_b64_tr_b16 a[10:11], v11 offset:4096
    ds_read_b64_tr_b16 a[12:13], v11 offset:8192
    ds_read_b64_tr_b16 a[14:15], v11 offset:12288
    ds_read_b64_tr_b16 a[24:25], v11 offset:16384
    ds_read_b64_tr_b16 a[26:27], v11 offset:20480
    ds_read_b64_tr_b16 a[28:29], v11 offset:24576
    ds_read_b64_tr_b16 a[30:31], v11 offset:28672
    ds_read_b64_tr_b16 a[40:41], v11 offset:32768
    ds_read_b64_tr_b16 a[42:43], v11 offset:36864
    ds_read_b64_tr_b16 a[44:45], v11 offset:40960
    ds_read_b64_tr_b16 a[46:47], v11 offset:45056
    s_waitcnt lgkmcnt(0)
    s_barrier
    s_lshl_b32 s72, s6, 12
    s_mov_b32 s71, 0
    s_add_u32 m0, s72, 15360
    s_nop 0
    buffer_load_dwordx4 v20, s[12:15], s71 offen lds
    s_mov_b32 s71, 0
    s_add_u32 m0, s72, 16384
    s_nop 0
    buffer_load_dwordx4 v21, s[12:15], s71 offen lds
    s_mov_b32 s71, 131072
    s_add_u32 m0, s72, 17408
    s_nop 0
    buffer_load_dwordx4 v20, s[12:15], s71 offen lds
    s_mov_b32 s71, 131072
    s_add_u32 m0, s72, 18432
    s_nop 0
    buffer_load_dwordx4 v21, s[12:15], s71 offen lds
    s_mov_b32 s71, 524288
    s_add_u32 m0, s72, 31744
    s_nop 0
    buffer_load_dwordx4 v20, s[12:15], s71 offen lds
    s_mov_b32 s71, 524288
    s_add_u32 m0, s72, 32768
    s_nop 0
    buffer_load_dwordx4 v21, s[12:15], s71 offen lds
    s_mov_b32 s71, 655360
    s_add_u32 m0, s72, 33792
    s_nop 0
    buffer_load_dwordx4 v20, s[12:15], s71 offen lds
    s_mov_b32 s71, 655360
    s_add_u32 m0, s72, 34816
    s_nop 0
    buffer_load_dwordx4 v21, s[12:15], s71 offen lds
    s_mov_b32 s71, 1048576
    s_add_u32 m0, s72, 48128
    s_nop 0
    buffer_load_dwordx4 v20, s[12:15], s71 offen lds
    s_mov_b32 s71, 1048576
    s_add_u32 m0, s72, 49152
    s_nop 0
    buffer_load_dwordx4 v21, s[12:15], s71 offen lds
    s_mov_b32 s71, 1179648
    s_add_u32 m0, s72, 50176
    s_nop 0
    buffer_load_dwordx4 v20, s[12:15], s71 offen lds
    s_mov_b32 s71, 1179648
    s_add_u32 m0, s72, 51200
    s_nop 0
    buffer_load_dwordx4 v21, s[12:15], s71 offen lds
    s_waitcnt vmcnt(24)
    s_barrier
    v_add_u32 v11, 49152, v42
    ds_read_b64_tr_b16 a[48:49], v11 offset:0
    ds_read_b64_tr_b16 a[50:51], v11 offset:4096
    ds_read_b64_tr_b16 a[52:53], v11 offset:8192
    ds_read_b64_tr_b16 a[54:55], v11 offset:12288
    ds_read_b64_tr_b16 a[64:65], v11 offset:16384
    ds_read_b64_tr_b16 a[66:67], v11 offset:20480
    ds_read_b64_tr_b16 a[68:69], v11 offset:24576
    ds_read_b64_tr_b16 a[70:71], v11 offset:28672
    ds_read_b64_tr_b16 a[80:81], v11 offset:32768
    ds_read_b64_tr_b16 a[82:83], v11 offset:36864
    ds_read_b64_tr_b16 a[84:85], v11 offset:40960
    ds_read_b64_tr_b16 a[86:87], v11 offset:45056
    v_add_u32 v11, 49152, v43
    ds_read_b64_tr_b16 a[56:57], v11 offset:0
    ds_read_b64_tr_b16 a[58:59], v11 offset:4096
    ds_read_b64_tr_b16 a[60:61], v11 offset:8192
    ds_read_b64_tr_b16 a[62:63], v11 offset:12288
    ds_read_b64_tr_b16 a[72:73], v11 offset:16384
    ds_read_b64_tr_b16 a[74:75], v11 offset:20480
    ds_read_b64_tr_b16 a[76:77], v11 offset:24576
    ds_read_b64_tr_b16 a[78:79], v11 offset:28672
    ds_read_b64_tr_b16 a[88:89], v11 offset:32768
    ds_read_b64_tr_b16 a[90:91], v11 offset:36864
    ds_read_b64_tr_b16 a[92:93], v11 offset:40960
    ds_read_b64_tr_b16 a[94:95], v11 offset:45056
    s_waitcnt lgkmcnt(0)
    s_barrier
    s_lshl_b32 s72, s6, 12
    s_mov_b32 s71, 1572864
    s_add_u32 m0, s72, 64512
    s_nop 0
    buffer_load_dwordx4 v20, s[12:15], s71 offen lds
    s_mov_b32 s71, 1572864
    s_add_u32 m0, s72, 65536
    s_nop 0
    buffer_load_dwordx4 v21, s[12:15], s71 offen lds
    s_mov_b32 s71, 1703936
    s_add_u32 m0, s72, 66560
    s_nop 0
    buffer_load_dwordx4 v20, s[12:15], s71 offen lds
    s_mov_b32 s71, 1703936
    s_add_u32 m0, s72, 67584
    s_nop 0
    buffer_load_dwordx4 v21, s[12:15], s71 offen lds
    s_mov_b32 s71, 2097152
    s_add_u32 m0, s72, 80896
    s_nop 0
    buffer_load_dwordx4 v20, s[12:15], s71 offen lds
    s_mov_b32 s71, 2097152
    s_add_u32 m0, s72, 81920
    s_nop 0
    buffer_load_dwordx4 v21, s[12:15], s71 offen lds
    s_mov_b32 s71, 2228224
    s_add_u32 m0, s72, 82944
    s_nop 0
    buffer_load_dwordx4 v20, s[12:15], s71 offen lds
    s_mov_b32 s71, 2228224
    s_add_u32 m0, s72, 83968
    s_nop 0
    buffer_load_dwordx4 v21, s[12:15], s71 offen lds
    s_mov_b32 s71, 2621440
    s_add_u32 m0, s72, 97280
    s_nop 0
    buffer_load_dwordx4 v20, s[12:15], s71 offen lds
    s_mov_b32 s71, 2621440
    s_add_u32 m0, s72, 98304
    s_nop 0
    buffer_load_dwordx4 v21, s[12:15], s71 offen lds
    s_mov_b32 s71, 2752512
    s_add_u32 m0, s72, 99328
    s_nop 0
    buffer_load_dwordx4 v20, s[12:15], s71 offen lds
    s_mov_b32 s71, 2752512
    s_add_u32 m0, s72, 100352
    s_nop 0
    buffer_load_dwordx4 v21, s[12:15], s71 offen lds
    s_waitcnt vmcnt(24)
    s_barrier
    v_add_u32 v11, 98304, v42
    ds_read_b64_tr_b16 a[96:97], v11 offset:0
    ds_read_b64_tr_b16 a[98:99], v11 offset:4096
    ds_read_b64_tr_b16 a[100:101], v11 offset:8192
    ds_read_b64_tr_b16 a[102:103], v11 offset:12288
    ds_read_b64_tr_b16 a[112:113], v11 offset:16384
    ds_read_b64_tr_b16 a[114:115], v11 offset:20480
    ds_read_b64_tr_b16 a[116:117], v11 offset:24576
    ds_read_b64_tr_b16 a[118:119], v11 offset:28672
    ds_read_b64_tr_b16 a[128:129], v11 offset:32768
    ds_read_b64_tr_b16 a[130:131], v11 offset:36864
    ds_read_b64_tr_b16 a[132:133], v11 offset:40960
    ds_read_b64_tr_b16 a[134:135], v11 offset:45056
    v_add_u32 v11, 98304, v43
    ds_read_b64_tr_b16 a[104:105], v11 offset:0
    ds_read_b64_tr_b16 a[106:107], v11 offset:4096
    ds_read_b64_tr_b16 a[108:109], v11 offset:8192
    ds_read_b64_tr_b16 a[110:111], v11 offset:12288
    ds_read_b64_tr_b16 a[120:121], v11 offset:16384
    ds_read_b64_tr_b16 a[122:123], v11 offset:20480
    ds_read_b64_tr_b16 a[124:125], v11 offset:24576
    ds_read_b64_tr_b16 a[126:127], v11 offset:28672
    ds_read_b64_tr_b16 a[136:137], v11 offset:32768
    ds_read_b64_tr_b16 a[138:139], v11 offset:36864
    ds_read_b64_tr_b16 a[140:141], v11 offset:40960
    ds_read_b64_tr_b16 a[142:143], v11 offset:45056
    s_waitcnt lgkmcnt(0)
    s_barrier
    s_lshl_b32 s72, s6, 12
    s_mov_b32 s71, 3145728
    s_add_u32 m0, s72, 113664
    s_nop 0
    buffer_load_dwordx4 v20, s[12:15], s71 offen lds
    s_mov_b32 s71, 3145728
    s_add_u32 m0, s72, 114688
    s_nop 0
    buffer_load_dwordx4 v21, s[12:15], s71 offen lds
    s_mov_b32 s71, 3276800
    s_add_u32 m0, s72, 115712
    s_nop 0
    buffer_load_dwordx4 v20, s[12:15], s71 offen lds
    s_mov_b32 s71, 3276800
    s_add_u32 m0, s72, 116736
    s_nop 0
    buffer_load_dwordx4 v21, s[12:15], s71 offen lds
    s_mov_b32 s71, 3670016
    s_add_u32 m0, s72, 130048
    s_nop 0
    buffer_load_dwordx4 v20, s[12:15], s71 offen lds
    s_mov_b32 s71, 3670016
    s_add_u32 m0, s72, 131072
    s_nop 0
    buffer_load_dwordx4 v21, s[12:15], s71 offen lds
    s_mov_b32 s71, 3801088
    s_add_u32 m0, s72, 132096
    s_nop 0
    buffer_load_dwordx4 v20, s[12:15], s71 offen lds
    s_mov_b32 s71, 3801088
    s_add_u32 m0, s72, 133120
    s_nop 0
    buffer_load_dwordx4 v21, s[12:15], s71 offen lds
    s_mov_b32 s71, 4194304
    s_add_u32 m0, s72, 146432
    s_nop 0
    buffer_load_dwordx4 v20, s[12:15], s71 offen lds
    s_mov_b32 s71, 4194304
    s_add_u32 m0, s72, 147456
    s_nop 0
    buffer_load_dwordx4 v21, s[12:15], s71 offen lds
    s_mov_b32 s71, 4325376
    s_add_u32 m0, s72, 148480
    s_nop 0
    buffer_load_dwordx4 v20, s[12:15], s71 offen lds
    s_mov_b32 s71, 4325376
    s_add_u32 m0, s72, 149504
    s_nop 0
    buffer_load_dwordx4 v21, s[12:15], s71 offen lds
    s_waitcnt vmcnt(24)
    s_barrier
    v_add_u32 v11, 0, v42
    ds_read_b64_tr_b16 a[144:145], v11 offset:0
    ds_read_b64_tr_b16 a[146:147], v11 offset:4096
    ds_read_b64_tr_b16 a[148:149], v11 offset:8192
    ds_read_b64_tr_b16 a[150:151], v11 offset:12288
    ds_read_b64_tr_b16 a[160:161], v11 offset:16384
    ds_read_b64_tr_b16 a[162:163], v11 offset:20480
    ds_read_b64_tr_b16 a[164:165], v11 offset:24576
    ds_read_b64_tr_b16 a[166:167], v11 offset:28672
    ds_read_b64_tr_b16 a[176:177], v11 offset:32768
    ds_read_b64_tr_b16 a[178:179], v11 offset:36864
    ds_read_b64_tr_b16 a[180:181], v11 offset:40960
    ds_read_b64_tr_b16 a[182:183], v11 offset:45056
    v_add_u32 v11, 0, v43
    ds_read_b64_tr_b16 a[152:153], v11 offset:0
    ds_read_b64_tr_b16 a[154:155], v11 offset:4096
    ds_read_b64_tr_b16 a[156:157], v11 offset:8192
    ds_read_b64_tr_b16 a[158:159], v11 offset:12288
    ds_read_b64_tr_b16 a[168:169], v11 offset:16384
    ds_read_b64_tr_b16 a[170:171], v11 offset:20480
    ds_read_b64_tr_b16 a[172:173], v11 offset:24576
    ds_read_b64_tr_b16 a[174:175], v11 offset:28672
    ds_read_b64_tr_b16 a[184:185], v11 offset:32768
    ds_read_b64_tr_b16 a[186:187], v11 offset:36864
    ds_read_b64_tr_b16 a[188:189], v11 offset:40960
    ds_read_b64_tr_b16 a[190:191], v11 offset:45056
    s_waitcnt lgkmcnt(0)
    s_barrier
    s_lshl_b32 s72, s6, 11
    s_mov_b32 s71, 0
    s_add_u32 m0, s72, 15360
    s_nop 0
    buffer_load_dwordx4 v22, s[16:19], s71 offen lds
    s_mov_b32 s71, 131072
    s_add_u32 m0, s72, 16384
    s_nop 0
    buffer_load_dwordx4 v22, s[16:19], s71 offen lds
    s_mov_b32 s71, 524288
    s_add_u32 m0, s72, 23552
    s_nop 0
    buffer_load_dwordx4 v22, s[16:19], s71 offen lds
    s_mov_b32 s71, 655360
    s_add_u32 m0, s72, 24576
    s_nop 0
    buffer_load_dwordx4 v22, s[16:19], s71 offen lds
    s_mov_b32 s71, 1048576
    s_add_u32 m0, s72, 31744
    s_nop 0
    buffer_load_dwordx4 v22, s[16:19], s71 offen lds
    s_mov_b32 s71, 1179648
    s_add_u32 m0, s72, 32768
    s_nop 0
    buffer_load_dwordx4 v22, s[16:19], s71 offen lds
    s_mov_b32 s71, 1572864
    s_add_u32 m0, s72, 39936
    s_nop 0
    buffer_load_dwordx4 v22, s[16:19], s71 offen lds
    s_mov_b32 s71, 1703936
    s_add_u32 m0, s72, 40960
    s_nop 0
    buffer_load_dwordx4 v22, s[16:19], s71 offen lds
    s_mov_b32 s71, 2097152
    s_add_u32 m0, s72, 48128
    s_nop 0
    buffer_load_dwordx4 v22, s[16:19], s71 offen lds
    s_mov_b32 s71, 2228224
    s_add_u32 m0, s72, 49152
    s_nop 0
    buffer_load_dwordx4 v22, s[16:19], s71 offen lds
    s_mov_b32 s71, 2621440
    s_add_u32 m0, s72, 56320
    s_nop 0
    buffer_load_dwordx4 v22, s[16:19], s71 offen lds
    s_mov_b32 s71, 2752512
    s_add_u32 m0, s72, 57344
    s_nop 0
    buffer_load_dwordx4 v22, s[16:19], s71 offen lds
    s_waitcnt vmcnt(24)
    s_barrier
    v_add_u32 v11, 49152, v42
    ds_read_b64_tr_b16 a[192:193], v11 offset:0
    ds_read_b64_tr_b16 a[194:195], v11 offset:4096
    ds_read_b64_tr_b16 a[196:197], v11 offset:8192
    ds_read_b64_tr_b16 a[198:199], v11 offset:12288
    ds_read_b64_tr_b16 a[208:209], v11 offset:16384
    ds_read_b64_tr_b16 a[210:211], v11 offset:20480
    ds_read_b64_tr_b16 a[212:213], v11 offset:24576
    ds_read_b64_tr_b16 a[214:215], v11 offset:28672
    ds_read_b64_tr_b16 a[224:225], v11 offset:32768
    ds_read_b64_tr_b16 a[226:227], v11 offset:36864
    ds_read_b64_tr_b16 a[228:229], v11 offset:40960
    ds_read_b64_tr_b16 a[230:231], v11 offset:45056
    v_add_u32 v11, 49152, v43
    ds_read_b64_tr_b16 a[200:201], v11 offset:0
    ds_read_b64_tr_b16 a[202:203], v11 offset:4096
    ds_read_b64_tr_b16 a[204:205], v11 offset:8192
    ds_read_b64_tr_b16 a[206:207], v11 offset:12288
    ds_read_b64_tr_b16 a[216:217], v11 offset:16384
    ds_read_b64_tr_b16 a[218:219], v11 offset:20480
    ds_read_b64_tr_b16 a[220:221], v11 offset:24576
    ds_read_b64_tr_b16 a[222:223], v11 offset:28672
    ds_read_b64_tr_b16 a[232:233], v11 offset:32768
    ds_read_b64_tr_b16 a[234:235], v11 offset:36864
    ds_read_b64_tr_b16 a[236:237], v11 offset:40960
    ds_read_b64_tr_b16 a[238:239], v11 offset:45056
    s_waitcnt lgkmcnt(0)
    s_barrier
    s_lshl_b32 s72, s6, 11
    s_mov_b32 s71, 3145728
    s_add_u32 m0, s72, 64512
    s_nop 0
    buffer_load_dwordx4 v22, s[16:19], s71 offen lds
    s_mov_b32 s71, 3276800
    s_add_u32 m0, s72, 65536
    s_nop 0
    buffer_load_dwordx4 v22, s[16:19], s71 offen lds
    s_mov_b32 s71, 3670016
    s_add_u32 m0, s72, 72704
    s_nop 0
    buffer_load_dwordx4 v22, s[16:19], s71 offen lds
    s_mov_b32 s71, 3801088
    s_add_u32 m0, s72, 73728
    s_nop 0
    buffer_load_dwordx4 v22, s[16:19], s71 offen lds
    s_mov_b32 s71, 4194304
    s_add_u32 m0, s72, 80896
    s_nop 0
    buffer_load_dwordx4 v22, s[16:19], s71 offen lds
    s_mov_b32 s71, 4325376
    s_add_u32 m0, s72, 81920
    s_nop 0
    buffer_load_dwordx4 v22, s[16:19], s71 offen lds
    s_waitcnt vmcnt(18)
    s_barrier
    v_add_u32 v11, 98304, v42
    ds_read_b64_tr_b16 a[240:241], v11 offset:0
    ds_read_b64_tr_b16 a[242:243], v11 offset:4096
    ds_read_b64_tr_b16 a[244:245], v11 offset:8192
    ds_read_b64_tr_b16 a[246:247], v11 offset:12288
    ds_read_b64_tr_b16 v[80:81], v11 offset:16384
    ds_read_b64_tr_b16 v[82:83], v11 offset:20480
    ds_read_b64_tr_b16 v[84:85], v11 offset:24576
    ds_read_b64_tr_b16 v[86:87], v11 offset:28672
    ds_read_b64_tr_b16 v[96:97], v11 offset:32768
    ds_read_b64_tr_b16 v[98:99], v11 offset:36864
    ds_read_b64_tr_b16 v[100:101], v11 offset:40960
    ds_read_b64_tr_b16 v[102:103], v11 offset:45056
    v_add_u32 v11, 98304, v43
    ds_read_b64_tr_b16 a[248:249], v11 offset:0
    ds_read_b64_tr_b16 a[250:251], v11 offset:4096
    ds_read_b64_tr_b16 a[252:253], v11 offset:8192
    ds_read_b64_tr_b16 a[254:255], v11 offset:12288
    ds_read_b64_tr_b16 v[88:89], v11 offset:16384
    ds_read_b64_tr_b16 v[90:91], v11 offset:20480
    ds_read_b64_tr_b16 v[92:93], v11 offset:24576
    ds_read_b64_tr_b16 v[94:95], v11 offset:28672
    ds_read_b64_tr_b16 v[104:105], v11 offset:32768
    ds_read_b64_tr_b16 v[106:107], v11 offset:36864
    ds_read_b64_tr_b16 v[108:109], v11 offset:40960
    ds_read_b64_tr_b16 v[110:111], v11 offset:45056
    s_waitcnt lgkmcnt(0)
    s_barrier
    s_mul_i32 s72, s6, 18432
    s_mov_b32 s71, 0
    s_add_u32 m0, s72, 89088
    s_nop 0
    buffer_load_dwordx4 v24, s[20:23], s71 offen lds
    s_mov_b32 s71, 0
    s_add_u32 m0, s72, 90112
    s_nop 0
    buffer_load_dwordx4 v25, s[20:23], s71 offen lds
    s_mov_b32 s71, 0
    s_add_u32 m0, s72, 91136
    s_nop 0
    buffer_load_dwordx4 v26, s[20:23], s71 offen lds
    s_mov_b32 s71, 0
    s_add_u32 m0, s72, 92160
    s_nop 0
    buffer_load_dwordx4 v27, s[20:23], s71 offen lds
    s_mov_b32 s71, 0
    s_add_u32 m0, s72, 93184
    s_nop 0
    buffer_load_dwordx4 v28, s[20:23], s71 offen lds
    s_mov_b32 s71, 0
    s_add_u32 m0, s72, 94208
    s_nop 0
    buffer_load_dwordx4 v29, s[20:23], s71 offen lds
    s_mov_b32 s71, 0
    s_add_u32 m0, s72, 95232
    s_nop 0
    buffer_load_dwordx4 v30, s[20:23], s71 offen lds
    s_mov_b32 s71, 0
    s_add_u32 m0, s72, 96256
    s_nop 0
    buffer_load_dwordx4 v31, s[20:23], s71 offen lds
    s_mov_b32 s71, 0
    s_add_u32 m0, s72, 97280
    s_nop 0
    buffer_load_dwordx4 v32, s[20:23], s71 offen lds
    s_mov_b32 s71, 0
    s_add_u32 m0, s72, 98304
    s_nop 0
    buffer_load_dwordx4 v33, s[20:23], s71 offen lds
    s_mov_b32 s71, 0
    s_add_u32 m0, s72, 99328
    s_nop 0
    buffer_load_dwordx4 v34, s[20:23], s71 offen lds
    s_mov_b32 s71, 0
    s_add_u32 m0, s72, 100352
    s_nop 0
    buffer_load_dwordx4 v35, s[20:23], s71 offen lds
    s_mov_b32 s71, 0
    s_add_u32 m0, s72, 101376
    s_nop 0
    buffer_load_dwordx4 v36, s[20:23], s71 offen lds
    s_mov_b32 s71, 0
    s_add_u32 m0, s72, 102400
    s_nop 0
    buffer_load_dwordx4 v37, s[20:23], s71 offen lds
    s_mov_b32 s71, 0
    s_add_u32 m0, s72, 103424
    s_nop 0
    buffer_load_dwordx4 v38, s[20:23], s71 offen lds
    s_mov_b32 s71, 0
    s_add_u32 m0, s72, 104448
    s_nop 0
    buffer_load_dwordx4 v39, s[20:23], s71 offen lds
    s_mov_b32 s71, 0
    s_add_u32 m0, s72, 105472
    s_nop 0
    buffer_load_dwordx4 v40, s[20:23], s71 offen lds
    s_mov_b32 s71, 0
    s_add_u32 m0, s72, 106496
    s_nop 0
    buffer_load_dwordx4 v41, s[20:23], s71 offen lds
    s_waitcnt vmcnt(18)
    s_barrier
    ds_read_b64_tr_b16 v[112:113], v4 offset:0
    ds_read_b64_tr_b16 v[114:115], v4 offset:2048
    ds_read_b64_tr_b16 v[116:117], v4 offset:4096
    ds_read_b64_tr_b16 v[118:119], v4 offset:6144
    ds_read_b64_tr_b16 v[120:121], v4 offset:8192
    ds_read_b64_tr_b16 v[122:123], v4 offset:10240
    ds_read_b64_tr_b16 v[124:125], v4 offset:12288
    ds_read_b64_tr_b16 v[126:127], v4 offset:14336
    ds_read_b64_tr_b16 v[128:129], v4 offset:16384
    ds_read_b64_tr_b16 v[130:131], v4 offset:18432
    ds_read_b64_tr_b16 v[132:133], v4 offset:20480
    ds_read_b64_tr_b16 v[134:135], v4 offset:22528
    ds_read_b64_tr_b16 v[136:137], v4 offset:24576
    ds_read_b64_tr_b16 v[138:139], v4 offset:26624
    ds_read_b64_tr_b16 v[140:141], v4 offset:28672
    ds_read_b64_tr_b16 v[142:143], v4 offset:30720
    ds_read_b64_tr_b16 v[144:145], v4 offset:32768
    ds_read_b64_tr_b16 v[146:147], v4 offset:34816
    ds_read_b64_tr_b16 v[148:149], v4 offset:36864
    ds_read_b64_tr_b16 v[150:151], v4 offset:38912
    ds_read_b64_tr_b16 v[152:153], v4 offset:40960
    ds_read_b64_tr_b16 v[154:155], v4 offset:43008
    ds_read_b64_tr_b16 v[156:157], v4 offset:45056
    ds_read_b64_tr_b16 v[158:159], v4 offset:47104
    ds_read_b64_tr_b16 v[160:161], v4 offset:49152
    ds_read_b64_tr_b16 v[162:163], v4 offset:51200
    ds_read_b64_tr_b16 v[164:165], v4 offset:53248
    ds_read_b64_tr_b16 v[166:167], v4 offset:55296
    ds_read_b64_tr_b16 v[168:169], v4 offset:57344
    ds_read_b64_tr_b16 v[170:171], v4 offset:59392
    ds_read_b64_tr_b16 v[172:173], v4 offset:61440
    ds_read_b64_tr_b16 v[174:175], v4 offset:63488
    ds_read_b64_tr_b16 v[176:177], v3 offset:0
    ds_read_b64_tr_b16 v[178:179], v3 offset:2048
    ds_read_b64_tr_b16 v[180:181], v3 offset:4096
    ds_read_b64_tr_b16 v[182:183], v3 offset:6144
    s_waitcnt lgkmcnt(0)
    s_barrier
    s_lshl_b32 s72, s6, 11
    s_mov_b32 s71, 128
    s_add_u32 m0, s72, 15360
    s_nop 0
    buffer_load_dwordx4 v22, s[16:19], s71 offen lds
    s_mov_b32 s71, 131200
    s_add_u32 m0, s72, 16384
    s_nop 0
    buffer_load_dwordx4 v22, s[16:19], s71 offen lds
    s_mov_b32 s71, 524416
    s_add_u32 m0, s72, 23552
    s_nop 0
    buffer_load_dwordx4 v22, s[16:19], s71 offen lds
    s_mov_b32 s71, 655488
    s_add_u32 m0, s72, 24576
    s_nop 0
    buffer_load_dwordx4 v22, s[16:19], s71 offen lds
    s_mov_b32 s71, 1048704
    s_add_u32 m0, s72, 31744
    s_nop 0
    buffer_load_dwordx4 v22, s[16:19], s71 offen lds
    s_mov_b32 s71, 1179776
    s_add_u32 m0, s72, 32768
    s_nop 0
    buffer_load_dwordx4 v22, s[16:19], s71 offen lds
    s_mov_b32 s71, 1572992
    s_add_u32 m0, s72, 39936
    s_nop 0
    buffer_load_dwordx4 v22, s[16:19], s71 offen lds
    s_mov_b32 s71, 1704064
    s_add_u32 m0, s72, 40960
    s_nop 0
    buffer_load_dwordx4 v22, s[16:19], s71 offen lds
    s_mov_b32 s71, 2097280
    s_add_u32 m0, s72, 48128
    s_nop 0
    buffer_load_dwordx4 v22, s[16:19], s71 offen lds
    s_mov_b32 s71, 2228352
    s_add_u32 m0, s72, 49152
    s_nop 0
    buffer_load_dwordx4 v22, s[16:19], s71 offen lds
    s_mov_b32 s71, 2621568
    s_add_u32 m0, s72, 56320
    s_nop 0
    buffer_load_dwordx4 v22, s[16:19], s71 offen lds
    s_mov_b32 s71, 2752640
    s_add_u32 m0, s72, 57344
    s_nop 0
    buffer_load_dwordx4 v22, s[16:19], s71 offen lds
    s_mov_b32 s71, 3145856
    s_add_u32 m0, s72, 64512
    s_nop 0
    buffer_load_dwordx4 v22, s[16:19], s71 offen lds
    s_mov_b32 s71, 3276928
    s_add_u32 m0, s72, 65536
    s_nop 0
    buffer_load_dwordx4 v22, s[16:19], s71 offen lds
    s_mov_b32 s71, 3670144
    s_add_u32 m0, s72, 72704
    s_nop 0
    buffer_load_dwordx4 v22, s[16:19], s71 offen lds
    s_mov_b32 s71, 3801216
    s_add_u32 m0, s72, 73728
    s_nop 0
    buffer_load_dwordx4 v22, s[16:19], s71 offen lds
    s_mov_b32 s71, 4194432
    s_add_u32 m0, s72, 80896
    s_nop 0
    buffer_load_dwordx4 v22, s[16:19], s71 offen lds
    s_mov_b32 s71, 4325504
    s_add_u32 m0, s72, 81920
    s_nop 0
    buffer_load_dwordx4 v22, s[16:19], s71 offen lds
    s_waitcnt vmcnt(18)
    s_barrier
    ds_read_b64_tr_b16 v[184:185], v5 offset:0
    ds_read_b64_tr_b16 v[186:187], v5 offset:18432
    ds_read_b64_tr_b16 v[188:189], v5 offset:36864
    ds_read_b64_tr_b16 v[190:191], v5 offset:55296
    ds_read_b64_tr_b16 v[192:193], v5 offset:128
    ds_read_b64_tr_b16 v[194:195], v5 offset:18560
    ds_read_b64_tr_b16 v[196:197], v5 offset:36992
    ds_read_b64_tr_b16 v[198:199], v5 offset:55424
    ds_read_b64_tr_b16 v[200:201], v5 offset:256
    ds_read_b64_tr_b16 v[202:203], v5 offset:18688
    ds_read_b64_tr_b16 v[204:205], v5 offset:37120
    ds_read_b64_tr_b16 v[206:207], v5 offset:55552
    ds_read_b64_tr_b16 v[208:209], v5 offset:384
    ds_read_b64_tr_b16 v[210:211], v5 offset:18816
    ds_read_b64_tr_b16 v[212:213], v5 offset:37248
    ds_read_b64_tr_b16 v[214:215], v5 offset:55680
    ds_read_b64_tr_b16 v[216:217], v5 offset:512
    ds_read_b64_tr_b16 v[218:219], v5 offset:18944
    ds_read_b64_tr_b16 v[220:221], v5 offset:37376
    ds_read_b64_tr_b16 v[222:223], v5 offset:55808
    ds_read_b64_tr_b16 v[224:225], v5 offset:640
    ds_read_b64_tr_b16 v[226:227], v5 offset:19072
    ds_read_b64_tr_b16 v[228:229], v5 offset:37504
    ds_read_b64_tr_b16 v[230:231], v5 offset:55936
    ds_read_b64_tr_b16 v[232:233], v5 offset:768
    ds_read_b64_tr_b16 v[234:235], v5 offset:19200
    ds_read_b64_tr_b16 v[236:237], v5 offset:37632
    ds_read_b64_tr_b16 v[238:239], v5 offset:56064
    ds_read_b64_tr_b16 v[240:241], v5 offset:896
    ds_read_b64_tr_b16 v[242:243], v5 offset:19328
    ds_read_b64_tr_b16 v[244:245], v5 offset:37760
    ds_read_b64_tr_b16 v[246:247], v5 offset:56192
    ds_read_b64_tr_b16 v[248:249], v5 offset:1024
    ds_read_b64_tr_b16 v[250:251], v5 offset:19456
    ds_read_b64_tr_b16 v[252:253], v5 offset:37888
    ds_read_b64_tr_b16 v[254:255], v5 offset:56320
    s_waitcnt lgkmcnt(0)
    s_barrier
    s_mul_i32 s72, s6, 18432
    s_mov_b32 s71, 36864
    s_add_u32 m0, s72, 89088
    s_nop 0
    buffer_load_dwordx4 v24, s[20:23], s71 offen lds
    s_mov_b32 s71, 36864
    s_add_u32 m0, s72, 90112
    s_nop 0
    buffer_load_dwordx4 v25, s[20:23], s71 offen lds
    s_mov_b32 s71, 36864
    s_add_u32 m0, s72, 91136
    s_nop 0
    buffer_load_dwordx4 v26, s[20:23], s71 offen lds
    s_mov_b32 s71, 36864
    s_add_u32 m0, s72, 92160
    s_nop 0
    buffer_load_dwordx4 v27, s[20:23], s71 offen lds
    s_mov_b32 s71, 36864
    s_add_u32 m0, s72, 93184
    s_nop 0
    buffer_load_dwordx4 v28, s[20:23], s71 offen lds
    s_mov_b32 s71, 36864
    s_add_u32 m0, s72, 94208
    s_nop 0
    buffer_load_dwordx4 v29, s[20:23], s71 offen lds
    s_mov_b32 s71, 36864
    s_add_u32 m0, s72, 95232
    s_nop 0
    buffer_load_dwordx4 v30, s[20:23], s71 offen lds
    s_mov_b32 s71, 36864
    s_add_u32 m0, s72, 96256
    s_nop 0
    buffer_load_dwordx4 v31, s[20:23], s71 offen lds
    s_mov_b32 s71, 36864
    s_add_u32 m0, s72, 97280
    s_nop 0
    buffer_load_dwordx4 v32, s[20:23], s71 offen lds
    s_mov_b32 s71, 36864
    s_add_u32 m0, s72, 98304
    s_nop 0
    buffer_load_dwordx4 v33, s[20:23], s71 offen lds
    s_mov_b32 s71, 36864
    s_add_u32 m0, s72, 99328
    s_nop 0
    buffer_load_dwordx4 v34, s[20:23], s71 offen lds
    s_mov_b32 s71, 36864
    s_add_u32 m0, s72, 100352
    s_nop 0
    buffer_load_dwordx4 v35, s[20:23], s71 offen lds
    s_mov_b32 s71, 36864
    s_add_u32 m0, s72, 101376
    s_nop 0
    buffer_load_dwordx4 v36, s[20:23], s71 offen lds
    s_mov_b32 s71, 36864
    s_add_u32 m0, s72, 102400
    s_nop 0
    buffer_load_dwordx4 v37, s[20:23], s71 offen lds
    s_mov_b32 s71, 36864
    s_add_u32 m0, s72, 103424
    s_nop 0
    buffer_load_dwordx4 v38, s[20:23], s71 offen lds
    s_mov_b32 s71, 36864
    s_add_u32 m0, s72, 104448
    s_nop 0
    buffer_load_dwordx4 v39, s[20:23], s71 offen lds
    s_mov_b32 s71, 36864
    s_add_u32 m0, s72, 105472
    s_nop 0
    buffer_load_dwordx4 v40, s[20:23], s71 offen lds
    s_mov_b32 s71, 36864
    s_add_u32 m0, s72, 106496
    s_nop 0
    buffer_load_dwordx4 v41, s[20:23], s71 offen lds
    s_mul_i32 s68, s6, 18432
    s_add_u32 s68, s68, 15360
    v_lshlrev_b32 v0, 4, v12
    v_add_u32 v6, s68, v0
    v_add_u32 v7, 73728, v6
    s_waitcnt vmcnt(18)
    s_barrier
    ds_read_b64_tr_b16 v[8:9], v4 offset:0
    ds_read_b64_tr_b16 v[10:11], v4 offset:2048
    ds_read_b64_tr_b16 v[12:13], v4 offset:4096
    ds_read_b64_tr_b16 v[14:15], v4 offset:6144
    ds_read_b64_tr_b16 v[16:17], v4 offset:8192
    ds_read_b64_tr_b16 v[18:19], v4 offset:10240
    ds_read_b64_tr_b16 v[20:21], v4 offset:12288
    ds_read_b64_tr_b16 v[22:23], v4 offset:14336
    ds_read_b64_tr_b16 v[24:25], v4 offset:16384
    ds_read_b64_tr_b16 v[26:27], v4 offset:18432
    ds_read_b64_tr_b16 v[28:29], v4 offset:20480
    ds_read_b64_tr_b16 v[30:31], v4 offset:22528
    ds_read_b64_tr_b16 v[32:33], v4 offset:24576
    ds_read_b64_tr_b16 v[34:35], v4 offset:26624
    ds_read_b64_tr_b16 v[36:37], v4 offset:28672
    ds_read_b64_tr_b16 v[38:39], v4 offset:30720
    ds_read_b64_tr_b16 v[40:41], v4 offset:32768
    ds_read_b64_tr_b16 v[42:43], v4 offset:34816
    ds_read_b64_tr_b16 v[44:45], v4 offset:36864
    ds_read_b64_tr_b16 v[46:47], v4 offset:38912
    ds_read_b64_tr_b16 v[48:49], v4 offset:40960
    ds_read_b64_tr_b16 v[50:51], v4 offset:43008
    ds_read_b64_tr_b16 v[52:53], v4 offset:45056
    ds_read_b64_tr_b16 v[54:55], v4 offset:47104
    ds_read_b64_tr_b16 v[56:57], v4 offset:49152
    ds_read_b64_tr_b16 v[58:59], v4 offset:51200
    ds_read_b64_tr_b16 v[60:61], v4 offset:53248
    ds_read_b64_tr_b16 v[62:63], v4 offset:55296
    ds_read_b64_tr_b16 v[64:65], v4 offset:57344
    ds_read_b64_tr_b16 v[66:67], v4 offset:59392
    ds_read_b64_tr_b16 v[68:69], v4 offset:61440
    ds_read_b64_tr_b16 v[70:71], v4 offset:63488
    ds_read_b64_tr_b16 v[72:73], v3 offset:0
    ds_read_b64_tr_b16 v[74:75], v3 offset:2048
    ds_read_b64_tr_b16 v[76:77], v3 offset:4096
    ds_read_b64_tr_b16 v[78:79], v3 offset:6144
    s_waitcnt lgkmcnt(0)
    s_barrier
    ds_write_b128 v6, v[8:11] offset:0
    ds_write_b128 v6, v[12:15] offset:1024
    ds_write_b128 v6, v[16:19] offset:2048
    ds_write_b128 v6, v[20:23] offset:3072
    ds_write_b128 v6, v[24:27] offset:4096
    ds_write_b128 v6, v[28:31] offset:5120
    ds_write_b128 v6, v[32:35] offset:6144
    ds_write_b128 v6, v[36:39] offset:7168
    ds_write_b128 v6, v[40:43] offset:8192
    ds_write_b128 v6, v[44:47] offset:9216
    ds_write_b128 v6, v[48:51] offset:10240
    ds_write_b128 v6, v[52:55] offset:11264
    ds_write_b128 v6, v[56:59] offset:12288
    ds_write_b128 v6, v[60:63] offset:13312
    ds_write_b128 v6, v[64:67] offset:14336
    ds_write_b128 v6, v[68:71] offset:15360
    ds_write_b128 v6, v[72:75] offset:16384
    ds_write_b128 v6, v[76:79] offset:17408
    s_waitcnt lgkmcnt(0)
    s_waitcnt vmcnt(0)
    s_barrier
    ds_read_b64_tr_b16 v[8:9], v5 offset:0
    ds_read_b64_tr_b16 v[10:11], v5 offset:18432
    ds_read_b64_tr_b16 v[12:13], v5 offset:36864
    ds_read_b64_tr_b16 v[14:15], v5 offset:55296
    ds_read_b64_tr_b16 v[16:17], v5 offset:128
    ds_read_b64_tr_b16 v[18:19], v5 offset:18560
    ds_read_b64_tr_b16 v[20:21], v5 offset:36992
    ds_read_b64_tr_b16 v[22:23], v5 offset:55424
    ds_read_b64_tr_b16 v[24:25], v5 offset:256
    ds_read_b64_tr_b16 v[26:27], v5 offset:18688
    ds_read_b64_tr_b16 v[28:29], v5 offset:37120
    ds_read_b64_tr_b16 v[30:31], v5 offset:55552
    ds_read_b64_tr_b16 v[32:33], v5 offset:384
    ds_read_b64_tr_b16 v[34:35], v5 offset:18816
    ds_read_b64_tr_b16 v[36:37], v5 offset:37248
    ds_read_b64_tr_b16 v[38:39], v5 offset:55680
    ds_read_b64_tr_b16 v[40:41], v5 offset:512
    ds_read_b64_tr_b16 v[42:43], v5 offset:18944
    ds_read_b64_tr_b16 v[44:45], v5 offset:37376
    ds_read_b64_tr_b16 v[46:47], v5 offset:55808
    ds_read_b64_tr_b16 v[48:49], v5 offset:640
    ds_read_b64_tr_b16 v[50:51], v5 offset:19072
    ds_read_b64_tr_b16 v[52:53], v5 offset:37504
    ds_read_b64_tr_b16 v[54:55], v5 offset:55936
    ds_read_b64_tr_b16 v[56:57], v5 offset:768
    ds_read_b64_tr_b16 v[58:59], v5 offset:19200
    ds_read_b64_tr_b16 v[60:61], v5 offset:37632
    ds_read_b64_tr_b16 v[62:63], v5 offset:56064
    ds_read_b64_tr_b16 v[64:65], v5 offset:896
    ds_read_b64_tr_b16 v[66:67], v5 offset:19328
    ds_read_b64_tr_b16 v[68:69], v5 offset:37760
    ds_read_b64_tr_b16 v[70:71], v5 offset:56192
    ds_read_b64_tr_b16 v[72:73], v5 offset:1024
    ds_read_b64_tr_b16 v[74:75], v5 offset:19456
    ds_read_b64_tr_b16 v[76:77], v5 offset:37888
    ds_read_b64_tr_b16 v[78:79], v5 offset:56320
    s_waitcnt lgkmcnt(0)
    s_barrier
    ds_write_b128 v7, v[8:11] offset:0
    ds_write_b128 v7, v[12:15] offset:1024
    ds_write_b128 v7, v[16:19] offset:2048
    ds_write_b128 v7, v[20:23] offset:3072
    ds_write_b128 v7, v[24:27] offset:4096
    ds_write_b128 v7, v[28:31] offset:5120
    ds_write_b128 v7, v[32:35] offset:6144
    ds_write_b128 v7, v[36:39] offset:7168
    ds_write_b128 v7, v[40:43] offset:8192
    ds_write_b128 v7, v[44:47] offset:9216
    ds_write_b128 v7, v[48:51] offset:10240
    ds_write_b128 v7, v[52:55] offset:11264
    ds_write_b128 v7, v[56:59] offset:12288
    ds_write_b128 v7, v[60:63] offset:13312
    ds_write_b128 v7, v[64:67] offset:14336
    ds_write_b128 v7, v[68:71] offset:15360
    ds_write_b128 v7, v[72:75] offset:16384
    ds_write_b128 v7, v[76:79] offset:17408
    s_waitcnt lgkmcnt(0)
    v_mov_b32 v4, v6
    v_lshrrev_b32 v12, 4, v0
    v_lshrrev_b32 v13, 4, v12
    v_and_b32 v14, 15, v12
    v_mov_b32 v1, 0x44444444
    v_mov_b32 v15, 0xeeeeeeee
    v_cmp_le_u32 vcc, 8, v14
    s_nop 1
    v_cndmask_b32 v1, v1, v15, vcc
    v_and_b32 v20, 1, v13
    v_lshlrev_b32 v15, 2, v20
    v_and_b32 v16, 7, v14
    v_sub_u32 v15, v16, v15
    v_mov_b32 v2, 0
    v_mov_b32 v17, 0x3f80
    v_cmp_eq_u32 vcc, 0, v15
    s_nop 1
    v_cndmask_b32 v2, v2, v17, vcc
    v_mov_b32 v17, 0x3f800000
    v_cmp_eq_u32 vcc, 1, v15
    s_nop 1
    v_cndmask_b32 v2, v2, v17, vcc
    v_mov_b32 v3, 0
    v_mov_b32 v17, 0x3f80
    v_cmp_eq_u32 vcc, 2, v15
    s_nop 1
    v_cndmask_b32 v3, v3, v17, vcc
    v_mov_b32 v17, 0x3f800000
    v_cmp_eq_u32 vcc, 3, v15
    s_nop 1
    v_cndmask_b32 v3, v3, v17, vcc
    v_lshlrev_b32 v17, 4, v16
    v_lshl_add_u32 v17, v13, 7, v17
    s_lshl_b32 s68, s6, 9
    v_add_u32 v7, s68, v17
    v_lshrrev_b32 v18, 3, v14
    v_lshl_add_u32 v8, v18, 9, v17
    v_lshl_add_u32 v5, v18, 11, v17
    v_lshl_add_u32 v6, v18, 3, v17
    v_lshrrev_b32 v19, 1, v13
    v_lshl_add_u32 v19, v19, 3, v20
    s_lshl_b32 s68, s6, 1
    v_add_u32 v19, s68, v19
    v_lshlrev_b32 v9, 12, v19
    v_lshl_add_u32 v9, v16, 4, v9
    v_lshl_add_u32 v9, v18, 3, v9
    s_lshl_b32 s68, s3, 7
    v_add_u32 v9, s68, v9
    s_lshl_b32 s73, s6, 5
    s_add_u32 s73, s73, s3
    v_lshrrev_b32 v19, 1, v13
    v_lshlrev_b32 v10, 2, v19
    v_lshl_add_u32 v10, v16, 4, v10
    v_lshl_add_u32 v10, v20, 3, v10
    s_lshl_b32 s68, s73, 7
    v_add_u32 v10, s68, v10
    s_lshl_b32 s74, s73, 12
    v_lshrrev_b32 v39, 1, v0
    v_xor_b32 v39, v39, v0
    v_bfe_i32 v39, v39, 6, 1
    v_and_b32 v39, 0xc0, v39
    v_xor_b32 v39, v39, v0
    s_mov_b32 s64, 400000
    s_mov_b32 s65, 0
    s_mov_b32 s75, 0
    s_mov_b32 s76, 9216
    s_mov_b32 s77, 18432
    s_mov_b32 s78, 0
    s_lshl_b32 s79, s3, 13
    s_mov_b32 s80, 0x3e0293ee
    s_mov_b32 s82, 0x00ff00ff
    s_mov_b32 s83, 0x00ff00ff
    s_lshl_b32 s81, s3, 7
    s_add_u32 s81, s81, 28672
    s_mov_b32 s86, 0
    s_cmp_lg_u32 s6, 3
    s_cbranch_scc1 nofl0
    s_lshl_b32 s71, s86, 5
    s_add_u32 s71, s71, s3
    s_lshl_b32 s71, s71, 7
    s_bitset1_b32 s71, 16
    v_mov_b32 v28, 0
    s_buffer_load_dword s72, s[48:51], s71
    s_waitcnt lgkmcnt(0)
    s_cmp_lg_u32 s72, 0
    s_cbranch_scc1 flo_13
fl_12:
    buffer_load_dword v29, v28, s[48:51], s71 offen sc1
    s_waitcnt vmcnt(0)
    v_cmp_ne_u32 vcc, 0, v29
    s_cbranch_vccnz flo_13
    s_cmp_eq_u32 s64, 0
    s_cbranch_scc1 flo_13
    s_sub_u32 s64, s64, 1
    s_branch fl_12
flo_13:
nofl0:
    s_barrier
    s_mul_i32 s84, s6, 3072
    s_mov_b32 m0, 162816
    s_mov_b32 s34, 33554432
    s_mov_b32 s47, 33550336
    s_lshr_b32 s85, s6, 1
    s_lshl_b32 s85, s85, 24
    s_and_b32 s46, s6, 1
    s_lshl_b32 s46, s46, 12
    s_add_u32 s85, s85, s46
    s_add_u32 s85, s85, 262144
    s_mov_b32 s46, 589824
    s_mul_i32 s30, s73, 2304
    s_add_u32 s31, s75, s84
    v_add_u32 v11, s84, v0
step:
    s_cmp_lg_u32 s6, 3
    s_cbranch_scc1 mp0
    v_mov_b64 v[40:41], 0
    v_mov_b64 v[42:43], 0
    v_mov_b64 v[44:45], 0
    v_mov_b64 v[46:47], 0
    v_mov_b64 v[48:49], 0
    v_mov_b64 v[50:51], 0
    v_mov_b64 v[52:53], 0
    v_mov_b64 v[54:55], 0
    v_mov_b64 v[56:57], 0
    v_mov_b64 v[58:59], 0
    v_mov_b64 v[60:61], 0
    v_mov_b64 v[62:63], 0
    s_branch mp3
mp0:
    buffer_load_dwordx4 v[12:15], v39, s[56:59], s31 offen offset:0 sc1
    buffer_load_dwordx4 v[16:19], v39, s[56:59], s31 offen offset:1024 sc1
    buffer_load_dwordx4 v[20:23], v39, s[56:59], s31 offen offset:2048 sc1
    s_waitcnt vmcnt(4)
    v_mov_b64 v[40:41], 0
    v_mov_b64 v[42:43], 0
    v_mov_b64 v[44:45], 0
    v_mov_b64 v[46:47], 0
    v_mov_b64 v[48:49], 0
    v_mov_b64 v[50:51], 0
    v_mov_b64 v[52:53], 0
    v_mov_b64 v[54:55], 0
    v_mov_b64 v[56:57], 0
    v_mov_b64 v[58:59], 0
    v_mov_b64 v[60:61], 0
    v_mov_b64 v[62:63], 0
mp:
    buffer_load_dwordx4 v[24:27], v39, s[56:59], s31 offen offset:0 sc1
    buffer_load_dwordx4 v[72:75], v39, s[56:59], s31 offen offset:1024 sc1
    buffer_load_dwordx4 v[76:79], v39, s[56:59], s31 offen offset:2048 sc1
    s_waitcnt vmcnt(3)
    ds_write_b128 v11, v[12:15]
    v_max3_u32 v36, v12, v13, v14
    v_max3_u32 v37, v15, v16, v17
    ds_write_b128 v11, v[16:19] offset:1024
    v_max3_u32 v38, v18, v19, v20
    v_max3_u32 v36, v36, v21, v22
    ds_write_b128 v11, v[20:23] offset:2048
    v_max3_u32 v37, v37, v38, v23
    v_max_u32 v36, v36, v37
    v_cmp_eq_u32 vcc, -1, v36
    s_cbranch_vccz mpo
    s_waitcnt lgkmcnt(0)
    buffer_load_dwordx4 v[12:15], v39, s[56:59], s31 offen offset:0 sc1
    buffer_load_dwordx4 v[16:19], v39, s[56:59], s31 offen offset:1024 sc1
    buffer_load_dwordx4 v[20:23], v39, s[56:59], s31 offen offset:2048 sc1
    s_waitcnt vmcnt(3)
    ds_write_b128 v11, v[24:27]
    v_max3_u32 v36, v24, v25, v26
    v_max3_u32 v37, v27, v72, v73
    ds_write_b128 v11, v[72:75] offset:1024
    v_max3_u32 v38, v74, v75, v76
    v_max3_u32 v36, v36, v77, v78
    ds_write_b128 v11, v[76:79] offset:2048
    v_max3_u32 v37, v37, v38, v79
    v_max_u32 v36, v36, v37
    v_cmp_eq_u32 vcc, -1, v36
    s_cbranch_vccz mpo
    s_waitcnt lgkmcnt(0)
    s_cmp_eq_u32 s64, 0
    s_cbranch_scc1 mpo
    s_sub_u32 s64, s64, 1
    s_branch mp
mpo:
mp3:
    s_lshl_b32 s87, s7, 1
    s_add_u32 s87, s87, s79
    s_add_u32 s88, s79, s7
    s_add_u32 s89, s88, 4096
    s_waitcnt lgkmcnt(0)
    s_barrier
    ds_read_b128 v[28:31], v0 offset:0
    ds_read_b128 v[32:35], v0 offset:1024
    ds_read_b128 v[36:39], v0 offset:2048
    ds_read_b128 v[64:67], v4 offset:0
    ds_read_b128 v[68:71], v4 offset:1024
    buffer_load_dwordx4 v[12:15], v0, s[32:35], s87 offen offset:0
    buffer_load_dwordx4 v[16:19], v0, s[32:35], s87 offen offset:1024
    s_add_u32 s71, s79, s85
    s_min_u32 s71, s71, s47
    s_add_u32 s72, s46, s74
    s_cmp_ge_u32 s73, 72
    s_cselect_b64 vcc, -1, 0
    s_waitcnt lgkmcnt(4)
    v_smfmac_f32_16x16x64_bf16 v[40:43], v[28:31], a[0:7], v1
    v_smfmac_f32_16x16x64_bf16 v[44:47], v[28:31], a[8:15], v1
    v_smfmac_f32_16x16x64_bf16 v[48:51], v[28:31], a[144:151], v1
    v_smfmac_f32_16x16x64_bf16 v[52:55], v[28:31], a[152:159], v1
    s_waitcnt vmcnt(2)
    ds_read_b128 v[72:75], v4 offset:2048
    ds_read_b128 v[76:79], v4 offset:3072
    v_mov_b64 v[24:25], -1
    v_mov_b64 v[26:27], -1
    v_smfmac_f32_16x16x64_bf16 v[56:59], v[28:31], v[112:119], v1
    s_waitcnt lgkmcnt(2)
    v_smfmac_f32_16x16x64_bf16 v[60:63], v[28:31], v[64:71], v1
    ds_read_b128 v[64:67], v4 offset:4096
    ds_read_b128 v[68:71], v4 offset:5120
    ds_read_b128 v[28:31], v0 offset:3072
    v_smfmac_f32_16x16x64_bf16 v[40:43], v[32:35], a[16:23], v1
    v_smfmac_f32_16x16x64_bf16 v[44:47], v[32:35], a[24:31], v1
    buffer_load_dwordx4 v[20:23], v0, s[36:39], s88 offen
    s_cmp_lg_u32 s6, 3
    s_cbranch_scc1 ra2
    v_mov_b32 v11, s65
    s_mov_b64 exec, 1
    buffer_store_dword v11, v0, s[48:51], s81 offen sc1
    s_mov_b64 exec, -1
ra2:
    v_smfmac_f32_16x16x64_bf16 v[48:51], v[32:35], a[160:167], v1
    v_smfmac_f32_16x16x64_bf16 v[52:55], v[32:35], a[168:175], v1
    s_cbranch_vccnz nr_14
    buffer_store_dword v24, v10, s[56:59], s77 offen
nr_14:
    v_smfmac_f32_16x16x64_bf16 v[56:59], v[32:35], v[120:127], v1
    s_waitcnt lgkmcnt(3)
    v_smfmac_f32_16x16x64_bf16 v[60:63], v[32:35], v[72:79], v1
    ds_read_b128 v[72:75], v4 offset:6144
    ds_read_b128 v[76:79], v4 offset:7168
    ds_read_b128 v[32:35], v0 offset:4096
    v_smfmac_f32_16x16x64_bf16 v[40:43], v[36:39], a[32:39], v1
    v_smfmac_f32_16x16x64_bf16 v[44:47], v[36:39], a[40:47], v1
    s_cbranch_vccnz nr_15
    buffer_store_dwordx4 v[24:27], v0, s[52:55], s72 offen offset:0
nr_15:
    v_smfmac_f32_16x16x64_bf16 v[48:51], v[36:39], a[176:183], v1
    v_smfmac_f32_16x16x64_bf16 v[52:55], v[36:39], a[184:191], v1
    v_and_b32 v11, 0x1f0, v0
    v_lshlrev_b32 v11, 3, v11
    v_smfmac_f32_16x16x64_bf16 v[56:59], v[36:39], v[128:135], v1
    s_cbranch_vccnz nr_16
    buffer_store_dwordx4 v[24:27], v0, s[52:55], s72 offen offset:1024
nr_16:
    s_waitcnt lgkmcnt(4)
    v_smfmac_f32_16x16x64_bf16 v[60:63], v[36:39], v[64:71], v1
    ds_read_b128 v[64:67], v4 offset:8192
    ds_read_b128 v[68:71], v4 offset:9216
    ds_read_b128 v[36:39], v0 offset:5120
    s_waitcnt lgkmcnt(6)
    v_smfmac_f32_16x16x64_bf16 v[40:43], v[28:31], a[48:55], v1
    v_smfmac_f32_16x16x64_bf16 v[44:47], v[28:31], a[56:63], v1
    s_cbranch_vccnz nr_17
    buffer_store_dwordx4 v[24:27], v0, s[52:55], s72 offen offset:2048
nr_17:
    v_smfmac_f32_16x16x64_bf16 v[48:51], v[28:31], a[192:199], v1
    v_smfmac_f32_16x16x64_bf16 v[52:55], v[28:31], a[200:207], v1
    v_smfmac_f32_16x16x64_bf16 v[56:59], v[28:31], v[136:143], v1
    s_cbranch_vccnz nr_18
    buffer_store_dwordx4 v[24:27], v0, s[52:55], s72 offen offset:3072
nr_18:
    s_waitcnt lgkmcnt(4)
    v_smfmac_f32_16x16x64_bf16 v[60:63], v[28:31], v[72:79], v1
    ds_read_b128 v[72:75], v4 offset:10240
    ds_read_b128 v[76:79], v4 offset:11264
    ds_read_b128 v[28:31], v0 offset:6144
    s_waitcnt lgkmcnt(6)
    v_smfmac_f32_16x16x64_bf16 v[40:43], v[32:35], a[64:71], v1
    v_smfmac_f32_16x16x64_bf16 v[44:47], v[32:35], a[72:79], v1
    buffer_load_dwordx4 v[24:27], v0, s[36:39], s89 offen
    v_smfmac_f32_16x16x64_bf16 v[48:51], v[32:35], a[208:215], v1
    v_smfmac_f32_16x16x64_bf16 v[52:55], v[32:35], a[216:223], v1
    buffer_load_dword v11, s[32:35], s71 offen lds
    v_smfmac_f32_16x16x64_bf16 v[56:59], v[32:35], v[144:151], v1
    s_waitcnt lgkmcnt(4)
    v_smfmac_f32_16x16x64_bf16 v[60:63], v[32:35], v[64:71], v1
    ds_read_b128 v[64:67], v4 offset:12288
    ds_read_b128 v[68:71], v4 offset:13312
    ds_read_b128 v[32:35], v0 offset:7168
    s_waitcnt lgkmcnt(6)
    v_smfmac_f32_16x16x64_bf16 v[40:43], v[36:39], a[80:87], v1
    v_smfmac_f32_16x16x64_bf16 v[44:47], v[36:39], a[88:95], v1
    v_smfmac_f32_16x16x64_bf16 v[48:51], v[36:39], a[224:231], v1
    v_smfmac_f32_16x16x64_bf16 v[52:55], v[36:39], a[232:239], v1
    v_smfmac_f32_16x16x64_bf16 v[56:59], v[36:39], v[152:159], v1
    s_waitcnt lgkmcnt(4)
    v_smfmac_f32_16x16x64_bf16 v[60:63], v[36:39], v[72:79], v1
    ds_read_b128 v[72:75], v4 offset:14336
    ds_read_b128 v[76:79], v4 offset:15360
    ds_read_b128 v[36:39], v0 offset:8192
    s_waitcnt lgkmcnt(6)
    v_smfmac_f32_16x16x64_bf16 v[40:43], v[28:31], a[96:103], v1
    v_smfmac_f32_16x16x64_bf16 v[44:47], v[28:31], a[104:111], v1
    v_smfmac_f32_16x16x64_bf16 v[48:51], v[28:31], a[240:247], v1
    v_smfmac_f32_16x16x64_bf16 v[52:55], v[28:31], a[248:255], v1
    v_smfmac_f32_16x16x64_bf16 v[56:59], v[28:31], v[160:167], v1
    s_waitcnt lgkmcnt(4)
    v_smfmac_f32_16x16x64_bf16 v[60:63], v[28:31], v[64:71], v1
    ds_read_b128 v[64:67], v4 offset:16384
    ds_read_b128 v[68:71], v4 offset:17408
    s_waitcnt lgkmcnt(5)
    v_smfmac_f32_16x16x64_bf16 v[40:43], v[32:35], a[112:119], v1
    v_smfmac_f32_16x16x64_bf16 v[44:47], v[32:35], a[120:127], v1
    v_smfmac_f32_16x16x64_bf16 v[48:51], v[32:35], v[80:87], v1
    v_smfmac_f32_16x16x64_bf16 v[52:55], v[32:35], v[88:95], v1
    s_waitcnt lgkmcnt(2)
    v_smfmac_f32_16x16x64_bf16 v[40:43], v[36:39], a[128:135], v1
    v_smfmac_f32_16x16x64_bf16 v[44:47], v[36:39], a[136:143], v1
    v_smfmac_f32_16x16x64_bf16 v[48:51], v[36:39], v[96:103], v1
    v_smfmac_f32_16x16x64_bf16 v[52:55], v[36:39], v[104:111], v1
    v_smfmac_f32_16x16x64_bf16 v[56:59], v[32:35], v[168:175], v1
    v_smfmac_f32_16x16x64_bf16 v[60:63], v[32:35], v[72:79], v1
    v_add_u32 v11, 73728, v4
    s_nop 3
    v_cvt_pk_bf16_f32 v28, v40, v41
    v_cvt_pk_bf16_f32 v29, v42, v43
    v_cvt_pk_bf16_f32 v30, v44, v45
    v_cvt_pk_bf16_f32 v31, v46, v47
    ds_read_b128 v[72:75], v11 offset:16384
    ds_read_b128 v[76:79], v11 offset:17408
    v_mfma_f32_16x16x16_bf16 v[40:43], v[28:29], v[2:3], 0
    v_mfma_f32_16x16x16_bf16 v[44:47], v[30:31], v[2:3], 0
    v_cvt_pk_bf16_f32 v28, v48, v49
    v_cvt_pk_bf16_f32 v29, v50, v51
    v_cvt_pk_bf16_f32 v30, v52, v53
    v_cvt_pk_bf16_f32 v31, v54, v55
    s_nop 1
    v_mfma_f32_16x16x16_bf16 v[48:51], v[28:29], v[2:3], 0
    v_mfma_f32_16x16x16_bf16 v[52:55], v[30:31], v[2:3], 0
    v_smfmac_f32_16x16x64_bf16 v[56:59], v[36:39], v[176:183], v1
    v_cvt_pk_bf16_f32 v28, v40, v41
    v_cvt_pk_bf16_f32 v29, v42, v43
    v_cvt_pk_bf16_f32 v30, v44, v45
    v_cvt_pk_bf16_f32 v31, v46, v47
    s_nop 2
    v_cvt_pk_bf16_f32 v40, v48, v49
    v_cvt_pk_bf16_f32 v41, v50, v51
    v_cvt_pk_bf16_f32 v42, v52, v53
    v_cvt_pk_bf16_f32 v43, v54, v55
    s_waitcnt vmcnt(3)
    v_mfma_f32_16x16x32_bf16 v[48:51], v[12:15], v[28:31], 0
    v_mfma_f32_16x16x32_bf16 v[52:55], v[16:19], v[28:31], 0
    v_mfma_f32_16x16x32_bf16 v[44:47], v[40:43], v[28:31], 0
    s_waitcnt lgkmcnt(2)
    v_smfmac_f32_16x16x64_bf16 v[60:63], v[36:39], v[64:71], v1
    buffer_store_dwordx4 v[40:43], v0, s[60:63], s87 offen sc1
    ds_read_b128 v[64:67], v11 offset:0
    ds_read_b128 v[68:71], v11 offset:1024
    s_nop 2
    ds_write_b128 v7, v[48:51] offset:11264
    ds_write_b128 v7, v[52:55] offset:13312
    ds_write_b128 v7, v[44:47] offset:9216
    v_mov_b32 v32, 0x3f803f80
    v_mov_b32 v33, 0x3f803f80
    v_mov_b64 v[34:35], v[32:33]
    v_mov_b32 v36, 0x3f003f00
    v_mov_b32 v37, 0x3f003f00
    v_cvt_pk_bf16_f32 v40, v56, v57
    v_cvt_pk_bf16_f32 v41, v58, v59
    v_cvt_pk_bf16_f32 v42, v60, v61
    v_cvt_pk_bf16_f32 v43, v62, v63
    s_waitcnt lgkmcnt(0)
    s_barrier
    ds_read_b128 v[44:47], v5 offset:11264
    ds_read_b64 v[12:13], v6 offset:9216
    ds_read_b128 v[48:51], v5 offset:11776
    ds_read_b64 v[14:15], v6 offset:9728
    ds_read_b128 v[52:55], v5 offset:12288
    ds_read_b64 v[16:17], v6 offset:10240
    ds_read_b128 v[56:59], v5 offset:12800
    ds_read_b64 v[18:19], v6 offset:10752
    buffer_store_dwordx4 v[40:43], v0, s[60:63], s87 offen offset:1024 sc1
    s_cmp_eq_u32 s65, 63
    s_cbranch_scc1 chain_end
    v_mov_b64 v[60:61], 0
    v_mov_b64 v[62:63], 0
    s_waitcnt lgkmcnt(4)
    v_pk_add_f32 v[44:45], v[44:45], v[48:49]
    v_pk_add_f32 v[46:47], v[46:47], v[50:51]
    v_pk_add_f32 v[12:13], v[12:13], v[14:15]
    s_waitcnt lgkmcnt(0)
    v_pk_add_f32 v[52:53], v[52:53], v[56:57]
    v_pk_add_f32 v[54:55], v[54:55], v[58:59]
    v_pk_add_f32 v[16:17], v[16:17], v[18:19]
    v_pk_add_f32 v[44:45], v[44:45], v[52:53]
    v_pk_add_f32 v[46:47], v[46:47], v[54:55]
    v_pk_add_f32 v[48:49], v[12:13], v[16:17]
    v_max3_f32 v38, v44, v45, v46
    v_max3_f32 v39, v47, v48, v49
    v_max_f32 v38, v38, v39
    v_mov_b64 v[52:53], 0
    v_mov_b64 v[54:55], 0
    v_max_f32_dpp v38, v38, v38 row_ror:8 row_mask:0xf bank_mask:0xf
    v_mov_b32 v39, v38
    v_mov_b64 v[56:57], 0
    v_mov_b64 v[58:59], 0
    v_permlane32_swap_b32 v38, v39
    v_max_f32 v38, v38, v39
    v_mov_b32 v39, v38
    s_nop 1
    v_permlane16_swap_b32 v38, v39
    v_max_f32 v38, v38, v39
    v_mul_f32 v38, s80, v38
    v_pk_fma_f32 v[44:45], v[44:45], s[80:81], v[38:39] op_sel_hi:[1,0,0] neg_lo:[0,0,1] neg_hi:[0,0,1]
    v_pk_fma_f32 v[46:47], v[46:47], s[80:81], v[38:39] op_sel_hi:[1,0,0] neg_lo:[0,0,1] neg_hi:[0,0,1]
    v_pk_fma_f32 v[48:49], v[48:49], s[80:81], v[38:39] op_sel_hi:[1,0,0] neg_lo:[0,0,1] neg_hi:[0,0,1]
    v_exp_f32 v44, v44
    v_exp_f32 v45, v45
    v_exp_f32 v46, v46
    v_exp_f32 v47, v47
    v_exp_f32 v48, v48
    v_exp_f32 v49, v49
    v_cvt_pk_bf16_f32 v12, v44, v45
    v_cvt_pk_bf16_f32 v13, v46, v47
    v_cvt_pk_bf16_f32 v16, v48, v49
    s_waitcnt vmcnt(3)
    v_mov_b32_dpp v14, v12 row_ror:8 row_mask:0xf bank_mask:0xf
    v_mov_b32_dpp v15, v13 row_ror:8 row_mask:0xf bank_mask:0xf
    v_mov_b32_dpp v17, v16 row_ror:8 row_mask:0xf bank_mask:0xf
    s_nop 0
    v_mfma_f32_16x16x32_bf16 v[28:31], v[32:35], v[12:15], 0
    v_mfma_f32_16x16x32_bf16 v[44:47], v[20:23], v[12:15], 0
    v_mfma_f32_16x16x32_bf16 v[48:51], v[24:27], v[12:15], 0
    v_mfma_f32_16x16x16_bf16 v[28:31], v[36:37], v[16:17], v[28:31]
    v_mfma_f32_16x16x16_bf16 v[44:47], v[40:41], v[16:17], v[44:47]
    v_mfma_f32_16x16x16_bf16 v[48:51], v[42:43], v[16:17], v[48:51]
    ds_read_b128 v[20:23], v11 offset:2048
    ds_read_b128 v[24:27], v11 offset:3072
    v_mov_b64 v[12:13], 0
    v_mov_b64 v[14:15], 0
    v_mov_b64 v[16:17], 0
    v_mov_b64 v[18:19], 0
    v_rcp_f32 v28, v28
    v_mov_b64 v[36:37], 0
    v_pk_mul_f32 v[44:45], v[44:45], v[28:29] op_sel_hi:[1,0]
    v_pk_mul_f32 v[46:47], v[46:47], v[28:29] op_sel_hi:[1,0]
    v_pk_mul_f32 v[48:49], v[48:49], v[28:29] op_sel_hi:[1,0]
    v_pk_mul_f32 v[50:51], v[50:51], v[28:29] op_sel_hi:[1,0]
    v_cvt_pk_bf16_f32 v32, v44, v45
    v_cvt_pk_bf16_f32 v33, v46, v47
    v_cvt_pk_bf16_f32 v34, v48, v49
    v_cvt_pk_bf16_f32 v35, v50, v51
    s_mov_b64 exec, s[82:83]
    ds_write_b128 v7, v[32:35]
    s_mov_b64 exec, -1
    v_mov_b64 v[38:39], 0
    v_mov_b64 v[40:41], 0
    v_mov_b64 v[42:43], 0
    v_mov_b64 v[44:45], 0
    v_mov_b64 v[46:47], 0
    v_mov_b64 v[48:49], 0
    v_mov_b64 v[50:51], 0
    s_waitcnt lgkmcnt(0)
    s_barrier
    ds_read_b128 v[28:31], v8 offset:0
    ds_read_b128 v[32:35], v8 offset:1024
    s_add_u32 s66, s78, 0
    s_add_u32 s67, s78, 65536
    s_add_u32 s68, s78, 131072
    s_add_u32 s69, s78, 196608
    s_add_u32 s70, s78, 262144
    s_mov_b32 s71, -32764
    s_waitcnt lgkmcnt(1)
    v_smfmac_f32_16x16x64_bf16 v[52:55], v[28:31], v[248:255], v1
    v_smfmac_f32_16x16x64_bf16 v[56:59], v[28:31], v[184:191], v1
    v_smfmac_f32_16x16x64_bf16 v[60:63], v[28:31], v[192:199], v1
    s_waitcnt lgkmcnt(0)
    v_smfmac_f32_16x16x64_bf16 v[52:55], v[32:35], v[72:79], v1
    ds_read_b128 v[72:75], v11 offset:4096
    ds_read_b128 v[76:79], v11 offset:5120
    v_smfmac_f32_16x16x64_bf16 v[12:15], v[28:31], v[200:207], v1
    v_smfmac_f32_16x16x64_bf16 v[56:59], v[32:35], v[64:71], v1
    ds_read_b128 v[64:67], v11 offset:6144
    ds_read_b128 v[68:71], v11 offset:7168
    v_smfmac_f32_16x16x64_bf16 v[16:19], v[28:31], v[208:215], v1
    v_smfmac_f32_16x16x64_bf16 v[60:63], v[32:35], v[20:27], v1
    ds_read_b128 v[20:23], v11 offset:8192
    ds_read_b128 v[24:27], v11 offset:9216
    v_smfmac_f32_16x16x64_bf16 v[36:39], v[28:31], v[216:223], v1
    v_permlane32_swap_b32 v52, v54
    v_permlane32_swap_b32 v53, v55
    v_add_f32 v52, v52, v54
    v_add_f32 v53, v53, v55
    s_waitcnt lgkmcnt(4)
    v_smfmac_f32_16x16x64_bf16 v[12:15], v[32:35], v[72:79], v1
    ds_read_b128 v[72:75], v11 offset:10240
    ds_read_b128 v[76:79], v11 offset:11264
    v_smfmac_f32_16x16x64_bf16 v[40:43], v[28:31], v[224:231], v1
    v_bfe_u32 v54, v9, 15, 1
    v_cvt_pk_bf16_f32 v52, v52, v53
    v_mad_i32_i24 v54, v54, s71, v9
    buffer_store_dword v52, v54, s[52:55], s70 offen
    s_waitcnt lgkmcnt(4)
    v_smfmac_f32_16x16x64_bf16 v[16:19], v[32:35], v[64:71], v1
    ds_read_b128 v[64:67], v11 offset:12288
    ds_read_b128 v[68:71], v11 offset:13312
    v_smfmac_f32_16x16x64_bf16 v[44:47], v[28:31], v[232:239], v1
    v_permlane32_swap_b32 v56, v60
    v_permlane32_swap_b32 v57, v61
    v_permlane32_swap_b32 v58, v62
    v_permlane32_swap_b32 v59, v63
    s_waitcnt lgkmcnt(4)
    v_smfmac_f32_16x16x64_bf16 v[36:39], v[32:35], v[20:27], v1
    ds_read_b128 v[20:23], v11 offset:14336
    ds_read_b128 v[24:27], v11 offset:15360
    v_smfmac_f32_16x16x64_bf16 v[48:51], v[28:31], v[240:247], v1
    v_pk_add_f32 v[56:57], v[56:57], v[60:61]
    v_pk_add_f32 v[58:59], v[58:59], v[62:63]
    v_cvt_pk_bf16_f32 v56, v56, v57
    v_cvt_pk_bf16_f32 v57, v58, v59
    s_waitcnt lgkmcnt(4)
    v_smfmac_f32_16x16x64_bf16 v[40:43], v[32:35], v[72:79], v1
    buffer_store_dwordx2 v[56:57], v9, s[52:55], s66 offen
    v_permlane32_swap_b32 v12, v16
    v_permlane32_swap_b32 v13, v17
    v_permlane32_swap_b32 v14, v18
    s_waitcnt lgkmcnt(2)
    v_smfmac_f32_16x16x64_bf16 v[44:47], v[32:35], v[64:71], v1
    v_permlane32_swap_b32 v15, v19
    v_pk_add_f32 v[12:13], v[12:13], v[16:17]
    v_pk_add_f32 v[14:15], v[14:15], v[18:19]
    v_cvt_pk_bf16_f32 v12, v12, v13
    s_waitcnt lgkmcnt(0)
    v_smfmac_f32_16x16x64_bf16 v[48:51], v[32:35], v[20:27], v1
    v_cvt_pk_bf16_f32 v13, v14, v15
    buffer_store_dwordx2 v[12:13], v9, s[52:55], s67 offen
    v_permlane32_swap_b32 v36, v40
    v_permlane32_swap_b32 v37, v41
    v_permlane32_swap_b32 v38, v42
    v_permlane32_swap_b32 v39, v43
    v_pk_add_f32 v[36:37], v[36:37], v[40:41]
    v_pk_add_f32 v[38:39], v[38:39], v[42:43]
    v_cvt_pk_bf16_f32 v36, v36, v37
    v_cvt_pk_bf16_f32 v37, v38, v39
    buffer_store_dwordx2 v[36:37], v9, s[52:55], s68 offen
    v_permlane32_swap_b32 v44, v48
    v_permlane32_swap_b32 v45, v49
    v_permlane32_swap_b32 v46, v50
    v_permlane32_swap_b32 v47, v51
    v_pk_add_f32 v[44:45], v[44:45], v[48:49]
    v_pk_add_f32 v[46:47], v[46:47], v[50:51]
    v_cvt_pk_bf16_f32 v44, v44, v45
    v_cvt_pk_bf16_f32 v45, v46, v47
    buffer_store_dwordx2 v[44:45], v9, s[52:55], s69 offen
    s_add_u32 s65, s65, 1
    s_mov_b32 s46, s78
    s_add_u32 s78, s78, 294912
    s_cmp_eq_u32 s78, 589824
    s_cselect_b32 s78, 0, s78
    s_add_u32 s79, s79, 262144
    s_mov_b32 s87, s75
    s_mov_b32 s75, s76
    s_mov_b32 s76, s77
    s_mov_b32 s77, s87
    s_add_u32 s31, s75, s84
    v_add_u32 v11, s84, v0
    s_cmp_lt_u32 s73, 72
    s_cbranch_scc1 red_go
    v_lshrrev_b32 v39, 1, v0
    v_xor_b32 v39, v39, v0
    v_bfe_i32 v39, v39, 6, 1
    v_and_b32 v39, 0xc0, v39
    v_xor_b32 v39, v39, v0
    s_cmp_lg_u32 s6, 3
    s_cbranch_scc1 red_done
    s_add_u32 s86, s65, 1
    s_and_b32 s87, s86, 67
    s_cbranch_scc1 nofl
    s_lshr_b32 s86, s86, 2
    s_lshl_b32 s71, s86, 5
    s_add_u32 s71, s71, s3
    s_lshl_b32 s71, s71, 7
    s_bitset1_b32 s71, 16
    v_mov_b32 v28, 0
    s_buffer_load_dword s72, s[48:51], s71
    s_waitcnt lgkmcnt(0)
    s_cmp_lg_u32 s72, 0
    s_cbranch_scc1 flo_20
fl_19:
    buffer_load_dword v29, v28, s[48:51], s71 offen sc1
    s_waitcnt vmcnt(0)
    v_cmp_ne_u32 vcc, 0, v29
    s_cbranch_vccnz flo_20
    s_cmp_eq_u32 s64, 0
    s_cbranch_scc1 flo_20
    s_sub_u32 s64, s64, 1
    s_branch fl_19
flo_20:
nofl:
    s_waitcnt vmcnt(0)
    s_branch red_done
red_go:
    s_add_u32 s87, s46, s74
    buffer_load_dwordx4 v[12:15], v0, s[52:55], s87 offen offset:0 sc1
    buffer_load_dwordx4 v[16:19], v0, s[52:55], s87 offen offset:1024 sc1
    buffer_load_dwordx4 v[20:23], v0, s[52:55], s87 offen offset:2048 sc1
    buffer_load_dwordx4 v[24:27], v0, s[52:55], s87 offen offset:3072 sc1
    v_and_b32 v76, 0x30, v0
    v_mov_b32 v64, 0x3f80
    v_mov_b32 v65, 0
    v_lshlrev_b64 v[64:65], v76, v[64:65]
    v_bfe_i32 v76, v0, 6, 1
    v_and_b32 v66, v64, v76
    v_and_b32 v67, v65, v76
    v_xor_b32 v64, v64, v66
    v_xor_b32 v65, v65, v67
    v_lshrrev_b32 v39, 1, v0
    v_xor_b32 v39, v39, v0
    v_bfe_i32 v39, v39, 6, 1
    v_and_b32 v39, 0xc0, v39
    v_xor_b32 v39, v39, v0
rp:
    buffer_load_dwordx4 v[44:47], v0, s[52:55], s87 offen offset:0 sc1
    buffer_load_dwordx4 v[48:51], v0, s[52:55], s87 offen offset:1024 sc1
    buffer_load_dwordx4 v[52:55], v0, s[52:55], s87 offen offset:2048 sc1
    buffer_load_dwordx4 v[56:59], v0, s[52:55], s87 offen offset:3072 sc1
    s_waitcnt vmcnt(7)
    v_mfma_f32_16x16x32_bf16 v[72:75], v[12:15], v[64:67], 0
    s_waitcnt vmcnt(6)
    v_mfma_f32_16x16x32_bf16 v[72:75], v[16:19], v[64:67], v[72:75]
    s_waitcnt vmcnt(5)
    v_mfma_f32_16x16x32_bf16 v[72:75], v[20:23], v[64:67], v[72:75]
    s_waitcnt vmcnt(4)
    v_mfma_f32_16x16x32_bf16 v[72:75], v[24:27], v[64:67], v[72:75]
    s_nop 7
    v_permlane32_swap_b32 v72, v74
    v_permlane32_swap_b32 v73, v75
    v_add_f32 v72, v72, v74
    v_add_f32 v73, v73, v75
    v_cmp_u_f32 vcc, v72, v73
    v_cvt_pk_bf16_f32 v76, v72, v73
    s_cbranch_vccz rpo
    buffer_load_dwordx4 v[12:15], v0, s[52:55], s87 offen offset:0 sc1
    buffer_load_dwordx4 v[16:19], v0, s[52:55], s87 offen offset:1024 sc1
    buffer_load_dwordx4 v[20:23], v0, s[52:55], s87 offen offset:2048 sc1
    buffer_load_dwordx4 v[24:27], v0, s[52:55], s87 offen offset:3072 sc1
    s_waitcnt vmcnt(7)
    v_mfma_f32_16x16x32_bf16 v[72:75], v[44:47], v[64:67], 0
    s_waitcnt vmcnt(6)
    v_mfma_f32_16x16x32_bf16 v[72:75], v[48:51], v[64:67], v[72:75]
    s_waitcnt vmcnt(5)
    v_mfma_f32_16x16x32_bf16 v[72:75], v[52:55], v[64:67], v[72:75]
    s_waitcnt vmcnt(4)
    v_mfma_f32_16x16x32_bf16 v[72:75], v[56:59], v[64:67], v[72:75]
    s_nop 7
    v_permlane32_swap_b32 v72, v74
    v_permlane32_swap_b32 v73, v75
    v_add_f32 v72, v72, v74
    v_add_f32 v73, v73, v75
    v_cmp_u_f32 vcc, v72, v73
    v_cvt_pk_bf16_f32 v76, v72, v73
    s_cbranch_vccz rpo
    s_cmp_eq_u32 s64, 0
    s_cbranch_scc1 rpo
    s_sub_u32 s64, s64, 1
    s_branch rp
rpo:
    s_mov_b64 exec, s[82:83]
    buffer_store_dword v76, v10, s[56:59], s75 offen
    s_mov_b64 exec, -1
red_done:
    s_barrier
red_done2:
    s_branch step
chain_end:
    s_waitcnt vmcnt(0)
    s_barrier
    v_mov_b32 v11, 64
    s_mov_b64 exec, 1
    buffer_store_dword v11, v0, s[48:51], s81 offen sc1
    s_mov_b64 exec, -1
    s_endpgm
.globl mlp2_kernel
.p2align 8
.type mlp2_kernel,@function
mlp2_kernel:
    s_cmp_lt_u32 s2, 192
    s_cbranch_scc1 go_21
    s_endpgm
go_21:
    s_load_dwordx2 s[4:5], s[0:1], 112
    v_lshrrev_b32 v1, 6, v0
    s_nop 0
    v_readfirstlane_b32 s6, v1
    s_lshl_b32 s7, s6, 10
    s_lshr_b32 s46, s6, 2
    s_and_b32 s6, s6, 3
    s_lshl_b32 s7, s6, 10
    v_and_b32 v0, 255, v0
    s_waitcnt lgkmcnt(0)
    s_add_u32 s8, s4, 114454528
    s_addc_u32 s9, s5, 0
    s_mov_b32 s10, 5308416
    s_mov_b32 s11, 0x00020000
    s_add_u32 s12, s4, 119762944
    s_addc_u32 s13, s5, 0
    s_mov_b32 s14, 18874368
    s_mov_b32 s15, 0x00020000
    s_add_u32 s16, s4, 138637312
    s_addc_u32 s17, s5, 0
    s_mov_b32 s18, 18874368
    s_mov_b32 s19, 0x00020000
    s_and_b32 s30, s2, 7
    s_mul_i32 s30, s30, 24
    s_lshr_b32 s31, s2, 3
    s_add_u32 s30, s30, s31
    s_mul_i32 s33, s30, 1366
    s_lshr_b32 s33, s33, 16
    s_mul_i32 s34, s33, 48
    s_sub_u32 s34, s30, s34
    s_mul_i32 s31, s34, 21846
    s_lshr_b32 s31, s31, 16
    s_mul_i32 s32, s31, 3
    s_sub_u32 s32, s34, s32
    s_and_b32 s35, s6, 1
    s_mul_i32 s35, s35, 6
    s_lshr_b32 s36, s6, 1
    s_lshl_b32 s36, s36, 2
    s_lshl_b32 s40, s32, 2
    s_add_u32 s40, s40, s33
    s_mul_i32 s40, s40, 442368
    s_lshl_b32 s41, s31, 2
    s_add_u32 s41, s41, s33
    s_mul_i32 s41, s41, 294912
    v_and_b32 v2, 63, v0
    v_lshrrev_b32 v3, 3, v0
    v_bfe_u32 v4, v3, 1, 3
    v_and_b32 v5, 7, v0
    v_xor_b32 v4, v4, v5
    v_mul_u32_u24 v3, 128, v3
    v_lshl_add_u32 v8, v4, 4, v3
    v_and_b32 v3, 15, v0
    v_bfe_u32 v4, v0, 4, 2
    v_bfe_u32 v5, v0, 1, 3
    v_xor_b32 v4, v4, v5
    v_lshlrev_b32 v3, 7, v3
    v_lshl_add_u32 v9, v4, 4, v3
    v_mov_b32 v3, s35
    v_lshl_add_u32 v9, v3, 11, v9
    v_xor_b32 v10, 64, v9
    v_add_u32 v3, 0, v0
    v_lshrrev_b32 v4, 4, v3
    v_and_b32 v5, 15, v3
    v_bfe_u32 v6, v4, 2, 1
    v_and_b32 v7, 3, v4
    v_lshl_or_b32 v6, v6, 2, v7
    v_lshlrev_b32 v6, 1, v6
    v_xor_b32 v5, v5, v6
    v_mul_u32_u24 v4, 256, v4
    v_lshl_add_u32 v11, v5, 4, v4
    v_add_u32 v3, 256, v0
    v_lshrrev_b32 v4, 4, v3
    v_and_b32 v5, 15, v3
    v_bfe_u32 v6, v4, 2, 1
    v_and_b32 v7, 3, v4
    v_lshl_or_b32 v6, v6, 2, v7
    v_lshlrev_b32 v6, 1, v6
    v_xor_b32 v5, v5, v6
    v_mul_u32_u24 v4, 256, v4
    v_lshl_add_u32 v12, v5, 4, v4
    v_add_u32 v3, 512, v0
    v_lshrrev_b32 v4, 4, v3
    v_and_b32 v5, 15, v3
    v_bfe_u32 v6, v4, 2, 1
    v_and_b32 v7, 3, v4
    v_lshl_or_b32 v6, v6, 2, v7
    v_lshlrev_b32 v6, 1, v6
    v_xor_b32 v5, v5, v6
    v_mul_u32_u24 v4, 256, v4
    v_lshl_add_u32 v13, v5, 4, v4
    v_add_u32 v3, 768, v0
    v_lshrrev_b32 v4, 4, v3
    v_and_b32 v5, 15, v3
    v_bfe_u32 v6, v4, 2, 1
    v_and_b32 v7, 3, v4
    v_lshl_or_b32 v6, v6, 2, v7
    v_lshlrev_b32 v6, 1, v6
    v_xor_b32 v5, v5, v6
    v_mul_u32_u24 v4, 256, v4
    v_lshl_add_u32 v14, v5, 4, v4
    v_bfe_u32 v3, v0, 4, 2
    v_bfe_u32 v4, v0, 2, 2
    v_lshl_add_u32 v3, v3, 2, v4
    v_bfe_u32 v6, v3, 2, 1
    v_and_b32 v7, 3, v3
    v_lshl_or_b32 v6, v6, 2, v7
    v_mul_u32_u24 v3, 256, v3
    v_and_b32 v4, 3, v0
    v_lshl_add_u32 v3, v4, 3, v3
    v_mov_b32 v4, s36
    v_add_u32 v4, 0, v4
    v_xor_b32 v4, v4, v6
    v_lshl_add_u32 v15, v4, 5, v3
    v_mov_b32 v4, s36
    v_add_u32 v4, 1, v4
    v_xor_b32 v4, v4, v6
    v_lshl_add_u32 v16, v4, 5, v3
    v_mov_b32 v4, s36
    v_add_u32 v4, 2, v4
    v_xor_b32 v4, v4, v6
    v_lshl_add_u32 v17, v4, 5, v3
    v_mov_b32 v4, s36
    v_add_u32 v4, 3, v4
    v_xor_b32 v4, v4, v6
    v_lshl_add_u32 v18, v4, 5, v3
    s_cmp_eq_u32 s46, 0
    s_cbranch_scc1 m2c
    s_add_u32 m0, s7, 0
    s_add_u32 s38, s40, 0
    buffer_load_dwordx4 v8, s[8:11], s38 offen  lds
    s_add_u32 m0, s7, 4096
    s_add_u32 s38, s40, 4096
    buffer_load_dwordx4 v8, s[8:11], s38 offen  lds
    s_add_u32 m0, s7, 8192
    s_add_u32 s38, s40, 8192
    buffer_load_dwordx4 v8, s[8:11], s38 offen  lds
    s_add_u32 m0, s7, 12288
    s_add_u32 s38, s40, 12288
    buffer_load_dwordx4 v8, s[8:11], s38 offen  lds
    s_add_u32 m0, s7, 16384
    s_add_u32 s38, s40, 16384
    buffer_load_dwordx4 v8, s[8:11], s38 offen  lds
    s_add_u32 m0, s7, 20480
    s_add_u32 s38, s40, 20480
    buffer_load_dwordx4 v8, s[8:11], s38 offen  lds
    s_add_u32 s40, s40, 24576
    s_add_u32 m0, s7, 24576
    s_nop 0
    buffer_load_dwordx4 v11, s[12:15], s41 offen  lds
    s_add_u32 m0, s7, 28672
    s_nop 0
    buffer_load_dwordx4 v12, s[12:15], s41 offen  lds
    s_add_u32 m0, s7, 32768
    s_nop 0
    buffer_load_dwordx4 v13, s[12:15], s41 offen  lds
    s_add_u32 m0, s7, 36864
    s_nop 0
    buffer_load_dwordx4 v14, s[12:15], s41 offen  lds
    s_add_u32 s41, s41, 16384
    s_add_u32 m0, s7, 40960
    s_add_u32 s38, s40, 0
    buffer_load_dwordx4 v8, s[8:11], s38 offen  lds
    s_add_u32 m0, s7, 45056
    s_add_u32 s38, s40, 4096
    buffer_load_dwordx4 v8, s[8:11], s38 offen  lds
    s_add_u32 m0, s7, 49152
    s_add_u32 s38, s40, 8192
    buffer_load_dwordx4 v8, s[8:11], s38 offen  lds
    s_add_u32 m0, s7, 53248
    s_add_u32 s38, s40, 12288
    buffer_load_dwordx4 v8, s[8:11], s38 offen  lds
    s_add_u32 m0, s7, 57344
    s_add_u32 s38, s40, 16384
    buffer_load_dwordx4 v8, s[8:11], s38 offen  lds
    s_add_u32 m0, s7, 61440
    s_add_u32 s38, s40, 20480
    buffer_load_dwordx4 v8, s[8:11], s38 offen  lds
    s_add_u32 s40, s40, 24576
    s_add_u32 m0, s7, 65536
    s_nop 0
    buffer_load_dwordx4 v11, s[12:15], s41 offen  lds
    s_add_u32 m0, s7, 69632
    s_nop 0
    buffer_load_dwordx4 v12, s[12:15], s41 offen  lds
    s_add_u32 m0, s7, 73728
    s_nop 0
    buffer_load_dwordx4 v13, s[12:15], s41 offen  lds
    s_add_u32 m0, s7, 77824
    s_nop 0
    buffer_load_dwordx4 v14, s[12:15], s41 offen  lds
    s_add_u32 s41, s41, 16384
    s_add_u32 m0, s7, 81920
    s_add_u32 s38, s40, 0
    buffer_load_dwordx4 v8, s[8:11], s38 offen  lds
    s_add_u32 m0, s7, 86016
    s_add_u32 s38, s40, 4096
    buffer_load_dwordx4 v8, s[8:11], s38 offen  lds
    s_add_u32 m0, s7, 90112
    s_add_u32 s38, s40, 8192
    buffer_load_dwordx4 v8, s[8:11], s38 offen  lds
    s_add_u32 m0, s7, 94208
    s_add_u32 s38, s40, 12288
    buffer_load_dwordx4 v8, s[8:11], s38 offen  lds
    s_add_u32 m0, s7, 98304
    s_add_u32 s38, s40, 16384
    buffer_load_dwordx4 v8, s[8:11], s38 offen  lds
    s_add_u32 m0, s7, 102400
    s_add_u32 s38, s40, 20480
    buffer_load_dwordx4 v8, s[8:11], s38 offen  lds
    s_add_u32 s40, s40, 24576
    s_add_u32 m0, s7, 106496
    s_nop 0
    buffer_load_dwordx4 v11, s[12:15], s41 offen  lds
    s_add_u32 m0, s7, 110592
    s_nop 0
    buffer_load_dwordx4 v12, s[12:15], s41 offen  lds
    s_add_u32 m0, s7, 114688
    s_nop 0
    buffer_load_dwordx4 v13, s[12:15], s41 offen  lds
    s_add_u32 m0, s7, 118784
    s_nop 0
    buffer_load_dwordx4 v14, s[12:15], s41 offen  lds
    s_add_u32 s41, s41, 16384
    s_mov_b32 s39, 3
kl_22:
    s_waitcnt vmcnt(20)
    s_barrier
    s_add_u32 m0, s7, 122880
    s_add_u32 s38, s40, 0
    buffer_load_dwordx4 v8, s[8:11], s38 offen  lds
    s_add_u32 m0, s7, 126976
    s_add_u32 s38, s40, 4096
    buffer_load_dwordx4 v8, s[8:11], s38 offen  lds
    s_add_u32 m0, s7, 131072
    s_add_u32 s38, s40, 8192
    buffer_load_dwordx4 v8, s[8:11], s38 offen  lds
    s_add_u32 m0, s7, 135168
    s_add_u32 s38, s40, 12288
    buffer_load_dwordx4 v8, s[8:11], s38 offen  lds
    s_add_u32 m0, s7, 139264
    s_add_u32 s38, s40, 16384
    buffer_load_dwordx4 v8, s[8:11], s38 offen  lds
    s_add_u32 m0, s7, 143360
    s_add_u32 s38, s40, 20480
    buffer_load_dwordx4 v8, s[8:11], s38 offen  lds
    s_add_u32 s40, s40, 24576
    s_add_u32 m0, s7, 147456
    s_nop 0
    buffer_load_dwordx4 v11, s[12:15], s41 offen  lds
    s_add_u32 m0, s7, 151552
    s_nop 0
    buffer_load_dwordx4 v12, s[12:15], s41 offen  lds
    s_add_u32 m0, s7, 155648
    s_nop 0
    buffer_load_dwordx4 v13, s[12:15], s41 offen  lds
    s_add_u32 m0, s7, 159744
    s_nop 0
    buffer_load_dwordx4 v14, s[12:15], s41 offen  lds
    s_add_u32 s41, s41, 16384
    s_waitcnt vmcnt(20)
    s_barrier
    s_add_u32 m0, s7, 0
    s_add_u32 s38, s40, 0
    buffer_load_dwordx4 v8, s[8:11], s38 offen  lds
    s_add_u32 m0, s7, 4096
    s_add_u32 s38, s40, 4096
    buffer_load_dwordx4 v8, s[8:11], s38 offen  lds
    s_add_u32 m0, s7, 8192
    s_add_u32 s38, s40, 8192
    buffer_load_dwordx4 v8, s[8:11], s38 offen  lds
    s_add_u32 m0, s7, 12288
    s_add_u32 s38, s40, 12288
    buffer_load_dwordx4 v8, s[8:11], s38 offen  lds
    s_add_u32 m0, s7, 16384
    s_add_u32 s38, s40, 16384
    buffer_load_dwordx4 v8, s[8:11], s38 offen  lds
    s_add_u32 m0, s7, 20480
    s_add_u32 s38, s40, 20480
    buffer_load_dwordx4 v8, s[8:11], s38 offen  lds
    s_add_u32 s40, s40, 24576
    s_add_u32 m0, s7, 24576
    s_nop 0
    buffer_load_dwordx4 v11, s[12:15], s41 offen  lds
    s_add_u32 m0, s7, 28672
    s_nop 0
    buffer_load_dwordx4 v12, s[12:15], s41 offen  lds
    s_add_u32 m0, s7, 32768
    s_nop 0
    buffer_load_dwordx4 v13, s[12:15], s41 offen  lds
    s_add_u32 m0, s7, 36864
    s_nop 0
    buffer_load_dwordx4 v14, s[12:15], s41 offen  lds
    s_add_u32 s41, s41, 16384
    s_waitcnt vmcnt(20)
    s_barrier
    s_add_u32 m0, s7, 40960
    s_add_u32 s38, s40, 0
    buffer_load_dwordx4 v8, s[8:11], s38 offen  lds
    s_add_u32 m0, s7, 45056
    s_add_u32 s38, s40, 4096
    buffer_load_dwordx4 v8, s[8:11], s38 offen  lds
    s_add_u32 m0, s7, 49152
    s_add_u32 s38, s40, 8192
    buffer_load_dwordx4 v8, s[8:11], s38 offen  lds
    s_add_u32 m0, s7, 53248
    s_add_u32 s38, s40, 12288
    buffer_load_dwordx4 v8, s[8:11], s38 offen  lds
    s_add_u32 m0, s7, 57344
    s_add_u32 s38, s40, 16384
    buffer_load_dwordx4 v8, s[8:11], s38 offen  lds
    s_add_u32 m0, s7, 61440
    s_add_u32 s38, s40, 20480
    buffer_load_dwordx4 v8, s[8:11], s38 offen  lds
    s_add_u32 s40, s40, 24576
    s_add_u32 m0, s7, 65536
    s_nop 0
    buffer_load_dwordx4 v11, s[12:15], s41 offen  lds
    s_add_u32 m0, s7, 69632
    s_nop 0
    buffer_load_dwordx4 v12, s[12:15], s41 offen  lds
    s_add_u32 m0, s7, 73728
    s_nop 0
    buffer_load_dwordx4 v13, s[12:15], s41 offen  lds
    s_add_u32 m0, s7, 77824
    s_nop 0
    buffer_load_dwordx4 v14, s[12:15], s41 offen  lds
    s_add_u32 s41, s41, 16384
    s_waitcnt vmcnt(20)
    s_barrier
    s_add_u32 m0, s7, 81920
    s_add_u32 s38, s40, 0
    buffer_load_dwordx4 v8, s[8:11], s38 offen  lds
    s_add_u32 m0, s7, 86016
    s_add_u32 s38, s40, 4096
    buffer_load_dwordx4 v8, s[8:11], s38 offen  lds
    s_add_u32 m0, s7, 90112
    s_add_u32 s38, s40, 8192
    buffer_load_dwordx4 v8, s[8:11], s38 offen  lds
    s_add_u32 m0, s7, 94208
    s_add_u32 s38, s40, 12288
    buffer_load_dwordx4 v8, s[8:11], s38 offen  lds
    s_add_u32 m0, s7, 98304
    s_add_u32 s38, s40, 16384
    buffer_load_dwordx4 v8, s[8:11], s38 offen  lds
    s_add_u32 m0, s7, 102400
    s_add_u32 s38, s40, 20480
    buffer_load_dwordx4 v8, s[8:11], s38 offen  lds
    s_add_u32 s40, s40, 24576
    s_add_u32 m0, s7, 106496
    s_nop 0
    buffer_load_dwordx4 v11, s[12:15], s41 offen  lds
    s_add_u32 m0, s7, 110592
    s_nop 0
    buffer_load_dwordx4 v12, s[12:15], s41 offen  lds
    s_add_u32 m0, s7, 114688
    s_nop 0
    buffer_load_dwordx4 v13, s[12:15], s41 offen  lds
    s_add_u32 m0, s7, 118784
    s_nop 0
    buffer_load_dwordx4 v14, s[12:15], s41 offen  lds
    s_add_u32 s41, s41, 16384
    s_sub_u32 s39, s39, 1
    s_cmp_lg_u32 s39, 0
    s_cbranch_scc1 kl_22
    s_waitcnt vmcnt(20)
    s_barrier
    s_add_u32 m0, s7, 122880
    s_add_u32 s38, s40, 0
    buffer_load_dwordx4 v8, s[8:11], s38 offen  lds
    s_add_u32 m0, s7, 126976
    s_add_u32 s38, s40, 4096
    buffer_load_dwordx4 v8, s[8:11], s38 offen  lds
    s_add_u32 m0, s7, 131072
    s_add_u32 s38, s40, 8192
    buffer_load_dwordx4 v8, s[8:11], s38 offen  lds
    s_add_u32 m0, s7, 135168
    s_add_u32 s38, s40, 12288
    buffer_load_dwordx4 v8, s[8:11], s38 offen  lds
    s_add_u32 m0, s7, 139264
    s_add_u32 s38, s40, 16384
    buffer_load_dwordx4 v8, s[8:11], s38 offen  lds
    s_add_u32 m0, s7, 143360
    s_add_u32 s38, s40, 20480
    buffer_load_dwordx4 v8, s[8:11], s38 offen  lds
    s_add_u32 s40, s40, 24576
    s_add_u32 m0, s7, 147456
    s_nop 0
    buffer_load_dwordx4 v11, s[12:15], s41 offen  lds
    s_add_u32 m0, s7, 151552
    s_nop 0
    buffer_load_dwordx4 v12, s[12:15], s41 offen  lds
    s_add_u32 m0, s7, 155648
    s_nop 0
    buffer_load_dwordx4 v13, s[12:15], s41 offen  lds
    s_add_u32 m0, s7, 159744
    s_nop 0
    buffer_load_dwordx4 v14, s[12:15], s41 offen  lds
    s_add_u32 s41, s41, 16384
    s_waitcnt vmcnt(20)
    s_barrier
    s_add_u32 m0, s7, 0
    s_add_u32 s38, s40, 0
    buffer_load_dwordx4 v8, s[8:11], s38 offen  lds
    s_add_u32 m0, s7, 4096
    s_add_u32 s38, s40, 4096
    buffer_load_dwordx4 v8, s[8:11], s38 offen  lds
    s_add_u32 m0, s7, 8192
    s_add_u32 s38, s40, 8192
    buffer_load_dwordx4 v8, s[8:11], s38 offen  lds
    s_add_u32 m0, s7, 12288
    s_add_u32 s38, s40, 12288
    buffer_load_dwordx4 v8, s[8:11], s38 offen  lds
    s_add_u32 m0, s7, 16384
    s_add_u32 s38, s40, 16384
    buffer_load_dwordx4 v8, s[8:11], s38 offen  lds
    s_add_u32 m0, s7, 20480
    s_add_u32 s38, s40, 20480
    buffer_load_dwordx4 v8, s[8:11], s38 offen  lds
    s_add_u32 s40, s40, 24576
    s_add_u32 m0, s7, 24576
    s_nop 0
    buffer_load_dwordx4 v11, s[12:15], s41 offen  lds
    s_add_u32 m0, s7, 28672
    s_nop 0
    buffer_load_dwordx4 v12, s[12:15], s41 offen  lds
    s_add_u32 m0, s7, 32768
    s_nop 0
    buffer_load_dwordx4 v13, s[12:15], s41 offen  lds
    s_add_u32 m0, s7, 36864
    s_nop 0
    buffer_load_dwordx4 v14, s[12:15], s41 offen  lds
    s_add_u32 s41, s41, 16384
    s_waitcnt vmcnt(20)
    s_barrier
    s_add_u32 m0, s7, 40960
    s_add_u32 s38, s40, 0
    buffer_load_dwordx4 v8, s[8:11], s38 offen  lds
    s_add_u32 m0, s7, 45056
    s_add_u32 s38, s40, 4096
    buffer_load_dwordx4 v8, s[8:11], s38 offen  lds
    s_add_u32 m0, s7, 49152
    s_add_u32 s38, s40, 8192
    buffer_load_dwordx4 v8, s[8:11], s38 offen  lds
    s_add_u32 m0, s7, 53248
    s_add_u32 s38, s40, 12288
    buffer_load_dwordx4 v8, s[8:11], s38 offen  lds
    s_add_u32 m0, s7, 57344
    s_add_u32 s38, s40, 16384
    buffer_load_dwordx4 v8, s[8:11], s38 offen  lds
    s_add_u32 m0, s7, 61440
    s_add_u32 s38, s40, 20480
    buffer_load_dwordx4 v8, s[8:11], s38 offen  lds
    s_add_u32 s40, s40, 24576
    s_add_u32 m0, s7, 65536
    s_nop 0
    buffer_load_dwordx4 v11, s[12:15], s41 offen  lds
    s_add_u32 m0, s7, 69632
    s_nop 0
    buffer_load_dwordx4 v12, s[12:15], s41 offen  lds
    s_add_u32 m0, s7, 73728
    s_nop 0
    buffer_load_dwordx4 v13, s[12:15], s41 offen  lds
    s_add_u32 m0, s7, 77824
    s_nop 0
    buffer_load_dwordx4 v14, s[12:15], s41 offen  lds
    s_add_u32 s41, s41, 16384
    s_waitcnt vmcnt(20)
    s_barrier
    s_waitcnt vmcnt(10)
    s_barrier
    s_waitcnt vmcnt(0)
    s_barrier
    v_add_u32 v9, 0xfffec000, v9
    v_add_u32 v10, 0xfffec000, v10
    v_add_u32 v15, 0xfffec000, v15
    v_add_u32 v16, 0xfffec000, v16
    v_add_u32 v17, 0xfffec000, v17
    v_add_u32 v18, 0xfffec000, v18
    s_endpgm
m2c:
    v_mov_b32 v32, 0
    v_mov_b32 v33, 0
    v_mov_b32 v34, 0
    v_mov_b32 v35, 0
    v_mov_b32 v36, 0
    v_mov_b32 v37, 0
    v_mov_b32 v38, 0
    v_mov_b32 v39, 0
    v_mov_b32 v40, 0
    v_mov_b32 v41, 0
    v_mov_b32 v42, 0
    v_mov_b32 v43, 0
    v_mov_b32 v44, 0
    v_mov_b32 v45, 0
    v_mov_b32 v46, 0
    v_mov_b32 v47, 0
    v_mov_b32 v48, 0
    v_mov_b32 v49, 0
    v_mov_b32 v50, 0
    v_mov_b32 v51, 0
    v_mov_b32 v52, 0
    v_mov_b32 v53, 0
    v_mov_b32 v54, 0
    v_mov_b32 v55, 0
    v_mov_b32 v56, 0
    v_mov_b32 v57, 0
    v_mov_b32 v58, 0
    v_mov_b32 v59, 0
    v_mov_b32 v60, 0
    v_mov_b32 v61, 0
    v_mov_b32 v62, 0
    v_mov_b32 v63, 0
    v_mov_b32 v64, 0
    v_mov_b32 v65, 0
    v_mov_b32 v66, 0
    v_mov_b32 v67, 0
    v_mov_b32 v68, 0
    v_mov_b32 v69, 0
    v_mov_b32 v70, 0
    v_mov_b32 v71, 0
    v_mov_b32 v72, 0
    v_mov_b32 v73, 0
    v_mov_b32 v74, 0
    v_mov_b32 v75, 0
    v_mov_b32 v76, 0
    v_mov_b32 v77, 0
    v_mov_b32 v78, 0
    v_mov_b32 v79, 0
    v_mov_b32 v80, 0
    v_mov_b32 v81, 0
    v_mov_b32 v82, 0
    v_mov_b32 v83, 0
    v_mov_b32 v84, 0
    v_mov_b32 v85, 0
    v_mov_b32 v86, 0
    v_mov_b32 v87, 0
    v_mov_b32 v88, 0
    v_mov_b32 v89, 0
    v_mov_b32 v90, 0
    v_mov_b32 v91, 0
    v_mov_b32 v92, 0
    v_mov_b32 v93, 0
    v_mov_b32 v94, 0
    v_mov_b32 v95, 0
    v_mov_b32 v96, 0
    v_mov_b32 v97, 0
    v_mov_b32 v98, 0
    v_mov_b32 v99, 0
    v_mov_b32 v100, 0
    v_mov_b32 v101, 0
    v_mov_b32 v102, 0
    v_mov_b32 v103, 0
    v_mov_b32 v104, 0
    v_mov_b32 v105, 0
    v_mov_b32 v106, 0
    v_mov_b32 v107, 0
    v_mov_b32 v108, 0
    v_mov_b32 v109, 0
    v_mov_b32 v110, 0
    v_mov_b32 v111, 0
    v_mov_b32 v112, 0
    v_mov_b32 v113, 0
    v_mov_b32 v114, 0
    v_mov_b32 v115, 0
    v_mov_b32 v116, 0
    v_mov_b32 v117, 0
    v_mov_b32 v118, 0
    v_mov_b32 v119, 0
    v_mov_b32 v120, 0
    v_mov_b32 v121, 0
    v_mov_b32 v122, 0
    v_mov_b32 v123, 0
    v_mov_b32 v124, 0
    v_mov_b32 v125, 0
    v_mov_b32 v126, 0
    v_mov_b32 v127, 0
    s_mov_b32 s39, 3
kl_23:
    s_barrier
    ds_read_b128 v[128:131], v9 offset:0
    ds_read_b64_tr_b16 v[132:133], v15 offset:24576
    ds_read_b64_tr_b16 v[134:135], v15 offset:28672
    ds_read_b64_tr_b16 v[136:137], v16 offset:24576
    ds_read_b64_tr_b16 v[138:139], v16 offset:28672
    ds_read_b64_tr_b16 v[140:141], v17 offset:24576
    ds_read_b64_tr_b16 v[142:143], v17 offset:28672
    ds_read_b64_tr_b16 v[144:145], v18 offset:24576
    ds_read_b64_tr_b16 v[146:147], v18 offset:28672
    ds_read_b128 v[148:151], v9 offset:2048
    s_waitcnt lgkmcnt(7)
    v_mfma_f32_16x16x32_bf16 v[32:35], v[128:131], v[132:135], v[32:35]
    ds_read_b128 v[152:155], v9 offset:4096
    s_waitcnt lgkmcnt(6)
    v_mfma_f32_16x16x32_bf16 v[56:59], v[128:131], v[136:139], v[56:59]
    ds_read_b128 v[156:159], v9 offset:6144
    s_waitcnt lgkmcnt(5)
    v_mfma_f32_16x16x32_bf16 v[80:83], v[128:131], v[140:143], v[80:83]
    ds_read_b128 v[160:163], v9 offset:8192
    s_waitcnt lgkmcnt(4)
    v_mfma_f32_16x16x32_bf16 v[104:107], v[128:131], v[144:147], v[104:107]
    ds_read_b128 v[164:167], v9 offset:10240
    s_waitcnt lgkmcnt(4)
    v_mfma_f32_16x16x32_bf16 v[36:39], v[148:151], v[132:135], v[36:39]
    ds_read_b128 v[168:171], v10 offset:0
    v_mfma_f32_16x16x32_bf16 v[60:63], v[148:151], v[136:139], v[60:63]
    ds_read_b64_tr_b16 v[172:173], v15 offset:32768
    ds_read_b64_tr_b16 v[174:175], v15 offset:36864
    v_mfma_f32_16x16x32_bf16 v[84:87], v[148:151], v[140:143], v[84:87]
    ds_read_b64_tr_b16 v[176:177], v16 offset:32768
    ds_read_b64_tr_b16 v[178:179], v16 offset:36864
    v_mfma_f32_16x16x32_bf16 v[108:111], v[148:151], v[144:147], v[108:111]
    ds_read_b64_tr_b16 v[180:181], v17 offset:32768
    ds_read_b64_tr_b16 v[182:183], v17 offset:36864
    s_waitcnt lgkmcnt(10)
    v_mfma_f32_16x16x32_bf16 v[40:43], v[152:155], v[132:135], v[40:43]
    ds_read_b64_tr_b16 v[184:185], v18 offset:32768
    ds_read_b64_tr_b16 v[186:187], v18 offset:36864
    v_mfma_f32_16x16x32_bf16 v[64:67], v[152:155], v[136:139], v[64:67]
    ds_read_b128 v[188:191], v10 offset:2048
    v_mfma_f32_16x16x32_bf16 v[88:91], v[152:155], v[140:143], v[88:91]
    ds_read_b128 v[128:131], v10 offset:4096
    v_mfma_f32_16x16x32_bf16 v[112:115], v[152:155], v[144:147], v[112:115]
    ds_read_b128 v[148:151], v10 offset:6144
    s_waitcnt lgkmcnt(14)
    v_mfma_f32_16x16x32_bf16 v[44:47], v[156:159], v[132:135], v[44:47]
    ds_read_b128 v[152:155], v10 offset:8192
    v_mfma_f32_16x16x32_bf16 v[68:71], v[156:159], v[136:139], v[68:71]
    v_mfma_f32_16x16x32_bf16 v[92:95], v[156:159], v[140:143], v[92:95]
    v_mfma_f32_16x16x32_bf16 v[116:119], v[156:159], v[144:147], v[116:119]
    ds_read_b128 v[156:159], v10 offset:10240
    s_waitcnt lgkmcnt(15)
    v_mfma_f32_16x16x32_bf16 v[48:51], v[160:163], v[132:135], v[48:51]
    v_mfma_f32_16x16x32_bf16 v[72:75], v[160:163], v[136:139], v[72:75]
    v_mfma_f32_16x16x32_bf16 v[96:99], v[160:163], v[140:143], v[96:99]
    v_mfma_f32_16x16x32_bf16 v[120:123], v[160:163], v[144:147], v[120:123]
    s_waitcnt lgkmcnt(14)
    v_mfma_f32_16x16x32_bf16 v[52:55], v[164:167], v[132:135], v[52:55]
    v_mfma_f32_16x16x32_bf16 v[76:79], v[164:167], v[136:139], v[76:79]
    v_mfma_f32_16x16x32_bf16 v[100:103], v[164:167], v[140:143], v[100:103]
    v_mfma_f32_16x16x32_bf16 v[124:127], v[164:167], v[144:147], v[124:127]
    s_waitcnt lgkmcnt(11)
    v_mfma_f32_16x16x32_bf16 v[32:35], v[168:171], v[172:175], v[32:35]
    s_waitcnt lgkmcnt(9)
    v_mfma_f32_16x16x32_bf16 v[56:59], v[168:171], v[176:179], v[56:59]
    s_waitcnt lgkmcnt(7)
    v_mfma_f32_16x16x32_bf16 v[80:83], v[168:171], v[180:183], v[80:83]
    s_waitcnt lgkmcnt(5)
    v_mfma_f32_16x16x32_bf16 v[104:107], v[168:171], v[184:187], v[104:107]
    s_waitcnt lgkmcnt(4)
    v_mfma_f32_16x16x32_bf16 v[36:39], v[188:191], v[172:175], v[36:39]
    v_mfma_f32_16x16x32_bf16 v[60:63], v[188:191], v[176:179], v[60:63]
    v_mfma_f32_16x16x32_bf16 v[84:87], v[188:191], v[180:183], v[84:87]
    v_mfma_f32_16x16x32_bf16 v[108:111], v[188:191], v[184:187], v[108:111]
    s_waitcnt lgkmcnt(3)
    v_mfma_f32_16x16x32_bf16 v[40:43], v[128:131], v[172:175], v[40:43]
    v_mfma_f32_16x16x32_bf16 v[64:67], v[128:131], v[176:179], v[64:67]
    v_mfma_f32_16x16x32_bf16 v[88:91], v[128:131], v[180:183], v[88:91]
    v_mfma_f32_16x16x32_bf16 v[112:115], v[128:131], v[184:187], v[112:115]
    s_waitcnt lgkmcnt(2)
    v_mfma_f32_16x16x32_bf16 v[44:47], v[148:151], v[172:175], v[44:47]
    v_mfma_f32_16x16x32_bf16 v[68:71], v[148:151], v[176:179], v[68:71]
    v_mfma_f32_16x16x32_bf16 v[92:95], v[148:151], v[180:183], v[92:95]
    v_mfma_f32_16x16x32_bf16 v[116:119], v[148:151], v[184:187], v[116:119]
    s_waitcnt lgkmcnt(1)
    v_mfma_f32_16x16x32_bf16 v[48:51], v[152:155], v[172:175], v[48:51]
    v_mfma_f32_16x16x32_bf16 v[72:75], v[152:155], v[176:179], v[72:75]
    v_mfma_f32_16x16x32_bf16 v[96:99], v[152:155], v[180:183], v[96:99]
    v_mfma_f32_16x16x32_bf16 v[120:123], v[152:155], v[184:187], v[120:123]
    s_waitcnt lgkmcnt(0)
    v_mfma_f32_16x16x32_bf16 v[52:55], v[156:159], v[172:175], v[52:55]
    v_mfma_f32_16x16x32_bf16 v[76:79], v[156:159], v[176:179], v[76:79]
    v_mfma_f32_16x16x32_bf16 v[100:103], v[156:159], v[180:183], v[100:103]
    v_mfma_f32_16x16x32_bf16 v[124:127], v[156:159], v[184:187], v[124:127]
    v_add_u32 v9, 0xa000, v9
    v_add_u32 v10, 0xa000, v10
    v_add_u32 v15, 0xa000, v15
    v_add_u32 v16, 0xa000, v16
    v_add_u32 v17, 0xa000, v17
    v_add_u32 v18, 0xa000, v18
    s_barrier
    ds_read_b128 v[128:131], v9 offset:0
    ds_read_b64_tr_b16 v[132:133], v15 offset:24576
    ds_read_b64_tr_b16 v[134:135], v15 offset:28672
    ds_read_b64_tr_b16 v[136:137], v16 offset:24576
    ds_read_b64_tr_b16 v[138:139], v16 offset:28672
    ds_read_b64_tr_b16 v[140:141], v17 offset:24576
    ds_read_b64_tr_b16 v[142:143], v17 offset:28672
    ds_read_b64_tr_b16 v[144:145], v18 offset:24576
    ds_read_b64_tr_b16 v[146:147], v18 offset:28672
    ds_read_b128 v[148:151], v9 offset:2048
    s_waitcnt lgkmcnt(7)
    v_mfma_f32_16x16x32_bf16 v[32:35], v[128:131], v[132:135], v[32:35]
    ds_read_b128 v[152:155], v9 offset:4096
    s_waitcnt lgkmcnt(6)
    v_mfma_f32_16x16x32_bf16 v[56:59], v[128:131], v[136:139], v[56:59]
    ds_read_b128 v[156:159], v9 offset:6144
    s_waitcnt lgkmcnt(5)
    v_mfma_f32_16x16x32_bf16 v[80:83], v[128:131], v[140:143], v[80:83]
    ds_read_b128 v[160:163], v9 offset:8192
    s_waitcnt lgkmcnt(4)
    v_mfma_f32_16x16x32_bf16 v[104:107], v[128:131], v[144:147], v[104:107]
    ds_read_b128 v[164:167], v9 offset:10240
    s_waitcnt lgkmcnt(4)
    v_mfma_f32_16x16x32_bf16 v[36:39], v[148:151], v[132:135], v[36:39]
    ds_read_b128 v[168:171], v10 offset:0
    v_mfma_f32_16x16x32_bf16 v[60:63], v[148:151], v[136:139], v[60:63]
    ds_read_b64_tr_b16 v[172:173], v15 offset:32768
    ds_read_b64_tr_b16 v[174:175], v15 offset:36864
    v_mfma_f32_16x16x32_bf16 v[84:87], v[148:151], v[140:143], v[84:87]
    ds_read_b64_tr_b16 v[176:177], v16 offset:32768
    ds_read_b64_tr_b16 v[178:179], v16 offset:36864
    v_mfma_f32_16x16x32_bf16 v[108:111], v[148:151], v[144:147], v[108:111]
    ds_read_b64_tr_b16 v[180:181], v17 offset:32768
    ds_read_b64_tr_b16 v[182:183], v17 offset:36864
    s_waitcnt lgkmcnt(10)
    v_mfma_f32_16x16x32_bf16 v[40:43], v[152:155], v[132:135], v[40:43]
    ds_read_b64_tr_b16 v[184:185], v18 offset:32768
    ds_read_b64_tr_b16 v[186:187], v18 offset:36864
    v_mfma_f32_16x16x32_bf16 v[64:67], v[152:155], v[136:139], v[64:67]
    ds_read_b128 v[188:191], v10 offset:2048
    v_mfma_f32_16x16x32_bf16 v[88:91], v[152:155], v[140:143], v[88:91]
    ds_read_b128 v[128:131], v10 offset:4096
    v_mfma_f32_16x16x32_bf16 v[112:115], v[152:155], v[144:147], v[112:115]
    ds_read_b128 v[148:151], v10 offset:6144
    s_waitcnt lgkmcnt(14)
    v_mfma_f32_16x16x32_bf16 v[44:47], v[156:159], v[132:135], v[44:47]
    ds_read_b128 v[152:155], v10 offset:8192
    v_mfma_f32_16x16x32_bf16 v[68:71], v[156:159], v[136:139], v[68:71]
    v_mfma_f32_16x16x32_bf16 v[92:95], v[156:159], v[140:143], v[92:95]
    v_mfma_f32_16x16x32_bf16 v[116:119], v[156:159], v[144:147], v[116:119]
    ds_read_b128 v[156:159], v10 offset:10240
    s_waitcnt lgkmcnt(15)
    v_mfma_f32_16x16x32_bf16 v[48:51], v[160:163], v[132:135], v[48:51]
    v_mfma_f32_16x16x32_bf16 v[72:75], v[160:163], v[136:139], v[72:75]
    v_mfma_f32_16x16x32_bf16 v[96:99], v[160:163], v[140:143], v[96:99]
    v_mfma_f32_16x16x32_bf16 v[120:123], v[160:163], v[144:147], v[120:123]
    s_waitcnt lgkmcnt(14)
    v_mfma_f32_16x16x32_bf16 v[52:55], v[164:167], v[132:135], v[52:55]
    v_mfma_f32_16x16x32_bf16 v[76:79], v[164:167], v[136:139], v[76:79]
    v_mfma_f32_16x16x32_bf16 v[100:103], v[164:167], v[140:143], v[100:103]
    v_mfma_f32_16x16x32_bf16 v[124:127], v[164:167], v[144:147], v[124:127]
    s_waitcnt lgkmcnt(11)
    v_mfma_f32_16x16x32_bf16 v[32:35], v[168:171], v[172:175], v[32:35]
    s_waitcnt lgkmcnt(9)
    v_mfma_f32_16x16x32_bf16 v[56:59], v[168:171], v[176:179], v[56:59]
    s_waitcnt lgkmcnt(7)
    v_mfma_f32_16x16x32_bf16 v[80:83], v[168:171], v[180:183], v[80:83]
    s_waitcnt lgkmcnt(5)
    v_mfma_f32_16x16x32_bf16 v[104:107], v[168:171], v[184:187], v[104:107]
    s_waitcnt lgkmcnt(4)
    v_mfma_f32_16x16x32_bf16 v[36:39], v[188:191], v[172:175], v[36:39]
    v_mfma_f32_16x16x32_bf16 v[60:63], v[188:191], v[176:179], v[60:63]
    v_mfma_f32_16x16x32_bf16 v[84:87], v[188:191], v[180:183], v[84:87]
    v_mfma_f32_16x16x32_bf16 v[108:111], v[188:191], v[184:187], v[108:111]
    s_waitcnt lgkmcnt(3)
    v_mfma_f32_16x16x32_bf16 v[40:43], v[128:131], v[172:175], v[40:43]
    v_mfma_f32_16x16x32_bf16 v[64:67], v[128:131], v[176:179], v[64:67]
    v_mfma_f32_16x16x32_bf16 v[88:91], v[128:131], v[180:183], v[88:91]
    v_mfma_f32_16x16x32_bf16 v[112:115], v[128:131], v[184:187], v[112:115]
    s_waitcnt lgkmcnt(2)
    v_mfma_f32_16x16x32_bf16 v[44:47], v[148:151], v[172:175], v[44:47]
    v_mfma_f32_16x16x32_bf16 v[68:71], v[148:151], v[176:179], v[68:71]
    v_mfma_f32_16x16x32_bf16 v[92:95], v[148:151], v[180:183], v[92:95]
    v_mfma_f32_16x16x32_bf16 v[116:119], v[148:151], v[184:187], v[116:119]
    s_waitcnt lgkmcnt(1)
    v_mfma_f32_16x16x32_bf16 v[48:51], v[152:155], v[172:175], v[48:51]
    v_mfma_f32_16x16x32_bf16 v[72:75], v[152:155], v[176:179], v[72:75]
    v_mfma_f32_16x16x32_bf16 v[96:99], v[152:155], v[180:183], v[96:99]
    v_mfma_f32_16x16x32_bf16 v[120:123], v[152:155], v[184:187], v[120:123]
    s_waitcnt lgkmcnt(0)
    v_mfma_f32_16x16x32_bf16 v[52:55], v[156:159], v[172:175], v[52:55]
    v_mfma_f32_16x16x32_bf16 v[76:79], v[156:159], v[176:179], v[76:79]
    v_mfma_f32_16x16x32_bf16 v[100:103], v[156:159], v[180:183], v[100:103]
    v_mfma_f32_16x16x32_bf16 v[124:127], v[156:159], v[184:187], v[124:127]
    v_add_u32 v9, 0xa000, v9
    v_add_u32 v10, 0xa000, v10
    v_add_u32 v15, 0xa000, v15
    v_add_u32 v16, 0xa000, v16
    v_add_u32 v17, 0xa000, v17
    v_add_u32 v18, 0xa000, v18
    s_barrier
    ds_read_b128 v[128:131], v9 offset:0
    ds_read_b64_tr_b16 v[132:133], v15 offset:24576
    ds_read_b64_tr_b16 v[134:135], v15 offset:28672
    ds_read_b64_tr_b16 v[136:137], v16 offset:24576
    ds_read_b64_tr_b16 v[138:139], v16 offset:28672
    ds_read_b64_tr_b16 v[140:141], v17 offset:24576
    ds_read_b64_tr_b16 v[142:143], v17 offset:28672
    ds_read_b64_tr_b16 v[144:145], v18 offset:24576
    ds_read_b64_tr_b16 v[146:147], v18 offset:28672
    ds_read_b128 v[148:151], v9 offset:2048
    s_waitcnt lgkmcnt(7)
    v_mfma_f32_16x16x32_bf16 v[32:35], v[128:131], v[132:135], v[32:35]
    ds_read_b128 v[152:155], v9 offset:4096
    s_waitcnt lgkmcnt(6)
    v_mfma_f32_16x16x32_bf16 v[56:59], v[128:131], v[136:139], v[56:59]
    ds_read_b128 v[156:159], v9 offset:6144
    s_waitcnt lgkmcnt(5)
    v_mfma_f32_16x16x32_bf16 v[80:83], v[128:131], v[140:143], v[80:83]
    ds_read_b128 v[160:163], v9 offset:8192
    s_waitcnt lgkmcnt(4)
    v_mfma_f32_16x16x32_bf16 v[104:107], v[128:131], v[144:147], v[104:107]
    ds_read_b128 v[164:167], v9 offset:10240
    s_waitcnt lgkmcnt(4)
    v_mfma_f32_16x16x32_bf16 v[36:39], v[148:151], v[132:135], v[36:39]
    ds_read_b128 v[168:171], v10 offset:0
    v_mfma_f32_16x16x32_bf16 v[60:63], v[148:151], v[136:139], v[60:63]
    ds_read_b64_tr_b16 v[172:173], v15 offset:32768
    ds_read_b64_tr_b16 v[174:175], v15 offset:36864
    v_mfma_f32_16x16x32_bf16 v[84:87], v[148:151], v[140:143], v[84:87]
    ds_read_b64_tr_b16 v[176:177], v16 offset:32768
    ds_read_b64_tr_b16 v[178:179], v16 offset:36864
    v_mfma_f32_16x16x32_bf16 v[108:111], v[148:151], v[144:147], v[108:111]
    ds_read_b64_tr_b16 v[180:181], v17 offset:32768
    ds_read_b64_tr_b16 v[182:183], v17 offset:36864
    s_waitcnt lgkmcnt(10)
    v_mfma_f32_16x16x32_bf16 v[40:43], v[152:155], v[132:135], v[40:43]
    ds_read_b64_tr_b16 v[184:185], v18 offset:32768
    ds_read_b64_tr_b16 v[186:187], v18 offset:36864
    v_mfma_f32_16x16x32_bf16 v[64:67], v[152:155], v[136:139], v[64:67]
    ds_read_b128 v[188:191], v10 offset:2048
    v_mfma_f32_16x16x32_bf16 v[88:91], v[152:155], v[140:143], v[88:91]
    ds_read_b128 v[128:131], v10 offset:4096
    v_mfma_f32_16x16x32_bf16 v[112:115], v[152:155], v[144:147], v[112:115]
    ds_read_b128 v[148:151], v10 offset:6144
    s_waitcnt lgkmcnt(14)
    v_mfma_f32_16x16x32_bf16 v[44:47], v[156:159], v[132:135], v[44:47]
    ds_read_b128 v[152:155], v10 offset:8192
    v_mfma_f32_16x16x32_bf16 v[68:71], v[156:159], v[136:139], v[68:71]
    v_mfma_f32_16x16x32_bf16 v[92:95], v[156:159], v[140:143], v[92:95]
    v_mfma_f32_16x16x32_bf16 v[116:119], v[156:159], v[144:147], v[116:119]
    ds_read_b128 v[156:159], v10 offset:10240
    s_waitcnt lgkmcnt(15)
    v_mfma_f32_16x16x32_bf16 v[48:51], v[160:163], v[132:135], v[48:51]
    v_mfma_f32_16x16x32_bf16 v[72:75], v[160:163], v[136:139], v[72:75]
    v_mfma_f32_16x16x32_bf16 v[96:99], v[160:163], v[140:143], v[96:99]
    v_mfma_f32_16x16x32_bf16 v[120:123], v[160:163], v[144:147], v[120:123]
    s_waitcnt lgkmcnt(14)
    v_mfma_f32_16x16x32_bf16 v[52:55], v[164:167], v[132:135], v[52:55]
    v_mfma_f32_16x16x32_bf16 v[76:79], v[164:167], v[136:139], v[76:79]
    v_mfma_f32_16x16x32_bf16 v[100:103], v[164:167], v[140:143], v[100:103]
    v_mfma_f32_16x16x32_bf16 v[124:127], v[164:167], v[144:147], v[124:127]
    s_waitcnt lgkmcnt(11)
    v_mfma_f32_16x16x32_bf16 v[32:35], v[168:171], v[172:175], v[32:35]
    s_waitcnt lgkmcnt(9)
    v_mfma_f32_16x16x32_bf16 v[56:59], v[168:171], v[176:179], v[56:59]
    s_waitcnt lgkmcnt(7)
    v_mfma_f32_16x16x32_bf16 v[80:83], v[168:171], v[180:183], v[80:83]
    s_waitcnt lgkmcnt(5)
    v_mfma_f32_16x16x32_bf16 v[104:107], v[168:171], v[184:187], v[104:107]
    s_waitcnt lgkmcnt(4)
    v_mfma_f32_16x16x32_bf16 v[36:39], v[188:191], v[172:175], v[36:39]
    v_mfma_f32_16x16x32_bf16 v[60:63], v[188:191], v[176:179], v[60:63]
    v_mfma_f32_16x16x32_bf16 v[84:87], v[188:191], v[180:183], v[84:87]
    v_mfma_f32_16x16x32_bf16 v[108:111], v[188:191], v[184:187], v[108:111]
    s_waitcnt lgkmcnt(3)
    v_mfma_f32_16x16x32_bf16 v[40:43], v[128:131], v[172:175], v[40:43]
    v_mfma_f32_16x16x32_bf16 v[64:67], v[128:131], v[176:179], v[64:67]
    v_mfma_f32_16x16x32_bf16 v[88:91], v[128:131], v[180:183], v[88:91]
    v_mfma_f32_16x16x32_bf16 v[112:115], v[128:131], v[184:187], v[112:115]
    s_waitcnt lgkmcnt(2)
    v_mfma_f32_16x16x32_bf16 v[44:47], v[148:151], v[172:175], v[44:47]
    v_mfma_f32_16x16x32_bf16 v[68:71], v[148:151], v[176:179], v[68:71]
    v_mfma_f32_16x16x32_bf16 v[92:95], v[148:151], v[180:183], v[92:95]
    v_mfma_f32_16x16x32_bf16 v[116:119], v[148:151], v[184:187], v[116:119]
    s_waitcnt lgkmcnt(1)
    v_mfma_f32_16x16x32_bf16 v[48:51], v[152:155], v[172:175], v[48:51]
    v_mfma_f32_16x16x32_bf16 v[72:75], v[152:155], v[176:179], v[72:75]
    v_mfma_f32_16x16x32_bf16 v[96:99], v[152:155], v[180:183], v[96:99]
    v_mfma_f32_16x16x32_bf16 v[120:123], v[152:155], v[184:187], v[120:123]
    s_waitcnt lgkmcnt(0)
    v_mfma_f32_16x16x32_bf16 v[52:55], v[156:159], v[172:175], v[52:55]
    v_mfma_f32_16x16x32_bf16 v[76:79], v[156:159], v[176:179], v[76:79]
    v_mfma_f32_16x16x32_bf16 v[100:103], v[156:159], v[180:183], v[100:103]
    v_mfma_f32_16x16x32_bf16 v[124:127], v[156:159], v[184:187], v[124:127]
    v_add_u32 v9, 0xa000, v9
    v_add_u32 v10, 0xa000, v10
    v_add_u32 v15, 0xa000, v15
    v_add_u32 v16, 0xa000, v16
    v_add_u32 v17, 0xa000, v17
    v_add_u32 v18, 0xa000, v18
    s_barrier
    ds_read_b128 v[128:131], v9 offset:0
    ds_read_b64_tr_b16 v[132:133], v15 offset:24576
    ds_read_b64_tr_b16 v[134:135], v15 offset:28672
    ds_read_b64_tr_b16 v[136:137], v16 offset:24576
    ds_read_b64_tr_b16 v[138:139], v16 offset:28672
    ds_read_b64_tr_b16 v[140:141], v17 offset:24576
    ds_read_b64_tr_b16 v[142:143], v17 offset:28672
    ds_read_b64_tr_b16 v[144:145], v18 offset:24576
    ds_read_b64_tr_b16 v[146:147], v18 offset:28672
    ds_read_b128 v[148:151], v9 offset:2048
    s_waitcnt lgkmcnt(7)
    v_mfma_f32_16x16x32_bf16 v[32:35], v[128:131], v[132:135], v[32:35]
    ds_read_b128 v[152:155], v9 offset:4096
    s_waitcnt lgkmcnt(6)
    v_mfma_f32_16x16x32_bf16 v[56:59], v[128:131], v[136:139], v[56:59]
    ds_read_b128 v[156:159], v9 offset:6144
    s_waitcnt lgkmcnt(5)
    v_mfma_f32_16x16x32_bf16 v[80:83], v[128:131], v[140:143], v[80:83]
    ds_read_b128 v[160:163], v9 offset:8192
    s_waitcnt lgkmcnt(4)
    v_mfma_f32_16x16x32_bf16 v[104:107], v[128:131], v[144:147], v[104:107]
    ds_read_b128 v[164:167], v9 offset:10240
    s_waitcnt lgkmcnt(4)
    v_mfma_f32_16x16x32_bf16 v[36:39], v[148:151], v[132:135], v[36:39]
    ds_read_b128 v[168:171], v10 offset:0
    v_mfma_f32_16x16x32_bf16 v[60:63], v[148:151], v[136:139], v[60:63]
    ds_read_b64_tr_b16 v[172:173], v15 offset:32768
    ds_read_b64_tr_b16 v[174:175], v15 offset:36864
    v_mfma_f32_16x16x32_bf16 v[84:87], v[148:151], v[140:143], v[84:87]
    ds_read_b64_tr_b16 v[176:177], v16 offset:32768
    ds_read_b64_tr_b16 v[178:179], v16 offset:36864
    v_mfma_f32_16x16x32_bf16 v[108:111], v[148:151], v[144:147], v[108:111]
    ds_read_b64_tr_b16 v[180:181], v17 offset:32768
    ds_read_b64_tr_b16 v[182:183], v17 offset:36864
    s_waitcnt lgkmcnt(10)
    v_mfma_f32_16x16x32_bf16 v[40:43], v[152:155], v[132:135], v[40:43]
    ds_read_b64_tr_b16 v[184:185], v18 offset:32768
    ds_read_b64_tr_b16 v[186:187], v18 offset:36864
    v_mfma_f32_16x16x32_bf16 v[64:67], v[152:155], v[136:139], v[64:67]
    ds_read_b128 v[188:191], v10 offset:2048
    v_mfma_f32_16x16x32_bf16 v[88:91], v[152:155], v[140:143], v[88:91]
    ds_read_b128 v[128:131], v10 offset:4096
    v_mfma_f32_16x16x32_bf16 v[112:115], v[152:155], v[144:147], v[112:115]
    ds_read_b128 v[148:151], v10 offset:6144
    s_waitcnt lgkmcnt(14)
    v_mfma_f32_16x16x32_bf16 v[44:47], v[156:159], v[132:135], v[44:47]
    ds_read_b128 v[152:155], v10 offset:8192
    v_mfma_f32_16x16x32_bf16 v[68:71], v[156:159], v[136:139], v[68:71]
    v_mfma_f32_16x16x32_bf16 v[92:95], v[156:159], v[140:143], v[92:95]
    v_mfma_f32_16x16x32_bf16 v[116:119], v[156:159], v[144:147], v[116:119]
    ds_read_b128 v[156:159], v10 offset:10240
    s_waitcnt lgkmcnt(15)
    v_mfma_f32_16x16x32_bf16 v[48:51], v[160:163], v[132:135], v[48:51]
    v_mfma_f32_16x16x32_bf16 v[72:75], v[160:163], v[136:139], v[72:75]
    v_mfma_f32_16x16x32_bf16 v[96:99], v[160:163], v[140:143], v[96:99]
    v_mfma_f32_16x16x32_bf16 v[120:123], v[160:163], v[144:147], v[120:123]
    s_waitcnt lgkmcnt(14)
    v_mfma_f32_16x16x32_bf16 v[52:55], v[164:167], v[132:135], v[52:55]
    v_mfma_f32_16x16x32_bf16 v[76:79], v[164:167], v[136:139], v[76:79]
    v_mfma_f32_16x16x32_bf16 v[100:103], v[164:167], v[140:143], v[100:103]
    v_mfma_f32_16x16x32_bf16 v[124:127], v[164:167], v[144:147], v[124:127]
    s_waitcnt lgkmcnt(11)
    v_mfma_f32_16x16x32_bf16 v[32:35], v[168:171], v[172:175], v[32:35]
    s_waitcnt lgkmcnt(9)
    v_mfma_f32_16x16x32_bf16 v[56:59], v[168:171], v[176:179], v[56:59]
    s_waitcnt lgkmcnt(7)
    v_mfma_f32_16x16x32_bf16 v[80:83], v[168:171], v[180:183], v[80:83]
    s_waitcnt lgkmcnt(5)
    v_mfma_f32_16x16x32_bf16 v[104:107], v[168:171], v[184:187], v[104:107]
    s_waitcnt lgkmcnt(4)
    v_mfma_f32_16x16x32_bf16 v[36:39], v[188:191], v[172:175], v[36:39]
    v_mfma_f32_16x16x32_bf16 v[60:63], v[188:191], v[176:179], v[60:63]
    v_mfma_f32_16x16x32_bf16 v[84:87], v[188:191], v[180:183], v[84:87]
    v_mfma_f32_16x16x32_bf16 v[108:111], v[188:191], v[184:187], v[108:111]
    s_waitcnt lgkmcnt(3)
    v_mfma_f32_16x16x32_bf16 v[40:43], v[128:131], v[172:175], v[40:43]
    v_mfma_f32_16x16x32_bf16 v[64:67], v[128:131], v[176:179], v[64:67]
    v_mfma_f32_16x16x32_bf16 v[88:91], v[128:131], v[180:183], v[88:91]
    v_mfma_f32_16x16x32_bf16 v[112:115], v[128:131], v[184:187], v[112:115]
    s_waitcnt lgkmcnt(2)
    v_mfma_f32_16x16x32_bf16 v[44:47], v[148:151], v[172:175], v[44:47]
    v_mfma_f32_16x16x32_bf16 v[68:71], v[148:151], v[176:179], v[68:71]
    v_mfma_f32_16x16x32_bf16 v[92:95], v[148:151], v[180:183], v[92:95]
    v_mfma_f32_16x16x32_bf16 v[116:119], v[148:151], v[184:187], v[116:119]
    s_waitcnt lgkmcnt(1)
    v_mfma_f32_16x16x32_bf16 v[48:51], v[152:155], v[172:175], v[48:51]
    v_mfma_f32_16x16x32_bf16 v[72:75], v[152:155], v[176:179], v[72:75]
    v_mfma_f32_16x16x32_bf16 v[96:99], v[152:155], v[180:183], v[96:99]
    v_mfma_f32_16x16x32_bf16 v[120:123], v[152:155], v[184:187], v[120:123]
    s_waitcnt lgkmcnt(0)
    v_mfma_f32_16x16x32_bf16 v[52:55], v[156:159], v[172:175], v[52:55]
    v_mfma_f32_16x16x32_bf16 v[76:79], v[156:159], v[176:179], v[76:79]
    v_mfma_f32_16x16x32_bf16 v[100:103], v[156:159], v[180:183], v[100:103]
    v_mfma_f32_16x16x32_bf16 v[124:127], v[156:159], v[184:187], v[124:127]
    v_add_u32 v9, 0xfffe2000, v9
    v_add_u32 v10, 0xfffe2000, v10
    v_add_u32 v15, 0xfffe2000, v15
    v_add_u32 v16, 0xfffe2000, v16
    v_add_u32 v17, 0xfffe2000, v17
    v_add_u32 v18, 0xfffe2000, v18
    s_sub_u32 s39, s39, 1
    s_cmp_lg_u32 s39, 0
    s_cbranch_scc1 kl_23
    s_barrier
    ds_read_b128 v[128:131], v9 offset:0
    ds_read_b64_tr_b16 v[132:133], v15 offset:24576
    ds_read_b64_tr_b16 v[134:135], v15 offset:28672
    ds_read_b64_tr_b16 v[136:137], v16 offset:24576
    ds_read_b64_tr_b16 v[138:139], v16 offset:28672
    ds_read_b64_tr_b16 v[140:141], v17 offset:24576
    ds_read_b64_tr_b16 v[142:143], v17 offset:28672
    ds_read_b64_tr_b16 v[144:145], v18 offset:24576
    ds_read_b64_tr_b16 v[146:147], v18 offset:28672
    ds_read_b128 v[148:151], v9 offset:2048
    s_waitcnt lgkmcnt(7)
    v_mfma_f32_16x16x32_bf16 v[32:35], v[128:131], v[132:135], v[32:35]
    ds_read_b128 v[152:155], v9 offset:4096
    s_waitcnt lgkmcnt(6)
    v_mfma_f32_16x16x32_bf16 v[56:59], v[128:131], v[136:139], v[56:59]
    ds_read_b128 v[156:159], v9 offset:6144
    s_waitcnt lgkmcnt(5)
    v_mfma_f32_16x16x32_bf16 v[80:83], v[128:131], v[140:143], v[80:83]
    ds_read_b128 v[160:163], v9 offset:8192
    s_waitcnt lgkmcnt(4)
    v_mfma_f32_16x16x32_bf16 v[104:107], v[128:131], v[144:147], v[104:107]
    ds_read_b128 v[164:167], v9 offset:10240
    s_waitcnt lgkmcnt(4)
    v_mfma_f32_16x16x32_bf16 v[36:39], v[148:151], v[132:135], v[36:39]
    ds_read_b128 v[168:171], v10 offset:0
    v_mfma_f32_16x16x32_bf16 v[60:63], v[148:151], v[136:139], v[60:63]
    ds_read_b64_tr_b16 v[172:173], v15 offset:32768
    ds_read_b64_tr_b16 v[174:175], v15 offset:36864
    v_mfma_f32_16x16x32_bf16 v[84:87], v[148:151], v[140:143], v[84:87]
    ds_read_b64_tr_b16 v[176:177], v16 offset:32768
    ds_read_b64_tr_b16 v[178:179], v16 offset:36864
    v_mfma_f32_16x16x32_bf16 v[108:111], v[148:151], v[144:147], v[108:111]
    ds_read_b64_tr_b16 v[180:181], v17 offset:32768
    ds_read_b64_tr_b16 v[182:183], v17 offset:36864
    s_waitcnt lgkmcnt(10)
    v_mfma_f32_16x16x32_bf16 v[40:43], v[152:155], v[132:135], v[40:43]
    ds_read_b64_tr_b16 v[184:185], v18 offset:32768
    ds_read_b64_tr_b16 v[186:187], v18 offset:36864
    v_mfma_f32_16x16x32_bf16 v[64:67], v[152:155], v[136:139], v[64:67]
    ds_read_b128 v[188:191], v10 offset:2048
    v_mfma_f32_16x16x32_bf16 v[88:91], v[152:155], v[140:143], v[88:91]
    ds_read_b128 v[128:131], v10 offset:4096
    v_mfma_f32_16x16x32_bf16 v[112:115], v[152:155], v[144:147], v[112:115]
    ds_read_b128 v[148:151], v10 offset:6144
    s_waitcnt lgkmcnt(14)
    v_mfma_f32_16x16x32_bf16 v[44:47], v[156:159], v[132:135], v[44:47]
    ds_read_b128 v[152:155], v10 offset:8192
    v_mfma_f32_16x16x32_bf16 v[68:71], v[156:159], v[136:139], v[68:71]
    v_mfma_f32_16x16x32_bf16 v[92:95], v[156:159], v[140:143], v[92:95]
    v_mfma_f32_16x16x32_bf16 v[116:119], v[156:159], v[144:147], v[116:119]
    ds_read_b128 v[156:159], v10 offset:10240
    s_waitcnt lgkmcnt(15)
    v_mfma_f32_16x16x32_bf16 v[48:51], v[160:163], v[132:135], v[48:51]
    v_mfma_f32_16x16x32_bf16 v[72:75], v[160:163], v[136:139], v[72:75]
    v_mfma_f32_16x16x32_bf16 v[96:99], v[160:163], v[140:143], v[96:99]
    v_mfma_f32_16x16x32_bf16 v[120:123], v[160:163], v[144:147], v[120:123]
    s_waitcnt lgkmcnt(14)
    v_mfma_f32_16x16x32_bf16 v[52:55], v[164:167], v[132:135], v[52:55]
    v_mfma_f32_16x16x32_bf16 v[76:79], v[164:167], v[136:139], v[76:79]
    v_mfma_f32_16x16x32_bf16 v[100:103], v[164:167], v[140:143], v[100:103]
    v_mfma_f32_16x16x32_bf16 v[124:127], v[164:167], v[144:147], v[124:127]
    s_waitcnt lgkmcnt(11)
    v_mfma_f32_16x16x32_bf16 v[32:35], v[168:171], v[172:175], v[32:35]
    s_waitcnt lgkmcnt(9)
    v_mfma_f32_16x16x32_bf16 v[56:59], v[168:171], v[176:179], v[56:59]
    s_waitcnt lgkmcnt(7)
    v_mfma_f32_16x16x32_bf16 v[80:83], v[168:171], v[180:183], v[80:83]
    s_waitcnt lgkmcnt(5)
    v_mfma_f32_16x16x32_bf16 v[104:107], v[168:171], v[184:187], v[104:107]
    s_waitcnt lgkmcnt(4)
    v_mfma_f32_16x16x32_bf16 v[36:39], v[188:191], v[172:175], v[36:39]
    v_mfma_f32_16x16x32_bf16 v[60:63], v[188:191], v[176:179], v[60:63]
    v_mfma_f32_16x16x32_bf16 v[84:87], v[188:191], v[180:183], v[84:87]
    v_mfma_f32_16x16x32_bf16 v[108:111], v[188:191], v[184:187], v[108:111]
    s_waitcnt lgkmcnt(3)
    v_mfma_f32_16x16x32_bf16 v[40:43], v[128:131], v[172:175], v[40:43]
    v_mfma_f32_16x16x32_bf16 v[64:67], v[128:131], v[176:179], v[64:67]
    v_mfma_f32_16x16x32_bf16 v[88:91], v[128:131], v[180:183], v[88:91]
    v_mfma_f32_16x16x32_bf16 v[112:115], v[128:131], v[184:187], v[112:115]
    s_waitcnt lgkmcnt(2)
    v_mfma_f32_16x16x32_bf16 v[44:47], v[148:151], v[172:175], v[44:47]
    v_mfma_f32_16x16x32_bf16 v[68:71], v[148:151], v[176:179], v[68:71]
    v_mfma_f32_16x16x32_bf16 v[92:95], v[148:151], v[180:183], v[92:95]
    v_mfma_f32_16x16x32_bf16 v[116:119], v[148:151], v[184:187], v[116:119]
    s_waitcnt lgkmcnt(1)
    v_mfma_f32_16x16x32_bf16 v[48:51], v[152:155], v[172:175], v[48:51]
    v_mfma_f32_16x16x32_bf16 v[72:75], v[152:155], v[176:179], v[72:75]
    v_mfma_f32_16x16x32_bf16 v[96:99], v[152:155], v[180:183], v[96:99]
    v_mfma_f32_16x16x32_bf16 v[120:123], v[152:155], v[184:187], v[120:123]
    s_waitcnt lgkmcnt(0)
    v_mfma_f32_16x16x32_bf16 v[52:55], v[156:159], v[172:175], v[52:55]
    v_mfma_f32_16x16x32_bf16 v[76:79], v[156:159], v[176:179], v[76:79]
    v_mfma_f32_16x16x32_bf16 v[100:103], v[156:159], v[180:183], v[100:103]
    v_mfma_f32_16x16x32_bf16 v[124:127], v[156:159], v[184:187], v[124:127]
    v_add_u32 v9, 0xa000, v9
    v_add_u32 v10, 0xa000, v10
    v_add_u32 v15, 0xa000, v15
    v_add_u32 v16, 0xa000, v16
    v_add_u32 v17, 0xa000, v17
    v_add_u32 v18, 0xa000, v18
    s_barrier
    ds_read_b128 v[128:131], v9 offset:0
    ds_read_b64_tr_b16 v[132:133], v15 offset:24576
    ds_read_b64_tr_b16 v[134:135], v15 offset:28672
    ds_read_b64_tr_b16 v[136:137], v16 offset:24576
    ds_read_b64_tr_b16 v[138:139], v16 offset:28672
    ds_read_b64_tr_b16 v[140:141], v17 offset:24576
    ds_read_b64_tr_b16 v[142:143], v17 offset:28672
    ds_read_b64_tr_b16 v[144:145], v18 offset:24576
    ds_read_b64_tr_b16 v[146:147], v18 offset:28672
    ds_read_b128 v[148:151], v9 offset:2048
    s_waitcnt lgkmcnt(7)
    v_mfma_f32_16x16x32_bf16 v[32:35], v[128:131], v[132:135], v[32:35]
    ds_read_b128 v[152:155], v9 offset:4096
    s_waitcnt lgkmcnt(6)
    v_mfma_f32_16x16x32_bf16 v[56:59], v[128:131], v[136:139], v[56:59]
    ds_read_b128 v[156:159], v9 offset:6144
    s_waitcnt lgkmcnt(5)
    v_mfma_f32_16x16x32_bf16 v[80:83], v[128:131], v[140:143], v[80:83]
    ds_read_b128 v[160:163], v9 offset:8192
    s_waitcnt lgkmcnt(4)
    v_mfma_f32_16x16x32_bf16 v[104:107], v[128:131], v[144:147], v[104:107]
    ds_read_b128 v[164:167], v9 offset:10240
    s_waitcnt lgkmcnt(4)
    v_mfma_f32_16x16x32_bf16 v[36:39], v[148:151], v[132:135], v[36:39]
    ds_read_b128 v[168:171], v10 offset:0
    v_mfma_f32_16x16x32_bf16 v[60:63], v[148:151], v[136:139], v[60:63]
    ds_read_b64_tr_b16 v[172:173], v15 offset:32768
    ds_read_b64_tr_b16 v[174:175], v15 offset:36864
    v_mfma_f32_16x16x32_bf16 v[84:87], v[148:151], v[140:143], v[84:87]
    ds_read_b64_tr_b16 v[176:177], v16 offset:32768
    ds_read_b64_tr_b16 v[178:179], v16 offset:36864
    v_mfma_f32_16x16x32_bf16 v[108:111], v[148:151], v[144:147], v[108:111]
    ds_read_b64_tr_b16 v[180:181], v17 offset:32768
    ds_read_b64_tr_b16 v[182:183], v17 offset:36864
    s_waitcnt lgkmcnt(10)
    v_mfma_f32_16x16x32_bf16 v[40:43], v[152:155], v[132:135], v[40:43]
    ds_read_b64_tr_b16 v[184:185], v18 offset:32768
    ds_read_b64_tr_b16 v[186:187], v18 offset:36864
    v_mfma_f32_16x16x32_bf16 v[64:67], v[152:155], v[136:139], v[64:67]
    ds_read_b128 v[188:191], v10 offset:2048
    v_mfma_f32_16x16x32_bf16 v[88:91], v[152:155], v[140:143], v[88:91]
    ds_read_b128 v[128:131], v10 offset:4096
    v_mfma_f32_16x16x32_bf16 v[112:115], v[152:155], v[144:147], v[112:115]
    ds_read_b128 v[148:151], v10 offset:6144
    s_waitcnt lgkmcnt(14)
    v_mfma_f32_16x16x32_bf16 v[44:47], v[156:159], v[132:135], v[44:47]
    ds_read_b128 v[152:155], v10 offset:8192
    v_mfma_f32_16x16x32_bf16 v[68:71], v[156:159], v[136:139], v[68:71]
    v_mfma_f32_16x16x32_bf16 v[92:95], v[156:159], v[140:143], v[92:95]
    v_mfma_f32_16x16x32_bf16 v[116:119], v[156:159], v[144:147], v[116:119]
    ds_read_b128 v[156:159], v10 offset:10240
    s_waitcnt lgkmcnt(15)
    v_mfma_f32_16x16x32_bf16 v[48:51], v[160:163], v[132:135], v[48:51]
    v_mfma_f32_16x16x32_bf16 v[72:75], v[160:163], v[136:139], v[72:75]
    v_mfma_f32_16x16x32_bf16 v[96:99], v[160:163], v[140:143], v[96:99]
    v_mfma_f32_16x16x32_bf16 v[120:123], v[160:163], v[144:147], v[120:123]
    s_waitcnt lgkmcnt(14)
    v_mfma_f32_16x16x32_bf16 v[52:55], v[164:167], v[132:135], v[52:55]
    v_mfma_f32_16x16x32_bf16 v[76:79], v[164:167], v[136:139], v[76:79]
    v_mfma_f32_16x16x32_bf16 v[100:103], v[164:167], v[140:143], v[100:103]
    v_mfma_f32_16x16x32_bf16 v[124:127], v[164:167], v[144:147], v[124:127]
    s_waitcnt lgkmcnt(11)
    v_mfma_f32_16x16x32_bf16 v[32:35], v[168:171], v[172:175], v[32:35]
    s_waitcnt lgkmcnt(9)
    v_mfma_f32_16x16x32_bf16 v[56:59], v[168:171], v[176:179], v[56:59]
    s_waitcnt lgkmcnt(7)
    v_mfma_f32_16x16x32_bf16 v[80:83], v[168:171], v[180:183], v[80:83]
    s_waitcnt lgkmcnt(5)
    v_mfma_f32_16x16x32_bf16 v[104:107], v[168:171], v[184:187], v[104:107]
    s_waitcnt lgkmcnt(4)
    v_mfma_f32_16x16x32_bf16 v[36:39], v[188:191], v[172:175], v[36:39]
    v_mfma_f32_16x16x32_bf16 v[60:63], v[188:191], v[176:179], v[60:63]
    v_mfma_f32_16x16x32_bf16 v[84:87], v[188:191], v[180:183], v[84:87]
    v_mfma_f32_16x16x32_bf16 v[108:111], v[188:191], v[184:187], v[108:111]
    s_waitcnt lgkmcnt(3)
    v_mfma_f32_16x16x32_bf16 v[40:43], v[128:131], v[172:175], v[40:43]
    v_mfma_f32_16x16x32_bf16 v[64:67], v[128:131], v[176:179], v[64:67]
    v_mfma_f32_16x16x32_bf16 v[88:91], v[128:131], v[180:183], v[88:91]
    v_mfma_f32_16x16x32_bf16 v[112:115], v[128:131], v[184:187], v[112:115]
    s_waitcnt lgkmcnt(2)
    v_mfma_f32_16x16x32_bf16 v[44:47], v[148:151], v[172:175], v[44:47]
    v_mfma_f32_16x16x32_bf16 v[68:71], v[148:151], v[176:179], v[68:71]
    v_mfma_f32_16x16x32_bf16 v[92:95], v[148:151], v[180:183], v[92:95]
    v_mfma_f32_16x16x32_bf16 v[116:119], v[148:151], v[184:187], v[116:119]
    s_waitcnt lgkmcnt(1)
    v_mfma_f32_16x16x32_bf16 v[48:51], v[152:155], v[172:175], v[48:51]
    v_mfma_f32_16x16x32_bf16 v[72:75], v[152:155], v[176:179], v[72:75]
    v_mfma_f32_16x16x32_bf16 v[96:99], v[152:155], v[180:183], v[96:99]
    v_mfma_f32_16x16x32_bf16 v[120:123], v[152:155], v[184:187], v[120:123]
    s_waitcnt lgkmcnt(0)
    v_mfma_f32_16x16x32_bf16 v[52:55], v[156:159], v[172:175], v[52:55]
    v_mfma_f32_16x16x32_bf16 v[76:79], v[156:159], v[176:179], v[76:79]
    v_mfma_f32_16x16x32_bf16 v[100:103], v[156:159], v[180:183], v[100:103]
    v_mfma_f32_16x16x32_bf16 v[124:127], v[156:159], v[184:187], v[124:127]
    v_add_u32 v9, 0xa000, v9
    v_add_u32 v10, 0xa000, v10
    v_add_u32 v15, 0xa000, v15
    v_add_u32 v16, 0xa000, v16
    v_add_u32 v17, 0xa000, v17
    v_add_u32 v18, 0xa000, v18
    s_barrier
    ds_read_b128 v[128:131], v9 offset:0
    ds_read_b64_tr_b16 v[132:133], v15 offset:24576
    ds_read_b64_tr_b16 v[134:135], v15 offset:28672
    ds_read_b64_tr_b16 v[136:137], v16 offset:24576
    ds_read_b64_tr_b16 v[138:139], v16 offset:28672
    ds_read_b64_tr_b16 v[140:141], v17 offset:24576
    ds_read_b64_tr_b16 v[142:143], v17 offset:28672
    ds_read_b64_tr_b16 v[144:145], v18 offset:24576
    ds_read_b64_tr_b16 v[146:147], v18 offset:28672
    ds_read_b128 v[148:151], v9 offset:2048
    s_waitcnt lgkmcnt(7)
    v_mfma_f32_16x16x32_bf16 v[32:35], v[128:131], v[132:135], v[32:35]
    ds_read_b128 v[152:155], v9 offset:4096
    s_waitcnt lgkmcnt(6)
    v_mfma_f32_16x16x32_bf16 v[56:59], v[128:131], v[136:139], v[56:59]
    ds_read_b128 v[156:159], v9 offset:6144
    s_waitcnt lgkmcnt(5)
    v_mfma_f32_16x16x32_bf16 v[80:83], v[128:131], v[140:143], v[80:83]
    ds_read_b128 v[160:163], v9 offset:8192
    s_waitcnt lgkmcnt(4)
    v_mfma_f32_16x16x32_bf16 v[104:107], v[128:131], v[144:147], v[104:107]
    ds_read_b128 v[164:167], v9 offset:10240
    s_waitcnt lgkmcnt(4)
    v_mfma_f32_16x16x32_bf16 v[36:39], v[148:151], v[132:135], v[36:39]
    ds_read_b128 v[168:171], v10 offset:0
    v_mfma_f32_16x16x32_bf16 v[60:63], v[148:151], v[136:139], v[60:63]
    ds_read_b64_tr_b16 v[172:173], v15 offset:32768
    ds_read_b64_tr_b16 v[174:175], v15 offset:36864
    v_mfma_f32_16x16x32_bf16 v[84:87], v[148:151], v[140:143], v[84:87]
    ds_read_b64_tr_b16 v[176:177], v16 offset:32768
    ds_read_b64_tr_b16 v[178:179], v16 offset:36864
    v_mfma_f32_16x16x32_bf16 v[108:111], v[148:151], v[144:147], v[108:111]
    ds_read_b64_tr_b16 v[180:181], v17 offset:32768
    ds_read_b64_tr_b16 v[182:183], v17 offset:36864
    s_waitcnt lgkmcnt(10)
    v_mfma_f32_16x16x32_bf16 v[40:43], v[152:155], v[132:135], v[40:43]
    ds_read_b64_tr_b16 v[184:185], v18 offset:32768
    ds_read_b64_tr_b16 v[186:187], v18 offset:36864
    v_mfma_f32_16x16x32_bf16 v[64:67], v[152:155], v[136:139], v[64:67]
    ds_read_b128 v[188:191], v10 offset:2048
    v_mfma_f32_16x16x32_bf16 v[88:91], v[152:155], v[140:143], v[88:91]
    ds_read_b128 v[128:131], v10 offset:4096
    v_mfma_f32_16x16x32_bf16 v[112:115], v[152:155], v[144:147], v[112:115]
    ds_read_b128 v[148:151], v10 offset:6144
    s_waitcnt lgkmcnt(14)
    v_mfma_f32_16x16x32_bf16 v[44:47], v[156:159], v[132:135], v[44:47]
    ds_read_b128 v[152:155], v10 offset:8192
    v_mfma_f32_16x16x32_bf16 v[68:71], v[156:159], v[136:139], v[68:71]
    v_mfma_f32_16x16x32_bf16 v[92:95], v[156:159], v[140:143], v[92:95]
    v_mfma_f32_16x16x32_bf16 v[116:119], v[156:159], v[144:147], v[116:119]
    ds_read_b128 v[156:159], v10 offset:10240
    s_waitcnt lgkmcnt(15)
    v_mfma_f32_16x16x32_bf16 v[48:51], v[160:163], v[132:135], v[48:51]
    v_mfma_f32_16x16x32_bf16 v[72:75], v[160:163], v[136:139], v[72:75]
    v_mfma_f32_16x16x32_bf16 v[96:99], v[160:163], v[140:143], v[96:99]
    v_mfma_f32_16x16x32_bf16 v[120:123], v[160:163], v[144:147], v[120:123]
    s_waitcnt lgkmcnt(14)
    v_mfma_f32_16x16x32_bf16 v[52:55], v[164:167], v[132:135], v[52:55]
    v_mfma_f32_16x16x32_bf16 v[76:79], v[164:167], v[136:139], v[76:79]
    v_mfma_f32_16x16x32_bf16 v[100:103], v[164:167], v[140:143], v[100:103]
    v_mfma_f32_16x16x32_bf16 v[124:127], v[164:167], v[144:147], v[124:127]
    s_waitcnt lgkmcnt(11)
    v_mfma_f32_16x16x32_bf16 v[32:35], v[168:171], v[172:175], v[32:35]
    s_waitcnt lgkmcnt(9)
    v_mfma_f32_16x16x32_bf16 v[56:59], v[168:171], v[176:179], v[56:59]
    s_waitcnt lgkmcnt(7)
    v_mfma_f32_16x16x32_bf16 v[80:83], v[168:171], v[180:183], v[80:83]
    s_waitcnt lgkmcnt(5)
    v_mfma_f32_16x16x32_bf16 v[104:107], v[168:171], v[184:187], v[104:107]
    s_waitcnt lgkmcnt(4)
    v_mfma_f32_16x16x32_bf16 v[36:39], v[188:191], v[172:175], v[36:39]
    v_mfma_f32_16x16x32_bf16 v[60:63], v[188:191], v[176:179], v[60:63]
    v_mfma_f32_16x16x32_bf16 v[84:87], v[188:191], v[180:183], v[84:87]
    v_mfma_f32_16x16x32_bf16 v[108:111], v[188:191], v[184:187], v[108:111]
    s_waitcnt lgkmcnt(3)
    v_mfma_f32_16x16x32_bf16 v[40:43], v[128:131], v[172:175], v[40:43]
    v_mfma_f32_16x16x32_bf16 v[64:67], v[128:131], v[176:179], v[64:67]
    v_mfma_f32_16x16x32_bf16 v[88:91], v[128:131], v[180:183], v[88:91]
    v_mfma_f32_16x16x32_bf16 v[112:115], v[128:131], v[184:187], v[112:115]
    s_waitcnt lgkmcnt(2)
    v_mfma_f32_16x16x32_bf16 v[44:47], v[148:151], v[172:175], v[44:47]
    v_mfma_f32_16x16x32_bf16 v[68:71], v[148:151], v[176:179], v[68:71]
    v_mfma_f32_16x16x32_bf16 v[92:95], v[148:151], v[180:183], v[92:95]
    v_mfma_f32_16x16x32_bf16 v[116:119], v[148:151], v[184:187], v[116:119]
    s_waitcnt lgkmcnt(1)
    v_mfma_f32_16x16x32_bf16 v[48:51], v[152:155], v[172:175], v[48:51]
    v_mfma_f32_16x16x32_bf16 v[72:75], v[152:155], v[176:179], v[72:75]
    v_mfma_f32_16x16x32_bf16 v[96:99], v[152:155], v[180:183], v[96:99]
    v_mfma_f32_16x16x32_bf16 v[120:123], v[152:155], v[184:187], v[120:123]
    s_waitcnt lgkmcnt(0)
    v_mfma_f32_16x16x32_bf16 v[52:55], v[156:159], v[172:175], v[52:55]
    v_mfma_f32_16x16x32_bf16 v[76:79], v[156:159], v[176:179], v[76:79]
    v_mfma_f32_16x16x32_bf16 v[100:103], v[156:159], v[180:183], v[100:103]
    v_mfma_f32_16x16x32_bf16 v[124:127], v[156:159], v[184:187], v[124:127]
    v_add_u32 v9, 0xa000, v9
    v_add_u32 v10, 0xa000, v10
    v_add_u32 v15, 0xa000, v15
    v_add_u32 v16, 0xa000, v16
    v_add_u32 v17, 0xa000, v17
    v_add_u32 v18, 0xa000, v18
    s_barrier
    ds_read_b128 v[128:131], v9 offset:0
    ds_read_b64_tr_b16 v[132:133], v15 offset:24576
    ds_read_b64_tr_b16 v[134:135], v15 offset:28672
    ds_read_b64_tr_b16 v[136:137], v16 offset:24576
    ds_read_b64_tr_b16 v[138:139], v16 offset:28672
    ds_read_b64_tr_b16 v[140:141], v17 offset:24576
    ds_read_b64_tr_b16 v[142:143], v17 offset:28672
    ds_read_b64_tr_b16 v[144:145], v18 offset:24576
    ds_read_b64_tr_b16 v[146:147], v18 offset:28672
    ds_read_b128 v[148:151], v9 offset:2048
    s_waitcnt lgkmcnt(7)
    v_mfma_f32_16x16x32_bf16 v[32:35], v[128:131], v[132:135], v[32:35]
    ds_read_b128 v[152:155], v9 offset:4096
    s_waitcnt lgkmcnt(6)
    v_mfma_f32_16x16x32_bf16 v[56:59], v[128:131], v[136:139], v[56:59]
    ds_read_b128 v[156:159], v9 offset:6144
    s_waitcnt lgkmcnt(5)
    v_mfma_f32_16x16x32_bf16 v[80:83], v[128:131], v[140:143], v[80:83]
    ds_read_b128 v[160:163], v9 offset:8192
    s_waitcnt lgkmcnt(4)
    v_mfma_f32_16x16x32_bf16 v[104:107], v[128:131], v[144:147], v[104:107]
    ds_read_b128 v[164:167], v9 offset:10240
    s_waitcnt lgkmcnt(4)
    v_mfma_f32_16x16x32_bf16 v[36:39], v[148:151], v[132:135], v[36:39]
    ds_read_b128 v[168:171], v10 offset:0
    v_mfma_f32_16x16x32_bf16 v[60:63], v[148:151], v[136:139], v[60:63]
    ds_read_b64_tr_b16 v[172:173], v15 offset:32768
    ds_read_b64_tr_b16 v[174:175], v15 offset:36864
    v_mfma_f32_16x16x32_bf16 v[84:87], v[148:151], v[140:143], v[84:87]
    ds_read_b64_tr_b16 v[176:177], v16 offset:32768
    ds_read_b64_tr_b16 v[178:179], v16 offset:36864
    v_mfma_f32_16x16x32_bf16 v[108:111], v[148:151], v[144:147], v[108:111]
    ds_read_b64_tr_b16 v[180:181], v17 offset:32768
    ds_read_b64_tr_b16 v[182:183], v17 offset:36864
    s_waitcnt lgkmcnt(10)
    v_mfma_f32_16x16x32_bf16 v[40:43], v[152:155], v[132:135], v[40:43]
    ds_read_b64_tr_b16 v[184:185], v18 offset:32768
    ds_read_b64_tr_b16 v[186:187], v18 offset:36864
    v_mfma_f32_16x16x32_bf16 v[64:67], v[152:155], v[136:139], v[64:67]
    ds_read_b128 v[188:191], v10 offset:2048
    v_mfma_f32_16x16x32_bf16 v[88:91], v[152:155], v[140:143], v[88:91]
    ds_read_b128 v[128:131], v10 offset:4096
    v_mfma_f32_16x16x32_bf16 v[112:115], v[152:155], v[144:147], v[112:115]
    ds_read_b128 v[148:151], v10 offset:6144
    s_waitcnt lgkmcnt(14)
    v_mfma_f32_16x16x32_bf16 v[44:47], v[156:159], v[132:135], v[44:47]
    ds_read_b128 v[152:155], v10 offset:8192
    v_mfma_f32_16x16x32_bf16 v[68:71], v[156:159], v[136:139], v[68:71]
    v_mfma_f32_16x16x32_bf16 v[92:95], v[156:159], v[140:143], v[92:95]
    v_mfma_f32_16x16x32_bf16 v[116:119], v[156:159], v[144:147], v[116:119]
    ds_read_b128 v[156:159], v10 offset:10240
    s_waitcnt lgkmcnt(15)
    v_mfma_f32_16x16x32_bf16 v[48:51], v[160:163], v[132:135], v[48:51]
    v_mfma_f32_16x16x32_bf16 v[72:75], v[160:163], v[136:139], v[72:75]
    v_mfma_f32_16x16x32_bf16 v[96:99], v[160:163], v[140:143], v[96:99]
    v_mfma_f32_16x16x32_bf16 v[120:123], v[160:163], v[144:147], v[120:123]
    s_waitcnt lgkmcnt(14)
    v_mfma_f32_16x16x32_bf16 v[52:55], v[164:167], v[132:135], v[52:55]
    v_mfma_f32_16x16x32_bf16 v[76:79], v[164:167], v[136:139], v[76:79]
    v_mfma_f32_16x16x32_bf16 v[100:103], v[164:167], v[140:143], v[100:103]
    v_mfma_f32_16x16x32_bf16 v[124:127], v[164:167], v[144:147], v[124:127]
    s_waitcnt lgkmcnt(11)
    v_mfma_f32_16x16x32_bf16 v[32:35], v[168:171], v[172:175], v[32:35]
    s_waitcnt lgkmcnt(9)
    v_mfma_f32_16x16x32_bf16 v[56:59], v[168:171], v[176:179], v[56:59]
    s_waitcnt lgkmcnt(7)
    v_mfma_f32_16x16x32_bf16 v[80:83], v[168:171], v[180:183], v[80:83]
    s_waitcnt lgkmcnt(5)
    v_mfma_f32_16x16x32_bf16 v[104:107], v[168:171], v[184:187], v[104:107]
    s_waitcnt lgkmcnt(4)
    v_mfma_f32_16x16x32_bf16 v[36:39], v[188:191], v[172:175], v[36:39]
    v_mfma_f32_16x16x32_bf16 v[60:63], v[188:191], v[176:179], v[60:63]
    v_mfma_f32_16x16x32_bf16 v[84:87], v[188:191], v[180:183], v[84:87]
    v_mfma_f32_16x16x32_bf16 v[108:111], v[188:191], v[184:187], v[108:111]
    s_waitcnt lgkmcnt(3)
    v_mfma_f32_16x16x32_bf16 v[40:43], v[128:131], v[172:175], v[40:43]
    v_mfma_f32_16x16x32_bf16 v[64:67], v[128:131], v[176:179], v[64:67]
    v_mfma_f32_16x16x32_bf16 v[88:91], v[128:131], v[180:183], v[88:91]
    v_mfma_f32_16x16x32_bf16 v[112:115], v[128:131], v[184:187], v[112:115]
    s_waitcnt lgkmcnt(2)
    v_mfma_f32_16x16x32_bf16 v[44:47], v[148:151], v[172:175], v[44:47]
    v_mfma_f32_16x16x32_bf16 v[68:71], v[148:151], v[176:179], v[68:71]
    v_mfma_f32_16x16x32_bf16 v[92:95], v[148:151], v[180:183], v[92:95]
    v_mfma_f32_16x16x32_bf16 v[116:119], v[148:151], v[184:187], v[116:119]
    s_waitcnt lgkmcnt(1)
    v_mfma_f32_16x16x32_bf16 v[48:51], v[152:155], v[172:175], v[48:51]
    v_mfma_f32_16x16x32_bf16 v[72:75], v[152:155], v[176:179], v[72:75]
    v_mfma_f32_16x16x32_bf16 v[96:99], v[152:155], v[180:183], v[96:99]
    v_mfma_f32_16x16x32_bf16 v[120:123], v[152:155], v[184:187], v[120:123]
    s_waitcnt lgkmcnt(0)
    v_mfma_f32_16x16x32_bf16 v[52:55], v[156:159], v[172:175], v[52:55]
    v_mfma_f32_16x16x32_bf16 v[76:79], v[156:159], v[176:179], v[76:79]
    v_mfma_f32_16x16x32_bf16 v[100:103], v[156:159], v[180:183], v[100:103]
    v_mfma_f32_16x16x32_bf16 v[124:127], v[156:159], v[184:187], v[124:127]
    v_add_u32 v9, 0xfffe2000, v9
    v_add_u32 v10, 0xfffe2000, v10
    v_add_u32 v15, 0xfffe2000, v15
    v_add_u32 v16, 0xfffe2000, v16
    v_add_u32 v17, 0xfffe2000, v17
    v_add_u32 v18, 0xfffe2000, v18
    s_barrier
    ds_read_b128 v[128:131], v9 offset:0
    ds_read_b64_tr_b16 v[132:133], v15 offset:24576
    ds_read_b64_tr_b16 v[134:135], v15 offset:28672
    ds_read_b64_tr_b16 v[136:137], v16 offset:24576
    ds_read_b64_tr_b16 v[138:139], v16 offset:28672
    ds_read_b64_tr_b16 v[140:141], v17 offset:24576
    ds_read_b64_tr_b16 v[142:143], v17 offset:28672
    ds_read_b64_tr_b16 v[144:145], v18 offset:24576
    ds_read_b64_tr_b16 v[146:147], v18 offset:28672
    ds_read_b128 v[148:151], v9 offset:2048
    s_waitcnt lgkmcnt(7)
    v_mfma_f32_16x16x32_bf16 v[32:35], v[128:131], v[132:135], v[32:35]
    ds_read_b128 v[152:155], v9 offset:4096
    s_waitcnt lgkmcnt(6)
    v_mfma_f32_16x16x32_bf16 v[56:59], v[128:131], v[136:139], v[56:59]
    ds_read_b128 v[156:159], v9 offset:6144
    s_waitcnt lgkmcnt(5)
    v_mfma_f32_16x16x32_bf16 v[80:83], v[128:131], v[140:143], v[80:83]
    ds_read_b128 v[160:163], v9 offset:8192
    s_waitcnt lgkmcnt(4)
    v_mfma_f32_16x16x32_bf16 v[104:107], v[128:131], v[144:147], v[104:107]
    ds_read_b128 v[164:167], v9 offset:10240
    s_waitcnt lgkmcnt(4)
    v_mfma_f32_16x16x32_bf16 v[36:39], v[148:151], v[132:135], v[36:39]
    ds_read_b128 v[168:171], v10 offset:0
    v_mfma_f32_16x16x32_bf16 v[60:63], v[148:151], v[136:139], v[60:63]
    ds_read_b64_tr_b16 v[172:173], v15 offset:32768
    ds_read_b64_tr_b16 v[174:175], v15 offset:36864
    v_mfma_f32_16x16x32_bf16 v[84:87], v[148:151], v[140:143], v[84:87]
    ds_read_b64_tr_b16 v[176:177], v16 offset:32768
    ds_read_b64_tr_b16 v[178:179], v16 offset:36864
    v_mfma_f32_16x16x32_bf16 v[108:111], v[148:151], v[144:147], v[108:111]
    ds_read_b64_tr_b16 v[180:181], v17 offset:32768
    ds_read_b64_tr_b16 v[182:183], v17 offset:36864
    s_waitcnt lgkmcnt(10)
    v_mfma_f32_16x16x32_bf16 v[40:43], v[152:155], v[132:135], v[40:43]
    ds_read_b64_tr_b16 v[184:185], v18 offset:32768
    ds_read_b64_tr_b16 v[186:187], v18 offset:36864
    v_mfma_f32_16x16x32_bf16 v[64:67], v[152:155], v[136:139], v[64:67]
    ds_read_b128 v[188:191], v10 offset:2048
    v_mfma_f32_16x16x32_bf16 v[88:91], v[152:155], v[140:143], v[88:91]
    ds_read_b128 v[128:131], v10 offset:4096
    v_mfma_f32_16x16x32_bf16 v[112:115], v[152:155], v[144:147], v[112:115]
    ds_read_b128 v[148:151], v10 offset:6144
    s_waitcnt lgkmcnt(14)
    v_mfma_f32_16x16x32_bf16 v[44:47], v[156:159], v[132:135], v[44:47]
    ds_read_b128 v[152:155], v10 offset:8192
    v_mfma_f32_16x16x32_bf16 v[68:71], v[156:159], v[136:139], v[68:71]
    v_mfma_f32_16x16x32_bf16 v[92:95], v[156:159], v[140:143], v[92:95]
    v_mfma_f32_16x16x32_bf16 v[116:119], v[156:159], v[144:147], v[116:119]
    ds_read_b128 v[156:159], v10 offset:10240
    s_waitcnt lgkmcnt(15)
    v_mfma_f32_16x16x32_bf16 v[48:51], v[160:163], v[132:135], v[48:51]
    v_mfma_f32_16x16x32_bf16 v[72:75], v[160:163], v[136:139], v[72:75]
    v_mfma_f32_16x16x32_bf16 v[96:99], v[160:163], v[140:143], v[96:99]
    v_mfma_f32_16x16x32_bf16 v[120:123], v[160:163], v[144:147], v[120:123]
    s_waitcnt lgkmcnt(14)
    v_mfma_f32_16x16x32_bf16 v[52:55], v[164:167], v[132:135], v[52:55]
    v_mfma_f32_16x16x32_bf16 v[76:79], v[164:167], v[136:139], v[76:79]
    v_mfma_f32_16x16x32_bf16 v[100:103], v[164:167], v[140:143], v[100:103]
    v_mfma_f32_16x16x32_bf16 v[124:127], v[164:167], v[144:147], v[124:127]
    s_waitcnt lgkmcnt(11)
    v_mfma_f32_16x16x32_bf16 v[32:35], v[168:171], v[172:175], v[32:35]
    s_waitcnt lgkmcnt(9)
    v_mfma_f32_16x16x32_bf16 v[56:59], v[168:171], v[176:179], v[56:59]
    s_waitcnt lgkmcnt(7)
    v_mfma_f32_16x16x32_bf16 v[80:83], v[168:171], v[180:183], v[80:83]
    s_waitcnt lgkmcnt(5)
    v_mfma_f32_16x16x32_bf16 v[104:107], v[168:171], v[184:187], v[104:107]
    s_waitcnt lgkmcnt(4)
    v_mfma_f32_16x16x32_bf16 v[36:39], v[188:191], v[172:175], v[36:39]
    v_mfma_f32_16x16x32_bf16 v[60:63], v[188:191], v[176:179], v[60:63]
    v_mfma_f32_16x16x32_bf16 v[84:87], v[188:191], v[180:183], v[84:87]
    v_mfma_f32_16x16x32_bf16 v[108:111], v[188:191], v[184:187], v[108:111]
    s_waitcnt lgkmcnt(3)
    v_mfma_f32_16x16x32_bf16 v[40:43], v[128:131], v[172:175], v[40:43]
    v_mfma_f32_16x16x32_bf16 v[64:67], v[128:131], v[176:179], v[64:67]
    v_mfma_f32_16x16x32_bf16 v[88:91], v[128:131], v[180:183], v[88:91]
    v_mfma_f32_16x16x32_bf16 v[112:115], v[128:131], v[184:187], v[112:115]
    s_waitcnt lgkmcnt(2)
    v_mfma_f32_16x16x32_bf16 v[44:47], v[148:151], v[172:175], v[44:47]
    v_mfma_f32_16x16x32_bf16 v[68:71], v[148:151], v[176:179], v[68:71]
    v_mfma_f32_16x16x32_bf16 v[92:95], v[148:151], v[180:183], v[92:95]
    v_mfma_f32_16x16x32_bf16 v[116:119], v[148:151], v[184:187], v[116:119]
    s_waitcnt lgkmcnt(1)
    v_mfma_f32_16x16x32_bf16 v[48:51], v[152:155], v[172:175], v[48:51]
    v_mfma_f32_16x16x32_bf16 v[72:75], v[152:155], v[176:179], v[72:75]
    v_mfma_f32_16x16x32_bf16 v[96:99], v[152:155], v[180:183], v[96:99]
    v_mfma_f32_16x16x32_bf16 v[120:123], v[152:155], v[184:187], v[120:123]
    s_waitcnt lgkmcnt(0)
    v_mfma_f32_16x16x32_bf16 v[52:55], v[156:159], v[172:175], v[52:55]
    v_mfma_f32_16x16x32_bf16 v[76:79], v[156:159], v[176:179], v[76:79]
    v_mfma_f32_16x16x32_bf16 v[100:103], v[156:159], v[180:183], v[100:103]
    v_mfma_f32_16x16x32_bf16 v[124:127], v[156:159], v[184:187], v[124:127]
    v_add_u32 v9, 0xa000, v9
    v_add_u32 v10, 0xa000, v10
    v_add_u32 v15, 0xa000, v15
    v_add_u32 v16, 0xa000, v16
    v_add_u32 v17, 0xa000, v17
    v_add_u32 v18, 0xa000, v18
    s_barrier
    ds_read_b128 v[128:131], v9 offset:0
    ds_read_b64_tr_b16 v[132:133], v15 offset:24576
    ds_read_b64_tr_b16 v[134:135], v15 offset:28672
    ds_read_b64_tr_b16 v[136:137], v16 offset:24576
    ds_read_b64_tr_b16 v[138:139], v16 offset:28672
    ds_read_b64_tr_b16 v[140:141], v17 offset:24576
    ds_read_b64_tr_b16 v[142:143], v17 offset:28672
    ds_read_b64_tr_b16 v[144:145], v18 offset:24576
    ds_read_b64_tr_b16 v[146:147], v18 offset:28672
    ds_read_b128 v[148:151], v9 offset:2048
    s_waitcnt lgkmcnt(7)
    v_mfma_f32_16x16x32_bf16 v[32:35], v[128:131], v[132:135], v[32:35]
    ds_read_b128 v[152:155], v9 offset:4096
    s_waitcnt lgkmcnt(6)
    v_mfma_f32_16x16x32_bf16 v[56:59], v[128:131], v[136:139], v[56:59]
    ds_read_b128 v[156:159], v9 offset:6144
    s_waitcnt lgkmcnt(5)
    v_mfma_f32_16x16x32_bf16 v[80:83], v[128:131], v[140:143], v[80:83]
    ds_read_b128 v[160:163], v9 offset:8192
    s_waitcnt lgkmcnt(4)
    v_mfma_f32_16x16x32_bf16 v[104:107], v[128:131], v[144:147], v[104:107]
    ds_read_b128 v[164:167], v9 offset:10240
    s_waitcnt lgkmcnt(4)
    v_mfma_f32_16x16x32_bf16 v[36:39], v[148:151], v[132:135], v[36:39]
    ds_read_b128 v[168:171], v10 offset:0
    v_mfma_f32_16x16x32_bf16 v[60:63], v[148:151], v[136:139], v[60:63]
    ds_read_b64_tr_b16 v[172:173], v15 offset:32768
    ds_read_b64_tr_b16 v[174:175], v15 offset:36864
    v_mfma_f32_16x16x32_bf16 v[84:87], v[148:151], v[140:143], v[84:87]
    ds_read_b64_tr_b16 v[176:177], v16 offset:32768
    ds_read_b64_tr_b16 v[178:179], v16 offset:36864
    v_mfma_f32_16x16x32_bf16 v[108:111], v[148:151], v[144:147], v[108:111]
    ds_read_b64_tr_b16 v[180:181], v17 offset:32768
    ds_read_b64_tr_b16 v[182:183], v17 offset:36864
    s_waitcnt lgkmcnt(10)
    v_mfma_f32_16x16x32_bf16 v[40:43], v[152:155], v[132:135], v[40:43]
    ds_read_b64_tr_b16 v[184:185], v18 offset:32768
    ds_read_b64_tr_b16 v[186:187], v18 offset:36864
    v_mfma_f32_16x16x32_bf16 v[64:67], v[152:155], v[136:139], v[64:67]
    ds_read_b128 v[188:191], v10 offset:2048
    v_mfma_f32_16x16x32_bf16 v[88:91], v[152:155], v[140:143], v[88:91]
    ds_read_b128 v[128:131], v10 offset:4096
    v_mfma_f32_16x16x32_bf16 v[112:115], v[152:155], v[144:147], v[112:115]
    ds_read_b128 v[148:151], v10 offset:6144
    s_waitcnt lgkmcnt(14)
    v_mfma_f32_16x16x32_bf16 v[44:47], v[156:159], v[132:135], v[44:47]
    ds_read_b128 v[152:155], v10 offset:8192
    v_mfma_f32_16x16x32_bf16 v[68:71], v[156:159], v[136:139], v[68:71]
    v_mfma_f32_16x16x32_bf16 v[92:95], v[156:159], v[140:143], v[92:95]
    v_mfma_f32_16x16x32_bf16 v[116:119], v[156:159], v[144:147], v[116:119]
    ds_read_b128 v[156:159], v10 offset:10240
    s_waitcnt lgkmcnt(15)
    v_mfma_f32_16x16x32_bf16 v[48:51], v[160:163], v[132:135], v[48:51]
    v_mfma_f32_16x16x32_bf16 v[72:75], v[160:163], v[136:139], v[72:75]
    v_mfma_f32_16x16x32_bf16 v[96:99], v[160:163], v[140:143], v[96:99]
    v_mfma_f32_16x16x32_bf16 v[120:123], v[160:163], v[144:147], v[120:123]
    s_waitcnt lgkmcnt(14)
    v_mfma_f32_16x16x32_bf16 v[52:55], v[164:167], v[132:135], v[52:55]
    v_mfma_f32_16x16x32_bf16 v[76:79], v[164:167], v[136:139], v[76:79]
    v_mfma_f32_16x16x32_bf16 v[100:103], v[164:167], v[140:143], v[100:103]
    v_mfma_f32_16x16x32_bf16 v[124:127], v[164:167], v[144:147], v[124:127]
    s_waitcnt lgkmcnt(11)
    v_mfma_f32_16x16x32_bf16 v[32:35], v[168:171], v[172:175], v[32:35]
    s_waitcnt lgkmcnt(9)
    v_mfma_f32_16x16x32_bf16 v[56:59], v[168:171], v[176:179], v[56:59]
    s_waitcnt lgkmcnt(7)
    v_mfma_f32_16x16x32_bf16 v[80:83], v[168:171], v[180:183], v[80:83]
    s_waitcnt lgkmcnt(5)
    v_mfma_f32_16x16x32_bf16 v[104:107], v[168:171], v[184:187], v[104:107]
    s_waitcnt lgkmcnt(4)
    v_mfma_f32_16x16x32_bf16 v[36:39], v[188:191], v[172:175], v[36:39]
    v_mfma_f32_16x16x32_bf16 v[60:63], v[188:191], v[176:179], v[60:63]
    v_mfma_f32_16x16x32_bf16 v[84:87], v[188:191], v[180:183], v[84:87]
    v_mfma_f32_16x16x32_bf16 v[108:111], v[188:191], v[184:187], v[108:111]
    s_waitcnt lgkmcnt(3)
    v_mfma_f32_16x16x32_bf16 v[40:43], v[128:131], v[172:175], v[40:43]
    v_mfma_f32_16x16x32_bf16 v[64:67], v[128:131], v[176:179], v[64:67]
    v_mfma_f32_16x16x32_bf16 v[88:91], v[128:131], v[180:183], v[88:91]
    v_mfma_f32_16x16x32_bf16 v[112:115], v[128:131], v[184:187], v[112:115]
    s_waitcnt lgkmcnt(2)
    v_mfma_f32_16x16x32_bf16 v[44:47], v[148:151], v[172:175], v[44:47]
    v_mfma_f32_16x16x32_bf16 v[68:71], v[148:151], v[176:179], v[68:71]
    v_mfma_f32_16x16x32_bf16 v[92:95], v[148:151], v[180:183], v[92:95]
    v_mfma_f32_16x16x32_bf16 v[116:119], v[148:151], v[184:187], v[116:119]
    s_waitcnt lgkmcnt(1)
    v_mfma_f32_16x16x32_bf16 v[48:51], v[152:155], v[172:175], v[48:51]
    v_mfma_f32_16x16x32_bf16 v[72:75], v[152:155], v[176:179], v[72:75]
    v_mfma_f32_16x16x32_bf16 v[96:99], v[152:155], v[180:183], v[96:99]
    v_mfma_f32_16x16x32_bf16 v[120:123], v[152:155], v[184:187], v[120:123]
    s_waitcnt lgkmcnt(0)
    v_mfma_f32_16x16x32_bf16 v[52:55], v[156:159], v[172:175], v[52:55]
    v_mfma_f32_16x16x32_bf16 v[76:79], v[156:159], v[176:179], v[76:79]
    v_mfma_f32_16x16x32_bf16 v[100:103], v[156:159], v[180:183], v[100:103]
    v_mfma_f32_16x16x32_bf16 v[124:127], v[156:159], v[184:187], v[124:127]
    v_add_u32 v9, 0xa000, v9
    v_add_u32 v10, 0xa000, v10
    v_add_u32 v15, 0xa000, v15
    v_add_u32 v16, 0xa000, v16
    v_add_u32 v17, 0xa000, v17
    v_add_u32 v18, 0xa000, v18
    v_add_u32 v9, 0xfffec000, v9
    v_add_u32 v10, 0xfffec000, v10
    v_add_u32 v15, 0xfffec000, v15
    v_add_u32 v16, 0xfffec000, v16
    v_add_u32 v17, 0xfffec000, v17
    v_add_u32 v18, 0xfffec000, v18
    s_lshl_b32 s42, s30, 2
    s_add_u32 s42, s42, s6
    s_mul_i32 s42, s42, 12288
    v_and_b32 v2, 63, v0
    v_lshlrev_b32 v2, 4, v2
    s_nop 7
    v_cvt_pk_bf16_f32 v32, v32, v33
    v_cvt_pk_bf16_f32 v33, v34, v35
    v_cvt_pk_bf16_f32 v34, v36, v37
    v_cvt_pk_bf16_f32 v35, v38, v39
    buffer_store_dwordx4 v[32:35], v2, s[16:19], s42 offen offset:0
    v_cvt_pk_bf16_f32 v40, v40, v41
    v_cvt_pk_bf16_f32 v41, v42, v43
    v_cvt_pk_bf16_f32 v42, v44, v45
    v_cvt_pk_bf16_f32 v43, v46, v47
    buffer_store_dwordx4 v[40:43], v2, s[16:19], s42 offen offset:1024
    v_cvt_pk_bf16_f32 v48, v48, v49
    v_cvt_pk_bf16_f32 v49, v50, v51
    v_cvt_pk_bf16_f32 v50, v52, v53
    v_cvt_pk_bf16_f32 v51, v54, v55
    buffer_store_dwordx4 v[48:51], v2, s[16:19], s42 offen offset:2048
    v_cvt_pk_bf16_f32 v56, v56, v57
    v_cvt_pk_bf16_f32 v57, v58, v59
    v_cvt_pk_bf16_f32 v58, v60, v61
    v_cvt_pk_bf16_f32 v59, v62, v63
    buffer_store_dwordx4 v[56:59], v2, s[16:19], s42 offen offset:3072
    s_add_u32 s42, s42, 4096
    v_cvt_pk_bf16_f32 v64, v64, v65
    v_cvt_pk_bf16_f32 v65, v66, v67
    v_cvt_pk_bf16_f32 v66, v68, v69
    v_cvt_pk_bf16_f32 v67, v70, v71
    buffer_store_dwordx4 v[64:67], v2, s[16:19], s42 offen offset:0
    v_cvt_pk_bf16_f32 v72, v72, v73
    v_cvt_pk_bf16_f32 v73, v74, v75
    v_cvt_pk_bf16_f32 v74, v76, v77
    v_cvt_pk_bf16_f32 v75, v78, v79
    buffer_store_dwordx4 v[72:75], v2, s[16:19], s42 offen offset:1024
    v_cvt_pk_bf16_f32 v80, v80, v81
    v_cvt_pk_bf16_f32 v81, v82, v83
    v_cvt_pk_bf16_f32 v82, v84, v85
    v_cvt_pk_bf16_f32 v83, v86, v87
    buffer_store_dwordx4 v[80:83], v2, s[16:19], s42 offen offset:2048
    v_cvt_pk_bf16_f32 v88, v88, v89
    v_cvt_pk_bf16_f32 v89, v90, v91
    v_cvt_pk_bf16_f32 v90, v92, v93
    v_cvt_pk_bf16_f32 v91, v94, v95
    buffer_store_dwordx4 v[88:91], v2, s[16:19], s42 offen offset:3072
    s_add_u32 s42, s42, 4096
    v_cvt_pk_bf16_f32 v96, v96, v97
    v_cvt_pk_bf16_f32 v97, v98, v99
    v_cvt_pk_bf16_f32 v98, v100, v101
    v_cvt_pk_bf16_f32 v99, v102, v103
    buffer_store_dwordx4 v[96:99], v2, s[16:19], s42 offen offset:0
    v_cvt_pk_bf16_f32 v104, v104, v105
    v_cvt_pk_bf16_f32 v105, v106, v107
    v_cvt_pk_bf16_f32 v106, v108, v109
    v_cvt_pk_bf16_f32 v107, v110, v111
    buffer_store_dwordx4 v[104:107], v2, s[16:19], s42 offen offset:1024
    v_cvt_pk_bf16_f32 v112, v112, v113
    v_cvt_pk_bf16_f32 v113, v114, v115
    v_cvt_pk_bf16_f32 v114, v116, v117
    v_cvt_pk_bf16_f32 v115, v118, v119
    buffer_store_dwordx4 v[112:115], v2, s[16:19], s42 offen offset:2048
    v_cvt_pk_bf16_f32 v120, v120, v121
    v_cvt_pk_bf16_f32 v121, v122, v123
    v_cvt_pk_bf16_f32 v122, v124, v125
    v_cvt_pk_bf16_f32 v123, v126, v127
    buffer_store_dwordx4 v[120:123], v2, s[16:19], s42 offen offset:3072
    s_add_u32 s42, s42, 4096
    s_endpgm
.globl fin_kernel
.p2align 8
.type fin_kernel,@function
fin_kernel:
    s_cmp_lt_u32 s2, 576
    s_cbranch_scc1 go_24
    s_endpgm
go_24:
    s_load_dwordx2 s[4:5], s[0:1], 112
    s_load_dwordx2 s[24:25], s[0:1], 88
    s_mov_b32 s26, 4096
    s_mov_b32 s27, 0x00020000
    s_load_dwordx2 s[20:21], s[0:1], 96
    s_mov_b32 s22, 2359296
    s_mov_b32 s23, 0x00020000
    v_lshrrev_b32 v1, 6, v0
    s_nop 0
    v_readfirstlane_b32 s6, v1
    s_lshl_b32 s7, s6, 10
    s_waitcnt lgkmcnt(0)
    s_add_u32 s8, s4, 138637312
    s_addc_u32 s9, s5, 0
    s_mov_b32 s10, 18874368
    s_mov_b32 s11, 0x00020000
    s_add_u32 s16, s4, 109735936
    s_addc_u32 s17, s5, 0
    s_mov_b32 s18, 2359296
    s_mov_b32 s19, 0x00020000
    s_lshl_b32 s29, s2, 2
    s_add_u32 s29, s29, s6
    s_lshl_b32 s42, s29, 10
    v_and_b32 v1, 63, v0
    v_lshlrev_b32 v1, 4, v1
    buffer_load_dwordx4 v[16:19], v1, s[8:11], s42 offen
    s_add_u32 s42, s42, 2359296
    buffer_load_dwordx4 v[20:23], v1, s[8:11], s42 offen
    s_add_u32 s42, s42, 2359296
    buffer_load_dwordx4 v[24:27], v1, s[8:11], s42 offen
    s_add_u32 s42, s42, 2359296
    buffer_load_dwordx4 v[28:31], v1, s[8:11], s42 offen
    s_add_u32 s42, s42, 2359296
    s_mul_i32 s30, s29, 21846
    s_lshr_b32 s30, s30, 16
    s_mul_i32 s35, s30, 3
    s_sub_u32 s35, s29, s35
    s_lshr_b32 s34, s30, 4
    s_mul_i32 s31, s34, 21846
    s_lshr_b32 s31, s31, 16
    s_mul_i32 s32, s31, 3
    s_sub_u32 s32, s34, s32
    s_lshl_b32 s31, s31, 3
    s_bfe_u32 s33, s30, 0x10003
    s_lshl_b32 s33, s33, 2
    s_add_u32 s31, s31, s33
    s_and_b32 s33, s30, 3
    s_add_u32 s31, s31, s33
    s_lshl_b32 s31, s31, 4
    s_lshl_b32 s32, s32, 1
    s_bfe_u32 s33, s30, 0x10002
    s_add_u32 s32, s32, s33
    s_mul_i32 s32, s32, 3
    s_add_u32 s32, s32, s35
    s_lshl_b32 s43, s32, 6
    v_and_b32 v2, 15, v0
    v_bfe_u32 v3, v0, 4, 2
    v_add_u32 v4, s31, v2
    v_mul_u32_u24 v5, 1152, v4
    v_lshl_add_u32 v5, v3, 3, v5
    v_lshlrev_b32 v4, 1, v4
    buffer_load_dwordx2 v[32:33], v5, s[16:19], s43 offen offset:0
    buffer_load_dwordx2 v[34:35], v5, s[16:19], s43 offen offset:32
    buffer_load_ushort v6, v4, s[24:27], 0 offen
    s_waitcnt vmcnt(0)
    v_lshlrev_b32 v6, 16, v6
    v_lshlrev_b32 v40, 16, v16
    v_and_b32 v41, 0xffff0000, v16
    v_lshlrev_b32 v42, 16, v17
    v_and_b32 v43, 0xffff0000, v17
    v_lshlrev_b32 v44, 16, v18
    v_and_b32 v45, 0xffff0000, v18
    v_lshlrev_b32 v46, 16, v19
    v_and_b32 v47, 0xffff0000, v19
    v_add_f32 v8, v6, v40
    v_add_f32 v9, v6, v41
    v_add_f32 v10, v6, v42
    v_add_f32 v11, v6, v43
    v_add_f32 v12, v6, v44
    v_add_f32 v13, v6, v45
    v_add_f32 v14, v6, v46
    v_add_f32 v15, v6, v47
    v_lshlrev_b32 v40, 16, v20
    v_and_b32 v41, 0xffff0000, v20
    v_lshlrev_b32 v42, 16, v21
    v_and_b32 v43, 0xffff0000, v21
    v_lshlrev_b32 v44, 16, v22
    v_and_b32 v45, 0xffff0000, v22
    v_lshlrev_b32 v46, 16, v23
    v_and_b32 v47, 0xffff0000, v23
    v_add_f32 v8, v8, v40
    v_add_f32 v9, v9, v41
    v_add_f32 v10, v10, v42
    v_add_f32 v11, v11, v43
    v_add_f32 v12, v12, v44
    v_add_f32 v13, v13, v45
    v_add_f32 v14, v14, v46
    v_add_f32 v15, v15, v47
    v_lshlrev_b32 v40, 16, v24
    v_and_b32 v41, 0xffff0000, v24
    v_lshlrev_b32 v42, 16, v25
    v_and_b32 v43, 0xffff0000, v25
    v_lshlrev_b32 v44, 16, v26
    v_and_b32 v45, 0xffff0000, v26
    v_lshlrev_b32 v46, 16, v27
    v_and_b32 v47, 0xffff0000, v27
    v_add_f32 v8, v8, v40
    v_add_f32 v9, v9, v41
    v_add_f32 v10, v10, v42
    v_add_f32 v11, v11, v43
    v_add_f32 v12, v12, v44
    v_add_f32 v13, v13, v45
    v_add_f32 v14, v14, v46
    v_add_f32 v15, v15, v47
    v_lshlrev_b32 v40, 16, v28
    v_and_b32 v41, 0xffff0000, v28
    v_lshlrev_b32 v42, 16, v29
    v_and_b32 v43, 0xffff0000, v29
    v_lshlrev_b32 v44, 16, v30
    v_and_b32 v45, 0xffff0000, v30
    v_lshlrev_b32 v46, 16, v31
    v_and_b32 v47, 0xffff0000, v31
    v_add_f32 v8, v8, v40
    v_add_f32 v9, v9, v41
    v_add_f32 v10, v10, v42
    v_add_f32 v11, v11, v43
    v_add_f32 v12, v12, v44
    v_add_f32 v13, v13, v45
    v_add_f32 v14, v14, v46
    v_add_f32 v15, v15, v47
    v_lshlrev_b32 v40, 16, v32
    v_and_b32 v41, 0xffff0000, v32
    v_lshlrev_b32 v42, 16, v33
    v_and_b32 v43, 0xffff0000, v33
    v_lshlrev_b32 v44, 16, v34
    v_and_b32 v45, 0xffff0000, v34
    v_lshlrev_b32 v46, 16, v35
    v_and_b32 v47, 0xffff0000, v35
    v_add_f32 v8, v8, v40
    v_add_f32 v9, v9, v41
    v_add_f32 v10, v10, v42
    v_add_f32 v11, v11, v43
    v_add_f32 v12, v12, v44
    v_add_f32 v13, v13, v45
    v_add_f32 v14, v14, v46
    v_add_f32 v15, v15, v47
    v_cvt_pk_bf16_f32 v8, v8, v9
    v_cvt_pk_bf16_f32 v9, v10, v11
    v_cvt_pk_bf16_f32 v10, v12, v13
    v_cvt_pk_bf16_f32 v11, v14, v15
    buffer_store_dwordx2 v[8:9], v5, s[20:23], s43 offen offset:0
    buffer_store_dwordx2 v[10:11], v5, s[20:23], s43 offen offset:32
    s_endpgm
.section .rodata,"a"
.p2align 6
.amdhsa_kernel init_kernel
  .amdhsa_next_free_vgpr 56
  .amdhsa_next_free_sgpr 102
  .amdhsa_accum_offset 56
  .amdhsa_group_segment_fixed_size 0
  .amdhsa_kernarg_size 120
  .amdhsa_user_sgpr_count 2
  .amdhsa_user_sgpr_kernarg_segment_ptr 1
  .amdhsa_system_sgpr_workgroup_id_x 1
.end_amdhsa_kernel
.p2align 6
.amdhsa_kernel main_kernel
  .amdhsa_next_free_vgpr 512
  .amdhsa_next_free_sgpr 102
  .amdhsa_accum_offset 256
  .amdhsa_group_segment_fixed_size 0
  .amdhsa_kernarg_size 120
  .amdhsa_user_sgpr_count 2
  .amdhsa_user_sgpr_kernarg_segment_ptr 1
  .amdhsa_system_sgpr_workgroup_id_x 1
.end_amdhsa_kernel
.p2align 6
.amdhsa_kernel mlp2_kernel
  .amdhsa_next_free_vgpr 192
  .amdhsa_next_free_sgpr 102
  .amdhsa_accum_offset 192
  .amdhsa_group_segment_fixed_size 0
  .amdhsa_kernarg_size 120
  .amdhsa_user_sgpr_count 2
  .amdhsa_user_sgpr_kernarg_segment_ptr 1
  .amdhsa_system_sgpr_workgroup_id_x 1
.end_amdhsa_kernel
.p2align 6
.amdhsa_kernel fin_kernel
  .amdhsa_next_free_vgpr 64
  .amdhsa_next_free_sgpr 102
  .amdhsa_accum_offset 64
  .amdhsa_group_segment_fixed_size 0
  .amdhsa_kernarg_size 120
  .amdhsa_user_sgpr_count 2
  .amdhsa_user_sgpr_kernarg_segment_ptr 1
  .amdhsa_system_sgpr_workgroup_id_x 1
.end_amdhsa_kernel
```
